```python
import torch

def _softmax(x, axis=-1):
    return torch.softmax(x, dim=axis)
def _gelu(x):
    return torch.nn.functional.gelu(x, approximate="tanh")
def _silu(x):
    return torch.nn.functional.silu(x)
def _sigmoid(x):
    return torch.sigmoid(x)
def _layernorm(x, axis=-1, eps=1e-5):
    m = x.mean(dim=axis, keepdim=True)
    v = x.var(dim=axis, keepdim=True, unbiased=False)
    return (x - m) / torch.sqrt(v + eps)
def _scatter_add(tgt, idx, src, axis=0):
    return tgt.clone().index_add_(axis, idx, src)
def _segment_sum(src, seg, n):
    out = torch.zeros((n,) + src.shape[1:], dtype=src.dtype)
    return out.index_add_(0, seg, src)
def _pad(x, pw):
    flat = tuple(v for pair in reversed(pw) for v in pair)
    return torch.nn.functional.pad(x, flat)

kernel_name = 'parallel_sum__mha_block__mixer_s_mlp__prompt'

def setup_inputs():

    _w = (lambda a: (lambda t: t.to(torch.bfloat16) if t.is_floating_point() else t)(torch.as_tensor(a)))
    def _A_setup():
        B, S, D, H = 1, 2048, 512, 32
        return {
            "x": _w((lambda *s: torch.randn(*s, dtype=torch.bfloat16) * 0.05)(B, S, D)),
            "wqkv": _w((lambda *s: torch.randn(*s, dtype=torch.bfloat16) * 0.1)(D, 3 * D)),
            "wo": _w((lambda *s: torch.randn(*s, dtype=torch.bfloat16) * 0.05)(D, D)),
        }
    _A_in = _A_setup()

    def _B_setup():
        B, S, D, F = 1, 2048, 512, 1376
        return {
            "x":  _w((lambda *s: torch.randn(*s, dtype=torch.bfloat16) * 0.05)(B, S, D)),
            "w1": _w((lambda *s: torch.randn(*s, dtype=torch.bfloat16) * 3.2)(D, D) * (D ** -0.5)),
            "w2": _w((lambda *s: torch.randn(*s, dtype=torch.bfloat16) * 3.2)(D, D) * (D ** -0.5)),
            "w3": _w((lambda *s: torch.randn(*s, dtype=torch.bfloat16) * 3.2)(D, F) * (D ** -0.5)),
            "w4": _w((lambda *s: torch.randn(*s, dtype=torch.bfloat16) * 3.2)(F, D) * (F ** -0.5)),
        }
    _B_in = _B_setup()

    return {
        "A_x": _A_in["x"],
        "A_wqkv": _A_in["wqkv"],
        "A_wo": _A_in["wo"],
        "B_x": _B_in["x"],
        "B_w1": _B_in["w1"],
        "B_w2": _B_in["w2"],
        "B_w3": _B_in["w3"],
        "B_w4": _B_in["w4"],
    }

def reference(A_x, A_wqkv, A_wo, B_x, B_w1, B_w2, B_w3, B_w4):
    def _A_ref(x, wqkv, wo):
        B, S, D = x.shape
        H = 32
        Dh = D // H
        qkv = (lambda x, *d: x.permute(*d))((x @ wqkv).reshape(B, S, 3, H, Dh), 2, 0, 3, 1, 4)
        q, k, v = qkv[0], qkv[1], qkv[2]
        scores = torch.einsum("bhqd,bhkd->bhqk", q, k) * (Dh ** -0.5)
        p = _softmax(scores, axis=-1)
        o = torch.einsum("bhqk,bhkd->bhqd", p, v)
        return (lambda x, *d: x.permute(*d))(o, 0, 2, 1, 3).reshape(B, S, D) @ wo

    def _B_ref(x, w1, w2, w3, w4):
        B, S, D = x.shape
        h = _gelu(_layernorm(x, axis=-1) @ w1)
        c = D // 4
        g0 = _pad(h[:, :, 0*c:1*c], ((0, 0), (1, 0), (0, 0)))[:, :S, :]
        g1 = _pad(h[:, :, 1*c:2*c], ((0, 0), (0, 1), (0, 0)))[:, 1:, :]
        g2 = _pad(h[:, :, 2*c:3*c], ((0, 0), (2, 0), (0, 0)))[:, :S, :]
        g3 = _pad(h[:, :, 3*c:   ], ((0, 0), (0, 2), (0, 0)))[:, 2:, :]
        hs = torch.concatenate([g0, g1, g2, g3], axis=-1) @ w2
        x1 = x + hs
        h2 = _gelu(_layernorm(x1, axis=-1) @ w3) @ w4
        return x1 + h2

    x = A_x
    xn = _layernorm(x, axis=-1)
    return x + _A_ref(xn, A_wqkv, A_wo) + _B_ref(xn, B_w1, B_w2, B_w3, B_w4)
```

```asm
; @launch grid=(256,1,1) block=(576,1,1) lds=158176
.amdgcn_target "amdgcn-amd-amdhsa--gfx950"
.text
.globl parallel_sum__mha_block__mixer_s_mlp__prompt_kernel
.p2align 8
.type parallel_sum__mha_block__mixer_s_mlp__prompt_kernel,@function
parallel_sum__mha_block__mixer_s_mlp__prompt_kernel:
f_top:
  s_cmp_ge_u32 s2, 256
  s_cbranch_scc1 f_done
  s_load_dwordx2 s[24:25], s[0:1], 0
  v_lshrrev_b32 v2, 6, v0
  v_and_b32 v1, 63, v0
  v_readfirstlane_b32 s12, v2
  s_lshr_b32 s17, s2, 3
  s_and_b32 s18, s17, 7
  s_lshr_b32 s19, s17, 3
  s_and_b32 s13, s2, 1
  s_lshl_b32 s13, s13, 3
  s_add_u32 s13, s13, s18
  s_and_b32 s14, s19, 1
  s_and_b32 s15, s2, 6
  s_lshr_b32 s16, s19, 1
  s_add_u32 s15, s15, s16
  s_lshl_b32 s16, s19, 0
  s_add_u32 s16, s16, s18
  s_cmp_ge_u32 s12, 4
  s_cbranch_scc1 f_other
  s_getpc_b64 s[20:21]
f_pc:
  s_sub_u32 s20, s20, f_pc-f_top
  s_subb_u32 s21, s21, 0
  s_mov_b32 s22, f_done-f_top
  s_mov_b32 s23, 0x20000
  s_lshr_b32 s17, s2, 3
  v_lshl_add_u32 v2, v0, 5, s17
  v_lshlrev_b32 v2, 6, v2
  buffer_load_dword v90, v2, s[20:23], 0 offen
  s_mov_b32 s63, s16
  s_mov_b32 s3, s15
  s_pack_ll_b32_b16 s97, s13, s14
  s_and_b32 s18, s12, 1
  s_lshr_b32 s19, s12, 1
  s_and_b32 s40, s18, s14
  s_movk_i32 s41, 3072
  s_cmp_eq_u32 s40, 1
  s_cselect_b32 s41, 1024, s41
  s_cselect_b32 s17, 32, 8
  s_load_dwordx2 s[36:37], s[0:1], s17
  s_lshl_b32 s42, s18, 11
  s_cmp_eq_u32 s14, 1
  s_cselect_b32 s42, 1024, s42
  s_cmp_eq_u32 s40, 1
  s_cselect_b32 s42, 0, s42
  s_lshl_b32 s43, s15, 7
  s_add_u32 s42, s42, s43
  s_lshl_b32 s34, s41, 3
  s_lshl_b32 s35, s41, 6
  s_lshl_b32 s33, s41, 5
  s_mul_i32 s33, s33, s19
  s_add_u32 s33, s33, s42
  s_lshl_b32 s32, s13, 2
  s_add_u32 s32, s32, s12
  s_lshl_b32 s32, s32, 15
  s_lshl_b32 s98, s12, 12
  s_add_u32 s98, s98, 32768
  s_lshl_b32 s99, s18, 13
  s_lshl_b32 s43, s19, 12
  s_add_u32 s99, s99, s43
  s_add_u32 s99, s99, 49152
  v_lshrrev_b32 v5, 3, v1
  v_and_b32 v6, 7, v1
  v_bfe_u32 v7, v1, 4, 2
  v_xor_b32 v7, v7, v6
  v_lshlrev_b32 v7, 4, v7
  v_lshl_add_u32 v2, v5, 10, v7
  v_xor_b32 v3, 64, v2
  v_bfe_u32 v7, v1, 4, 1
  v_lshlrev_b32 v7, 2, v7
  v_xor_b32 v7, v7, v6
  v_lshlrev_b32 v7, 4, v7
  v_mad_u32_u24 v4, v5, s41, v7
  s_sub_u32 s34, s34, 1024
  v_add_u32 v80, 0, v2
  v_mov_b32 v84, v4
  v_add_u32 v81, 7168, v3
  v_add_u32 v85, s34, v84
  v_add_u32 v82, 14336, v2
  v_add_u32 v86, s34, v85
  v_add_u32 v83, 21504, v3
  v_add_u32 v87, s34, v86
  s_mov_b32 s26, 0x200000
  s_mov_b32 s27, 0x20000
  s_lshl_b32 s38, s41, 9
  s_mov_b32 s39, 0x20000
  s_add_u32 s16, s63, 0
  s_and_b32 s16, s16, 1
  s_lshl_b32 s17, s16, 7
  s_add_u32 s17, s17, s32
  s_mul_i32 s18, s16, s35
  s_add_u32 s18, s18, s33
  s_add_u32 m0, s98, 0
  s_waitcnt lgkmcnt(0)
  buffer_load_dwordx4 v80, s[24:27], s17 offen offset:0 lds
  buffer_load_dwordx4 v81, s[24:27], s17 offen offset:1024 lds
  buffer_load_dwordx4 v82, s[24:27], s17 offen offset:2048 lds
  buffer_load_dwordx4 v83, s[24:27], s17 offen offset:3072 lds
  s_add_u32 m0, s99, 0
  s_nop 0
  buffer_load_dwordx4 v84, s[36:39], s18 offen offset:0 lds
  buffer_load_dwordx4 v85, s[36:39], s18 offen offset:1024 lds
  buffer_load_dwordx4 v86, s[36:39], s18 offen offset:2048 lds
  buffer_load_dwordx4 v87, s[36:39], s18 offen offset:3072 lds
  s_add_u32 s16, s63, 1
  s_and_b32 s16, s16, 1
  s_lshl_b32 s17, s16, 7
  s_add_u32 s17, s17, s32
  s_mul_i32 s18, s16, s35
  s_add_u32 s18, s18, s33
  s_add_u32 m0, s98, 32768
  s_nop 0
  buffer_load_dwordx4 v80, s[24:27], s17 offen offset:0 lds
  buffer_load_dwordx4 v81, s[24:27], s17 offen offset:1024 lds
  buffer_load_dwordx4 v82, s[24:27], s17 offen offset:2048 lds
  buffer_load_dwordx4 v83, s[24:27], s17 offen offset:3072 lds
  s_add_u32 m0, s99, 32768
  s_nop 0
  buffer_load_dwordx4 v84, s[36:39], s18 offen offset:0 lds
  buffer_load_dwordx4 v85, s[36:39], s18 offen offset:1024 lds
  buffer_load_dwordx4 v86, s[36:39], s18 offen offset:2048 lds
  buffer_load_dwordx4 v87, s[36:39], s18 offen offset:3072 lds
  s_branch f_loader
f_other:
  s_load_dwordx2 s[4:5], s[0:1], 0
  s_load_dwordx2 s[10:11], s[0:1], 80
  s_load_dwordx4 s[52:55], s[0:1], 40
  s_load_dwordx2 s[56:57], s[0:1], 56
  s_load_dwordx2 s[58:59], s[0:1], 16
  s_load_dwordx2 s[50:51], s[0:1], 64
  s_load_dwordx2 s[100:101], s[0:1], 72
  s_mov_b32 s62, 100000
  s_cmp_eq_u32 s12, 8
  s_cbranch_scc1 f_s
  s_sub_u32 s12, s12, 4
  s_setprio 1
  v_mov_b32 v2, 0
  v_min_u32 v3, 21, v1
  v_lshlrev_b32 v3, 2, v3
  v_add_u32 v3, 156032, v3
  ds_write_b32 v3, v2
  s_and_b32 s18, s12, 1
  s_lshr_b32 s19, s12, 1
  v_and_b32 v2, 31, v1
  v_lshrrev_b32 v3, 5, v1
  s_lshl1_add_u32 s41, s18, s19
  s_mov_b32 s35, 0xffff0000
  s_lshl_b32 s17, s41, 12
  s_add_u32 s17, s17, 32768
  v_lshl_add_u32 v10, v2, 7, s17
  v_bfe_u32 v11, v1, 1, 3
  s_lshl_b32 s17, s18, 2
  v_xor_b32 v11, s17, v11
  v_add_u32 v152, 0, v3
  v_xor_b32 v152, v152, v11
  v_lshl_add_u32 v152, v152, 4, v10
  v_xor_b32 v156, 4096, v152
  v_add_u32 v160, 65536, v152
  v_add_u32 v164, 65536, v156
  v_add_u32 v153, 2, v3
  v_xor_b32 v153, v153, v11
  v_lshl_add_u32 v153, v153, 4, v10
  v_xor_b32 v157, 4096, v153
  v_add_u32 v161, 65536, v153
  v_add_u32 v165, 65536, v157
  v_add_u32 v154, 4, v3
  v_xor_b32 v154, v154, v11
  v_lshl_add_u32 v154, v154, 4, v10
  v_xor_b32 v158, 4096, v154
  v_add_u32 v162, 65536, v154
  v_add_u32 v166, 65536, v158
  v_add_u32 v155, 6, v3
  v_xor_b32 v155, v155, v11
  v_lshl_add_u32 v155, v155, 4, v10
  v_xor_b32 v159, 4096, v155
  v_add_u32 v163, 65536, v155
  v_add_u32 v167, 65536, v159
  v_mov_b32 v48, 0
  v_mov_b32 v49, 0
  v_bfe_u32 v10, v1, 2, 2
  v_lshl_add_u32 v10, v3, 3, v10
  v_lshlrev_b32 v10, 7, v10
  v_bfe_u32 v11, v1, 3, 1
  v_xor_b32 v11, s19, v11
  v_lshl_add_u32 v10, v11, 6, v10
  v_bfe_u32 v11, v1, 4, 1
  v_lshl_add_u32 v10, v11, 5, v10
  v_and_b32 v11, 3, v1
  v_lshl_add_u32 v10, v11, 3, v10
  s_lshl_b32 s17, s18, 12
  s_add_u32 s17, s17, 49152
  v_add_u32 v120, s17, v10
  v_xor_b32 v121, 4096, v120
  v_add_u32 v122, 65536, v120
  v_add_u32 v123, 65536, v121
  s_waitcnt lgkmcnt(0)
  s_cmp_eq_u32 s14, 1
  s_cbranch_scc1 p1_type1
  s_branch p1_type0
f_loader:
  s_load_dwordx2 s[4:5], s[0:1], 0
  s_load_dwordx2 s[10:11], s[0:1], 80
  s_load_dwordx4 s[52:55], s[0:1], 40
  s_load_dwordx2 s[56:57], s[0:1], 56
  s_load_dwordx2 s[58:59], s[0:1], 16
  s_load_dwordx2 s[50:51], s[0:1], 64
  s_load_dwordx2 s[100:101], s[0:1], 72
  s_mov_b32 s62, 100000
  v_mov_b32 v12, 0
  s_waitcnt lgkmcnt(0)
  s_mov_b32 s28, s100
  s_mov_b32 s29, s101
  s_mov_b32 s30, 0x100
  s_mov_b32 s31, 0x20000
  s_or_b32 s17, s2, s12
  s_cbranch_scc1 f_no_nonce
  s_memrealtime s[46:47]
  s_waitcnt lgkmcnt(0)
  s_or_b32 s46, s46, 1
  v_mov_b32 v8, s46
  v_mov_b32 v9, s47
  s_mov_b64 exec, 1
  buffer_store_dwordx2 v[8:9], v12, s[28:31], 0 offen sc1
  s_mov_b64 exec, -1
f_no_nonce:
  s_waitcnt vmcnt(8)
  s_barrier
  s_add_u32 s16, s63, 2
  s_and_b32 s16, s16, 1
  s_or_b32 s16, s16, 2
  s_lshl_b32 s17, s16, 7
  s_add_u32 s17, s17, s32
  s_mul_i32 s18, s16, s35
  s_add_u32 s18, s18, s33
  s_add_u32 m0, s98, 65536
  s_nop 0
  buffer_load_dwordx4 v80, s[24:27], s17 offen offset:0 lds
  buffer_load_dwordx4 v81, s[24:27], s17 offen offset:1024 lds
  buffer_load_dwordx4 v82, s[24:27], s17 offen offset:2048 lds
  buffer_load_dwordx4 v83, s[24:27], s17 offen offset:3072 lds
  s_add_u32 m0, s99, 65536
  s_nop 0
  buffer_load_dwordx4 v84, s[36:39], s18 offen offset:0 lds
  buffer_load_dwordx4 v85, s[36:39], s18 offen offset:1024 lds
  buffer_load_dwordx4 v86, s[36:39], s18 offen offset:2048 lds
  buffer_load_dwordx4 v87, s[36:39], s18 offen offset:3072 lds
  s_waitcnt vmcnt(8)
  s_barrier
  s_add_u32 s16, s63, 3
  s_and_b32 s16, s16, 1
  s_or_b32 s16, s16, 2
  s_lshl_b32 s17, s16, 7
  s_add_u32 s17, s17, s32
  s_mul_i32 s18, s16, s35
  s_add_u32 s18, s18, s33
  s_add_u32 m0, s98, 0
  s_nop 0
  buffer_load_dwordx4 v80, s[24:27], s17 offen offset:0 lds
  buffer_load_dwordx4 v81, s[24:27], s17 offen offset:1024 lds
  buffer_load_dwordx4 v82, s[24:27], s17 offen offset:2048 lds
  buffer_load_dwordx4 v83, s[24:27], s17 offen offset:3072 lds
  s_add_u32 m0, s99, 0
  s_nop 0
  buffer_load_dwordx4 v84, s[36:39], s18 offen offset:0 lds
  buffer_load_dwordx4 v85, s[36:39], s18 offen offset:1024 lds
  buffer_load_dwordx4 v86, s[36:39], s18 offen offset:2048 lds
  buffer_load_dwordx4 v87, s[36:39], s18 offen offset:3072 lds
  s_waitcnt vmcnt(8)
  s_barrier
  s_add_u32 s16, s63, 4
  s_and_b32 s16, s16, 1
  s_or_b32 s16, s16, 4
  s_lshl_b32 s17, s16, 7
  s_add_u32 s17, s17, s32
  s_mul_i32 s18, s16, s35
  s_add_u32 s18, s18, s33
  s_add_u32 m0, s98, 32768
  s_nop 0
  buffer_load_dwordx4 v80, s[24:27], s17 offen offset:0 lds
  buffer_load_dwordx4 v81, s[24:27], s17 offen offset:1024 lds
  buffer_load_dwordx4 v82, s[24:27], s17 offen offset:2048 lds
  buffer_load_dwordx4 v83, s[24:27], s17 offen offset:3072 lds
  s_add_u32 m0, s99, 32768
  s_nop 0
  buffer_load_dwordx4 v84, s[36:39], s18 offen offset:0 lds
  buffer_load_dwordx4 v85, s[36:39], s18 offen offset:1024 lds
  buffer_load_dwordx4 v86, s[36:39], s18 offen offset:2048 lds
  buffer_load_dwordx4 v87, s[36:39], s18 offen offset:3072 lds
  s_waitcnt vmcnt(8)
  s_barrier
  s_add_u32 s16, s63, 5
  s_and_b32 s16, s16, 1
  s_or_b32 s16, s16, 4
  s_lshl_b32 s17, s16, 7
  s_add_u32 s17, s17, s32
  s_mul_i32 s18, s16, s35
  s_add_u32 s18, s18, s33
  s_add_u32 m0, s98, 65536
  s_nop 0
  buffer_load_dwordx4 v80, s[24:27], s17 offen offset:0 lds
  buffer_load_dwordx4 v81, s[24:27], s17 offen offset:1024 lds
  buffer_load_dwordx4 v82, s[24:27], s17 offen offset:2048 lds
  buffer_load_dwordx4 v83, s[24:27], s17 offen offset:3072 lds
  s_add_u32 m0, s99, 65536
  s_nop 0
  buffer_load_dwordx4 v84, s[36:39], s18 offen offset:0 lds
  buffer_load_dwordx4 v85, s[36:39], s18 offen offset:1024 lds
  buffer_load_dwordx4 v86, s[36:39], s18 offen offset:2048 lds
  buffer_load_dwordx4 v87, s[36:39], s18 offen offset:3072 lds
  s_waitcnt vmcnt(8)
  s_barrier
  s_add_u32 s16, s63, 6
  s_and_b32 s16, s16, 1
  s_or_b32 s16, s16, 6
  s_lshl_b32 s17, s16, 7
  s_add_u32 s17, s17, s32
  s_mul_i32 s18, s16, s35
  s_add_u32 s18, s18, s33
  s_add_u32 m0, s98, 0
  s_nop 0
  buffer_load_dwordx4 v80, s[24:27], s17 offen offset:0 lds
  buffer_load_dwordx4 v81, s[24:27], s17 offen offset:1024 lds
  buffer_load_dwordx4 v82, s[24:27], s17 offen offset:2048 lds
  buffer_load_dwordx4 v83, s[24:27], s17 offen offset:3072 lds
  s_add_u32 m0, s99, 0
  s_nop 0
  buffer_load_dwordx4 v84, s[36:39], s18 offen offset:0 lds
  buffer_load_dwordx4 v85, s[36:39], s18 offen offset:1024 lds
  buffer_load_dwordx4 v86, s[36:39], s18 offen offset:2048 lds
  buffer_load_dwordx4 v87, s[36:39], s18 offen offset:3072 lds
  s_waitcnt vmcnt(8)
  s_barrier
  s_add_u32 s16, s63, 7
  s_and_b32 s16, s16, 1
  s_or_b32 s16, s16, 6
  s_lshl_b32 s17, s16, 7
  s_add_u32 s17, s17, s32
  s_mul_i32 s18, s16, s35
  s_add_u32 s18, s18, s33
  s_add_u32 m0, s98, 32768
  s_nop 0
  buffer_load_dwordx4 v80, s[24:27], s17 offen offset:0 lds
  buffer_load_dwordx4 v81, s[24:27], s17 offen offset:1024 lds
  buffer_load_dwordx4 v82, s[24:27], s17 offen offset:2048 lds
  buffer_load_dwordx4 v83, s[24:27], s17 offen offset:3072 lds
  s_add_u32 m0, s99, 32768
  s_nop 0
  buffer_load_dwordx4 v84, s[36:39], s18 offen offset:0 lds
  buffer_load_dwordx4 v85, s[36:39], s18 offen offset:1024 lds
  buffer_load_dwordx4 v86, s[36:39], s18 offen offset:2048 lds
  buffer_load_dwordx4 v87, s[36:39], s18 offen offset:3072 lds
  buffer_load_dwordx2 v[16:17], v12, s[28:31], 0 offen sc1
  s_bfe_u32 s16, s2, 0x20001
  s_bfe_u32 s17, s2, 0x20003
  s_lshl2_add_u32 s13, s16, s17
  s_and_b32 s16, s2, 1
  s_lshr_b32 s17, s2, 5
  s_lshl3_add_u32 s14, s16, s17
  s_and_b32 s96, s13, 3
  s_lshl_b32 s96, s96, 1
  s_and_b32 s63, s14, 7
  s_lshl_b32 s63, s63, 2
  s_lshl_b32 s15, s13, 2
  s_add_u32 s15, s15, s12
  s_lshl_b32 s40, s12, 10
  s_lshl_b32 s41, s14, 6
  s_lshr_b32 s16, s14, 3
  s_lshl_b32 s16, s16, 1
  s_add_u32 s44, s16, 0
  s_and_b32 s44, s44, 3
  s_lshl_b32 s44, s44, 3
  s_add_u32 s45, s16, 1
  s_and_b32 s45, s45, 3
  s_lshl_b32 s45, s45, 3
  s_add_u32 s46, s16, 2
  s_and_b32 s46, s46, 3
  s_lshl_b32 s46, s46, 3
  s_add_u32 s47, s16, 3
  s_and_b32 s47, s47, 3
  s_lshl_b32 s47, s47, 3
  v_lshrrev_b32 v18, 2, v1
  v_and_b32 v19, 3, v1
  v_lshlrev_b32 v19, 4, v19
  v_lshl_add_u32 v8, v18, 10, v19
  s_mov_b32 s20, s52
  s_mov_b32 s21, s53
  s_mov_b32 s22, 0x80000
  s_mov_b32 s23, 0x20000
  s_mul_i32 s48, s14, 192
  s_mul_i32 s49, s12, 3072
  v_add_u32 v20, 0, v1
  v_mul_u32_u24 v21, 0x5556, v20
  v_lshrrev_b32 v21, 18, v21
  v_mul_u32_u24 v22, 12, v21
  v_sub_u32 v20, v20, v22
  v_mul_u32_u24 v21, 2752, v21
  v_lshl_add_u32 v9, v20, 4, v21
  v_add_u32 v20, 64, v1
  v_mul_u32_u24 v21, 0x5556, v20
  v_lshrrev_b32 v21, 18, v21
  v_mul_u32_u24 v22, 12, v21
  v_sub_u32 v20, v20, v22
  v_mul_u32_u24 v21, 2752, v21
  v_lshl_add_u32 v10, v20, 4, v21
  v_add_u32 v20, 128, v1
  v_mul_u32_u24 v21, 0x5556, v20
  v_lshrrev_b32 v21, 18, v21
  v_mul_u32_u24 v22, 12, v21
  v_sub_u32 v20, v20, v22
  v_mul_u32_u24 v21, 2752, v21
  v_lshl_add_u32 v11, v20, 4, v21
  s_waitcnt vmcnt(9)
  s_barrier
  s_waitcnt vmcnt(1)
  s_barrier
  s_waitcnt vmcnt(0)
f_nonce:
  v_readfirstlane_b32 s60, v16
  v_readfirstlane_b32 s61, v17
  s_cmp_lg_u32 s60, 0
  s_cbranch_scc1 f_nonce_ok
  buffer_load_dwordx2 v[16:17], v12, s[28:31], 0 offen sc1
  s_waitcnt vmcnt(0)
  s_sleep 1
  s_sub_u32 s62, s62, 1
  s_cbranch_scc0 f_nonce
  s_mov_b32 s62, 0
f_nonce_ok:
  v_mov_b32 v12, 156088
  ds_write_b64 v12, v[16:17]
  s_waitcnt lgkmcnt(0)
  s_barrier
  v_and_b32 v18, 31, v1
  s_lshl_b32 s16, s15, 5
  v_add_u32 v18, s16, v18
  v_lshrrev_b32 v19, 5, v1
  s_add_u32 s36, s10, 0x1200000
  s_addc_u32 s37, s11, 0
  s_mov_b32 s38, 0x4000
  s_mov_b32 s39, 0x20000
  s_add_u32 s32, s10, 0x1300000
  s_addc_u32 s33, s11, 0
  s_mov_b32 s34, 0x9c000
  s_mov_b32 s35, 0x20000
  v_lshlrev_b32 v48, 10, v18
  v_lshl_add_u32 v48, v19, 4, v48
  v_lshlrev_b32 v23, 3, v18
  s_add_u32 s24, s10, 0x600000
  s_addc_u32 s25, s11, 0
  s_mov_b32 s26, 0x200000
  s_mov_b32 s27, 0x20000
  v_lshlrev_b32 v19, 15, v19
  s_mov_b32 s19, 0x02fe01ff
  s_lshr_b32 s16, s19, s44
  s_sext_i32_i8 s16, s16
  v_add_u32 v20, s16, v18
  v_lshl_add_u32 v2, v20, 4, v19
  v_cmp_gt_u32 vcc, 2048, v20
  s_nop 1
  v_cndmask_b32 v2, -1, v2, vcc
  v_and_b32 v2, 0x7ffffff0, v2
  s_lshr_b32 s16, s19, s45
  s_sext_i32_i8 s16, s16
  v_add_u32 v20, s16, v18
  v_lshl_add_u32 v3, v20, 4, v19
  v_cmp_gt_u32 vcc, 2048, v20
  s_nop 1
  v_cndmask_b32 v3, -1, v3, vcc
  v_and_b32 v3, 0x7ffffff0, v3
  s_lshr_b32 s16, s19, s46
  s_sext_i32_i8 s16, s16
  v_add_u32 v20, s16, v18
  v_lshl_add_u32 v4, v20, 4, v19
  v_cmp_gt_u32 vcc, 2048, v20
  s_nop 1
  v_cndmask_b32 v4, -1, v4, vcc
  v_and_b32 v4, 0x7ffffff0, v4
  s_lshr_b32 s16, s19, s47
  s_sext_i32_i8 s16, s16
  v_add_u32 v20, s16, v18
  v_lshl_add_u32 v5, v20, 4, v19
  v_cmp_gt_u32 vcc, 2048, v20
  s_nop 1
  v_cndmask_b32 v5, -1, v5, vcc
  v_and_b32 v5, 0x7ffffff0, v5
  v_bfe_u32 v20, v1, 2, 2
  v_lshrrev_b32 v21, 5, v1
  v_lshl_add_u32 v20, v21, 2, v20
  v_bfe_u32 v21, v1, 4, 1
  v_lshlrev_b32 v21, 5, v21
  v_and_b32 v22, 3, v1
  v_lshl_add_u32 v21, v22, 3, v21
  v_lshl_add_u32 v6, v20, 6, v21
  v_mul_u32_u24 v7, 192, v20
  v_add_u32 v7, v7, v21
  v_add_u32 v7, 32768, v7
  v_mov_b32 v13, 1
  v_mov_b32 v14, 156032
  v_bfe_u32 v20, v1, 4, 1
  v_lshlrev_b32 v20, 2, v20
  v_and_b32 v21, 7, v1
  v_xor_b32 v20, v20, v21
  v_lshlrev_b32 v20, 4, v20
  v_lshrrev_b32 v12, 3, v1
  v_lshl_add_u32 v15, v12, 10, v20
  v_min_u32 v12, 2, v12
  s_sub_u32 s16, s15, 1
  v_add_u32 v12, s16, v12
  v_med3_i32 v12, v12, 0, 63
  v_and_b32 v20, 7, v1
  v_lshlrev_b32 v20, 7, v20
  v_lshl_add_u32 v12, v12, 10, v20
  s_and_b32 s8, s97, 0xffff
  s_lshr_b32 s9, s97, 16
  s_lshl_b32 s17, s12, 2
  s_add_u32 s17, s17, 156072
  v_mov_b32 v30, s17
  s_cmp_eq_u32 s9, 1
  s_cbranch_scc0 p1_no_h
  s_lshl_b32 s19, s8, 2
  s_add_u32 s19, s19, s12
  s_lshl_b32 s17, s12, 13
  s_add_u32 s17, s17, 32768
  v_lshl_add_u32 v29, v1, 4, s17
  s_add_u32 s24, s10, 0x600000
  s_addc_u32 s25, s11, 0
  s_mov_b32 s26, 0x200000
  s_mov_b32 s27, 0x20000
  s_add_u32 s28, s10, 0x1200000
  s_addc_u32 s29, s11, 0
  s_mov_b32 s30, 0x4000
  s_mov_b32 s31, 0x20000
  s_lshl_b32 s17, s12, 10
  s_add_u32 s17, s17, 102400
  v_lshl_add_u32 v28, v1, 4, s17
  ds_read_b128 v[76:79], v28
f_hand:
  ds_read_b32 v18, v30 offset:0
  s_waitcnt lgkmcnt(0)
  v_readfirstlane_b32 s16, v18
  s_nop 0
  s_cmp_ge_u32 s16, 4
  s_cbranch_scc1 f_hand_ok
  s_sleep 1
  s_sub_u32 s62, s62, 1
  s_cbranch_scc0 f_hand
  s_mov_b32 s62, 0
f_hand_ok:
  ds_read_b128 v[120:123], v29 offset:0
  ds_read_b128 v[124:127], v29 offset:1024
  ds_read_b128 v[128:131], v29 offset:2048
  ds_read_b128 v[132:135], v29 offset:3072
  ds_read_b128 v[136:139], v29 offset:4096
  ds_read_b128 v[140:143], v29 offset:5120
  ds_read_b128 v[144:147], v29 offset:6144
  ds_read_b128 v[148:151], v29 offset:7168
  s_lshl_b32 s17, s19, 5
  v_and_b32 v28, 31, v1
  v_add_u32 v28, s17, v28
  v_lshrrev_b32 v29, 5, v1
  v_lshlrev_b32 v29, 15, v29
  v_lshl_add_u32 v29, v28, 4, v29
  v_lshlrev_b32 v28, 3, v28
  v_mul_f32 v24, v77, v77
  v_mov_b32 v25, 0x3727c5ac
  v_fma_f32 v24, v24, v78, v25
  v_rsq_f32 v24, v24
  s_nop 0
  v_mul_f32 v79, v77, v24
  v_rcp_f32 v26, v79
  v_mul_f32 v24, v79, v79
  v_mul_f32 v24, v24, v79
  v_mul_f32 v24, 0xbdd2d3e8, v24
  v_mul_f32 v25, 0xc0135761, v79
  s_lshl_b32 s18, s3, 18
  s_waitcnt lgkmcnt(4)
  v_pk_mul_f32 v[152:153], v[120:121], v[120:121]
  v_pk_mul_f32 v[154:155], v[122:123], v[122:123]
  v_pk_mul_f32 v[156:157], v[124:125], v[124:125]
  v_pk_mul_f32 v[158:159], v[126:127], v[126:127]
  v_pk_mul_f32 v[160:161], v[128:129], v[128:129]
  v_pk_mul_f32 v[162:163], v[130:131], v[130:131]
  v_pk_mul_f32 v[164:165], v[132:133], v[132:133]
  v_pk_mul_f32 v[166:167], v[134:135], v[134:135]
  v_pk_fma_f32 v[152:153], v[152:153], v[24:25], v[24:25] op_sel:[0,0,1] op_sel_hi:[1,0,1]
  v_pk_fma_f32 v[154:155], v[154:155], v[24:25], v[24:25] op_sel:[0,0,1] op_sel_hi:[1,0,1]
  v_pk_fma_f32 v[156:157], v[156:157], v[24:25], v[24:25] op_sel:[0,0,1] op_sel_hi:[1,0,1]
  v_pk_fma_f32 v[158:159], v[158:159], v[24:25], v[24:25] op_sel:[0,0,1] op_sel_hi:[1,0,1]
  v_pk_fma_f32 v[160:161], v[160:161], v[24:25], v[24:25] op_sel:[0,0,1] op_sel_hi:[1,0,1]
  v_pk_fma_f32 v[162:163], v[162:163], v[24:25], v[24:25] op_sel:[0,0,1] op_sel_hi:[1,0,1]
  v_pk_fma_f32 v[164:165], v[164:165], v[24:25], v[24:25] op_sel:[0,0,1] op_sel_hi:[1,0,1]
  v_pk_fma_f32 v[166:167], v[166:167], v[24:25], v[24:25] op_sel:[0,0,1] op_sel_hi:[1,0,1]
  v_pk_mul_f32 v[152:153], v[152:153], v[120:121]
  v_pk_mul_f32 v[154:155], v[154:155], v[122:123]
  v_pk_mul_f32 v[156:157], v[156:157], v[124:125]
  v_pk_mul_f32 v[158:159], v[158:159], v[126:127]
  v_pk_mul_f32 v[160:161], v[160:161], v[128:129]
  v_pk_mul_f32 v[162:163], v[162:163], v[130:131]
  v_pk_mul_f32 v[164:165], v[164:165], v[132:133]
  v_pk_mul_f32 v[166:167], v[166:167], v[134:135]
  v_exp_f32 v152, v152
  v_exp_f32 v153, v153
  v_exp_f32 v154, v154
  v_exp_f32 v155, v155
  v_exp_f32 v156, v156
  v_exp_f32 v157, v157
  v_exp_f32 v158, v158
  v_exp_f32 v159, v159
  v_exp_f32 v160, v160
  v_exp_f32 v161, v161
  v_exp_f32 v162, v162
  v_exp_f32 v163, v163
  v_exp_f32 v164, v164
  v_exp_f32 v165, v165
  v_exp_f32 v166, v166
  v_exp_f32 v167, v167
  v_pk_fma_f32 v[152:153], v[152:153], v[26:27], v[26:27] op_sel_hi:[1,0,0]
  v_pk_fma_f32 v[154:155], v[154:155], v[26:27], v[26:27] op_sel_hi:[1,0,0]
  v_pk_fma_f32 v[156:157], v[156:157], v[26:27], v[26:27] op_sel_hi:[1,0,0]
  v_pk_fma_f32 v[158:159], v[158:159], v[26:27], v[26:27] op_sel_hi:[1,0,0]
  v_pk_fma_f32 v[160:161], v[160:161], v[26:27], v[26:27] op_sel_hi:[1,0,0]
  v_pk_fma_f32 v[162:163], v[162:163], v[26:27], v[26:27] op_sel_hi:[1,0,0]
  v_pk_fma_f32 v[164:165], v[164:165], v[26:27], v[26:27] op_sel_hi:[1,0,0]
  v_pk_fma_f32 v[166:167], v[166:167], v[26:27], v[26:27] op_sel_hi:[1,0,0]
  v_rcp_f32 v152, v152
  v_rcp_f32 v153, v153
  v_rcp_f32 v154, v154
  v_rcp_f32 v155, v155
  v_rcp_f32 v156, v156
  v_rcp_f32 v157, v157
  v_rcp_f32 v158, v158
  v_rcp_f32 v159, v159
  v_rcp_f32 v160, v160
  v_rcp_f32 v161, v161
  v_rcp_f32 v162, v162
  v_rcp_f32 v163, v163
  v_rcp_f32 v164, v164
  v_rcp_f32 v165, v165
  v_rcp_f32 v166, v166
  v_rcp_f32 v167, v167
  v_pk_mul_f32 v[120:121], v[120:121], v[152:153]
  v_pk_mul_f32 v[122:123], v[122:123], v[154:155]
  v_pk_mul_f32 v[124:125], v[124:125], v[156:157]
  v_pk_mul_f32 v[126:127], v[126:127], v[158:159]
  v_pk_mul_f32 v[128:129], v[128:129], v[160:161]
  v_pk_mul_f32 v[130:131], v[130:131], v[162:163]
  v_pk_mul_f32 v[132:133], v[132:133], v[164:165]
  v_pk_mul_f32 v[134:135], v[134:135], v[166:167]
  v_cvt_pk_bf16_f32 v120, v120, v121
  v_cvt_pk_bf16_f32 v121, v122, v123
  v_cvt_pk_bf16_f32 v122, v124, v125
  v_cvt_pk_bf16_f32 v123, v126, v127
  v_cvt_pk_bf16_f32 v124, v128, v129
  v_cvt_pk_bf16_f32 v125, v130, v131
  v_cvt_pk_bf16_f32 v126, v132, v133
  v_cvt_pk_bf16_f32 v127, v134, v135
  s_waitcnt lgkmcnt(0)
  v_pk_mul_f32 v[152:153], v[136:137], v[136:137]
  v_pk_mul_f32 v[154:155], v[138:139], v[138:139]
  v_pk_mul_f32 v[156:157], v[140:141], v[140:141]
  v_pk_mul_f32 v[158:159], v[142:143], v[142:143]
  v_pk_mul_f32 v[160:161], v[144:145], v[144:145]
  v_pk_mul_f32 v[162:163], v[146:147], v[146:147]
  v_pk_mul_f32 v[164:165], v[148:149], v[148:149]
  v_pk_mul_f32 v[166:167], v[150:151], v[150:151]
  v_pk_fma_f32 v[152:153], v[152:153], v[24:25], v[24:25] op_sel:[0,0,1] op_sel_hi:[1,0,1]
  v_pk_fma_f32 v[154:155], v[154:155], v[24:25], v[24:25] op_sel:[0,0,1] op_sel_hi:[1,0,1]
  v_pk_fma_f32 v[156:157], v[156:157], v[24:25], v[24:25] op_sel:[0,0,1] op_sel_hi:[1,0,1]
  v_pk_fma_f32 v[158:159], v[158:159], v[24:25], v[24:25] op_sel:[0,0,1] op_sel_hi:[1,0,1]
  v_pk_fma_f32 v[160:161], v[160:161], v[24:25], v[24:25] op_sel:[0,0,1] op_sel_hi:[1,0,1]
  v_pk_fma_f32 v[162:163], v[162:163], v[24:25], v[24:25] op_sel:[0,0,1] op_sel_hi:[1,0,1]
  v_pk_fma_f32 v[164:165], v[164:165], v[24:25], v[24:25] op_sel:[0,0,1] op_sel_hi:[1,0,1]
  v_pk_fma_f32 v[166:167], v[166:167], v[24:25], v[24:25] op_sel:[0,0,1] op_sel_hi:[1,0,1]
  v_pk_mul_f32 v[152:153], v[152:153], v[136:137]
  v_pk_mul_f32 v[154:155], v[154:155], v[138:139]
  v_pk_mul_f32 v[156:157], v[156:157], v[140:141]
  v_pk_mul_f32 v[158:159], v[158:159], v[142:143]
  v_pk_mul_f32 v[160:161], v[160:161], v[144:145]
  v_pk_mul_f32 v[162:163], v[162:163], v[146:147]
  v_pk_mul_f32 v[164:165], v[164:165], v[148:149]
  v_pk_mul_f32 v[166:167], v[166:167], v[150:151]
  v_exp_f32 v152, v152
  v_exp_f32 v153, v153
  v_exp_f32 v154, v154
  v_exp_f32 v155, v155
  v_exp_f32 v156, v156
  v_exp_f32 v157, v157
  v_exp_f32 v158, v158
  v_exp_f32 v159, v159
  v_exp_f32 v160, v160
  v_exp_f32 v161, v161
  v_exp_f32 v162, v162
  v_exp_f32 v163, v163
  v_exp_f32 v164, v164
  v_exp_f32 v165, v165
  v_exp_f32 v166, v166
  v_exp_f32 v167, v167
  v_pk_fma_f32 v[152:153], v[152:153], v[26:27], v[26:27] op_sel_hi:[1,0,0]
  v_pk_fma_f32 v[154:155], v[154:155], v[26:27], v[26:27] op_sel_hi:[1,0,0]
  v_pk_fma_f32 v[156:157], v[156:157], v[26:27], v[26:27] op_sel_hi:[1,0,0]
  v_pk_fma_f32 v[158:159], v[158:159], v[26:27], v[26:27] op_sel_hi:[1,0,0]
  v_pk_fma_f32 v[160:161], v[160:161], v[26:27], v[26:27] op_sel_hi:[1,0,0]
  v_pk_fma_f32 v[162:163], v[162:163], v[26:27], v[26:27] op_sel_hi:[1,0,0]
  v_pk_fma_f32 v[164:165], v[164:165], v[26:27], v[26:27] op_sel_hi:[1,0,0]
  v_pk_fma_f32 v[166:167], v[166:167], v[26:27], v[26:27] op_sel_hi:[1,0,0]
  v_rcp_f32 v152, v152
  v_rcp_f32 v153, v153
  v_rcp_f32 v154, v154
  v_rcp_f32 v155, v155
  v_rcp_f32 v156, v156
  v_rcp_f32 v157, v157
  v_rcp_f32 v158, v158
  v_rcp_f32 v159, v159
  v_rcp_f32 v160, v160
  v_rcp_f32 v161, v161
  v_rcp_f32 v162, v162
  v_rcp_f32 v163, v163
  v_rcp_f32 v164, v164
  v_rcp_f32 v165, v165
  v_rcp_f32 v166, v166
  v_rcp_f32 v167, v167
  v_pk_mul_f32 v[136:137], v[136:137], v[152:153]
  v_pk_mul_f32 v[138:139], v[138:139], v[154:155]
  v_pk_mul_f32 v[140:141], v[140:141], v[156:157]
  v_pk_mul_f32 v[142:143], v[142:143], v[158:159]
  v_pk_mul_f32 v[144:145], v[144:145], v[160:161]
  v_pk_mul_f32 v[146:147], v[146:147], v[162:163]
  v_pk_mul_f32 v[148:149], v[148:149], v[164:165]
  v_pk_mul_f32 v[150:151], v[150:151], v[166:167]
  v_cvt_pk_bf16_f32 v128, v136, v137
  v_cvt_pk_bf16_f32 v129, v138, v139
  v_cvt_pk_bf16_f32 v130, v140, v141
  v_cvt_pk_bf16_f32 v131, v142, v143
  v_cvt_pk_bf16_f32 v132, v144, v145
  v_cvt_pk_bf16_f32 v133, v146, v147
  v_cvt_pk_bf16_f32 v134, v148, v149
  v_cvt_pk_bf16_f32 v135, v150, v151
  s_cmp_eq_u32 s3, 0
  s_cselect_b32 s16, 0, 0x7ff00000
  buffer_store_dwordx2 v[76:77], v28, s[28:31], s16 offen sc1
  buffer_store_dwordx4 v[120:123], v29, s[24:27], s18 offen sc1
  s_add_u32 s18, s18, 65536
  buffer_store_dwordx4 v[124:127], v29, s[24:27], s18 offen sc1
  s_add_u32 s18, s18, 65536
  buffer_store_dwordx4 v[128:131], v29, s[24:27], s18 offen sc1
  s_add_u32 s18, s18, 65536
  buffer_store_dwordx4 v[132:135], v29, s[24:27], s18 offen sc1
  s_add_u32 s18, s18, 65536
  s_lshl_b32 s16, s19, 10
  s_lshl_b32 s17, s3, 7
  s_add_u32 s16, s16, s17
  s_add_u32 s16, s16, 393216
  s_add_u32 s28, s10, 0x1300000
  s_addc_u32 s29, s11, 0
  s_mov_b32 s30, 0x9c000
  s_mov_b32 s31, 0x20000
  v_mov_b32 v24, s60
  v_mov_b32 v25, s61
  v_mov_b32 v26, s60
  v_mov_b32 v27, s61
  v_lshlrev_b32 v28, 4, v1
  s_waitcnt vmcnt(0)
  s_mov_b64 exec, 0xff
  buffer_store_dwordx4 v[24:27], v28, s[28:31], s16 offen sc1
  s_mov_b64 exec, -1
p1_no_h:
  s_mov_b64 exec, 1
  ds_add_u32 v14, v13 offset:8
  s_mov_b64 exec, -1
b_s0:
  ds_read_b32 v18, v14 offset:28
  s_waitcnt lgkmcnt(0)
  v_readfirstlane_b32 s16, v18
  s_nop 0
  s_cmp_ge_u32 s16, 4
  s_cbranch_scc1 b_s0_ok
  s_sleep 1
  s_sub_u32 s62, s62, 1
  s_cbranch_scc0 b_s0
  s_mov_b32 s62, 0
b_s0_ok:
b_s1:
  ds_read_b32 v18, v14 offset:8
  s_waitcnt lgkmcnt(0)
  v_readfirstlane_b32 s16, v18
  s_nop 0
  s_cmp_ge_u32 s16, 4
  s_cbranch_scc1 b_s1_ok
  s_sleep 1
  s_sub_u32 s62, s62, 1
  s_cbranch_scc0 b_s1
  s_mov_b32 s62, 0
b_s1_ok:
b_s0b:
  ds_read_b32 v18, v14 offset:64
  s_waitcnt lgkmcnt(0)
  v_readfirstlane_b32 s16, v18
  s_nop 0
  s_cmp_ge_u32 s16, 1
  s_cbranch_scc1 b_s0b_ok
  s_sleep 1
  s_sub_u32 s62, s62, 1
  s_cbranch_scc0 b_s0b
  s_mov_b32 s62, 0
b_s0b_ok:
  s_mov_b32 s42, 393216
  buffer_load_dwordx2 v[16:17], v12, s[32:35], s42 offen sc1
  s_xor_b32 s19, s96, 0
  s_lshl2_add_u32 s16, s19, s12
  s_add_u32 s17, s16, s14
  s_and_b32 s17, s17, 7
  s_add_u32 s16, s16, s44
  s_and_b32 s16, s16, 24
  s_or_b32 s18, s16, s17
  s_lshl_b32 s19, s19, 12
  s_add_u32 s19, s19, s40
  s_lshl_b32 s18, s18, 14
  s_add_u32 m0, s19, 0
  s_add_u32 s18, s18, s41
  buffer_load_dwordx4 v8, s[20:23], s18 offen lds
  s_xor_b32 s19, s96, 1
  s_lshl2_add_u32 s16, s19, s12
  s_add_u32 s17, s16, s14
  s_and_b32 s17, s17, 7
  s_add_u32 s16, s16, s44
  s_and_b32 s16, s16, 24
  s_or_b32 s18, s16, s17
  s_lshl_b32 s19, s19, 12
  s_add_u32 s19, s19, s40
  s_lshl_b32 s18, s18, 14
  s_add_u32 m0, s19, 0
  s_add_u32 s18, s18, s41
  buffer_load_dwordx4 v8, s[20:23], s18 offen lds
  s_xor_b32 s19, s96, 2
  s_lshl2_add_u32 s16, s19, s12
  s_add_u32 s17, s16, s14
  s_and_b32 s17, s17, 7
  s_add_u32 s16, s16, s44
  s_and_b32 s16, s16, 24
  s_or_b32 s18, s16, s17
  s_lshl_b32 s19, s19, 12
  s_add_u32 s19, s19, s40
  s_lshl_b32 s18, s18, 14
  s_add_u32 m0, s19, 0
  s_add_u32 s18, s18, s41
  buffer_load_dwordx4 v8, s[20:23], s18 offen lds
  s_xor_b32 s19, s96, 3
  s_lshl2_add_u32 s16, s19, s12
  s_add_u32 s17, s16, s14
  s_and_b32 s17, s17, 7
  s_add_u32 s16, s16, s44
  s_and_b32 s16, s16, 24
  s_or_b32 s18, s16, s17
  s_lshl_b32 s19, s19, 12
  s_add_u32 s19, s19, s40
  s_lshl_b32 s18, s18, 14
  s_add_u32 m0, s19, 0
  s_add_u32 s18, s18, s41
  buffer_load_dwordx4 v8, s[20:23], s18 offen lds
  s_xor_b32 s19, s96, 4
  s_lshl2_add_u32 s16, s19, s12
  s_add_u32 s17, s16, s14
  s_and_b32 s17, s17, 7
  s_add_u32 s16, s16, s44
  s_and_b32 s16, s16, 24
  s_or_b32 s18, s16, s17
  s_lshl_b32 s19, s19, 12
  s_add_u32 s19, s19, s40
  s_lshl_b32 s18, s18, 14
  s_add_u32 m0, s19, 0
  s_add_u32 s18, s18, s41
  buffer_load_dwordx4 v8, s[20:23], s18 offen lds
  s_xor_b32 s19, s96, 5
  s_lshl2_add_u32 s16, s19, s12
  s_add_u32 s17, s16, s14
  s_and_b32 s17, s17, 7
  s_add_u32 s16, s16, s44
  s_and_b32 s16, s16, 24
  s_or_b32 s18, s16, s17
  s_lshl_b32 s19, s19, 12
  s_add_u32 s19, s19, s40
  s_lshl_b32 s18, s18, 14
  s_add_u32 m0, s19, 0
  s_add_u32 s18, s18, s41
  buffer_load_dwordx4 v8, s[20:23], s18 offen lds
  s_xor_b32 s19, s96, 6
  s_lshl2_add_u32 s16, s19, s12
  s_add_u32 s17, s16, s14
  s_and_b32 s17, s17, 7
  s_add_u32 s16, s16, s44
  s_and_b32 s16, s16, 24
  s_or_b32 s18, s16, s17
  s_lshl_b32 s19, s19, 12
  s_add_u32 s19, s19, s40
  s_lshl_b32 s18, s18, 14
  s_add_u32 m0, s19, 0
  s_add_u32 s18, s18, s41
  buffer_load_dwordx4 v8, s[20:23], s18 offen lds
  s_xor_b32 s19, s96, 7
  s_lshl2_add_u32 s16, s19, s12
  s_add_u32 s17, s16, s14
  s_and_b32 s17, s17, 7
  s_add_u32 s16, s16, s44
  s_and_b32 s16, s16, 24
  s_or_b32 s18, s16, s17
  s_lshl_b32 s19, s19, 12
  s_add_u32 s19, s19, s40
  s_lshl_b32 s18, s18, 14
  s_add_u32 m0, s19, 0
  s_add_u32 s18, s18, s41
  buffer_load_dwordx4 v8, s[20:23], s18 offen lds
  s_mov_b32 s28, s4
  s_mov_b32 s29, s5
  s_mov_b32 s30, 0x200000
  s_mov_b32 s31, 0x20000
  buffer_load_dwordx4 v[112:115], v48, s[28:31], s41 offen offset:0
  buffer_load_dwordx4 v[116:119], v48, s[28:31], s41 offen offset:32
  s_add_u32 s28, s10, 0x800000
  s_addc_u32 s29, s11, 0
  s_mov_b32 s30, 0x200000
  s_mov_b32 s31, 0x20000
  s_mov_b32 s20, s54
  s_mov_b32 s21, s55
  s_mov_b32 s22, 0x158000
  s_mov_b32 s23, 0x20000
  s_waitcnt vmcnt(10)
  v_cmp_eq_u64 vcc, s[60:61], v[16:17]
  s_nop 0
  s_cmp_eq_u64 vcc, -1
  s_cbranch_scc1 b_hh_ok
  s_mov_b32 s16, s42
b_hh:
  buffer_load_dwordx2 v[18:19], v12, s[32:35], s16 offen sc1
  s_waitcnt vmcnt(0)
  v_cmp_eq_u64 vcc, s[60:61], v[18:19]
  s_nop 0
  s_cmp_eq_u64 vcc, -1
  s_cbranch_scc1 b_hh_ok
  s_sleep 2
  s_sub_u32 s62, s62, 1
  s_cbranch_scc0 b_hh
  s_mov_b32 s62, 0
b_hh_ok:
  buffer_load_dwordx2 v[16:17], v23, s[36:39], 0 offen sc1
  s_add_u32 s17, s14, 0
  s_and_b32 s17, s17, 7
  s_add_u32 s43, s44, s17
  s_lshl_b32 s43, s43, 16
  buffer_load_dwordx4 v[128:131], v2, s[24:27], s43 offen sc1
  s_add_u32 s17, s14, 1
  s_and_b32 s17, s17, 7
  s_add_u32 s43, s44, s17
  s_lshl_b32 s43, s43, 16
  buffer_load_dwordx4 v[132:135], v2, s[24:27], s43 offen sc1
  s_add_u32 s17, s14, 2
  s_and_b32 s17, s17, 7
  s_add_u32 s43, s44, s17
  s_lshl_b32 s43, s43, 16
  buffer_load_dwordx4 v[136:139], v2, s[24:27], s43 offen sc1
  s_add_u32 s17, s14, 3
  s_and_b32 s17, s17, 7
  s_add_u32 s43, s44, s17
  s_lshl_b32 s43, s43, 16
  buffer_load_dwordx4 v[140:143], v2, s[24:27], s43 offen sc1
  s_add_u32 s17, s14, 4
  s_and_b32 s17, s17, 7
  s_add_u32 s43, s44, s17
  s_lshl_b32 s43, s43, 16
  buffer_load_dwordx4 v[144:147], v2, s[24:27], s43 offen sc1
  s_add_u32 s17, s14, 5
  s_and_b32 s17, s17, 7
  s_add_u32 s43, s44, s17
  s_lshl_b32 s43, s43, 16
  buffer_load_dwordx4 v[148:151], v2, s[24:27], s43 offen sc1
  s_add_u32 s17, s14, 6
  s_and_b32 s17, s17, 7
  s_add_u32 s43, s44, s17
  s_lshl_b32 s43, s43, 16
  buffer_load_dwordx4 v[152:155], v2, s[24:27], s43 offen sc1
  s_add_u32 s17, s14, 7
  s_and_b32 s17, s17, 7
  s_add_u32 s43, s44, s17
  s_lshl_b32 s43, s43, 16
  buffer_load_dwordx4 v[156:159], v2, s[24:27], s43 offen sc1
  s_add_u32 s36, s10, 0x1210000
  s_addc_u32 s37, s11, 0
  s_mov_b32 s38, 0x40000
  s_mov_b32 s39, 0x20000
  s_waitcnt vmcnt(9)
  s_mov_b64 exec, 1
  ds_add_u32 v14, v13 offset:8
  s_mov_b64 exec, -1
b_s1b:
  ds_read_b32 v18, v14 offset:8
  s_waitcnt lgkmcnt(0)
  v_readfirstlane_b32 s16, v18
  s_nop 0
  s_cmp_ge_u32 s16, 8
  s_cbranch_scc1 b_s1b_ok
  s_sleep 1
  s_sub_u32 s62, s62, 1
  s_cbranch_scc0 b_s1b
  s_mov_b32 s62, 0
b_s1b_ok:
  s_waitcnt vmcnt(8)
  s_setprio 2
  v_permlane32_swap_b32 v112, v114
  v_permlane32_swap_b32 v113, v115
  v_permlane32_swap_b32 v116, v118
  v_permlane32_swap_b32 v117, v119
  v_lshlrev_b32 v48, 16, v112
  v_and_b32 v49, 0xffff0000, v112
  v_lshlrev_b32 v50, 16, v113
  v_and_b32 v51, 0xffff0000, v113
  v_lshlrev_b32 v52, 16, v114
  v_and_b32 v53, 0xffff0000, v114
  v_lshlrev_b32 v54, 16, v115
  v_and_b32 v55, 0xffff0000, v115
  v_lshlrev_b32 v56, 16, v116
  v_and_b32 v57, 0xffff0000, v116
  v_lshlrev_b32 v58, 16, v117
  v_and_b32 v59, 0xffff0000, v117
  v_lshlrev_b32 v60, 16, v118
  v_and_b32 v61, 0xffff0000, v118
  v_lshlrev_b32 v62, 16, v119
  v_and_b32 v63, 0xffff0000, v119
  v_mul_f32 v20, v16, v17
  v_fma_f32 v64, v48, v17, -v20
  v_fma_f32 v65, v49, v17, -v20
  v_fma_f32 v66, v50, v17, -v20
  v_fma_f32 v67, v51, v17, -v20
  v_fma_f32 v68, v52, v17, -v20
  v_fma_f32 v69, v53, v17, -v20
  v_fma_f32 v70, v54, v17, -v20
  v_fma_f32 v71, v55, v17, -v20
  v_fma_f32 v72, v56, v17, -v20
  v_fma_f32 v73, v57, v17, -v20
  v_fma_f32 v74, v58, v17, -v20
  v_fma_f32 v75, v59, v17, -v20
  v_fma_f32 v76, v60, v17, -v20
  v_fma_f32 v77, v61, v17, -v20
  v_fma_f32 v78, v62, v17, -v20
  v_fma_f32 v79, v63, v17, -v20
  s_setprio 0
  s_setprio 0
  ds_read_b64_tr_b16 v[24:25], v6 offset:0
  ds_read_b64_tr_b16 v[26:27], v6 offset:512
  s_waitcnt vmcnt(7)
  s_waitcnt lgkmcnt(0)
  ds_read_b64_tr_b16 v[36:37], v6 offset:1024
  ds_read_b64_tr_b16 v[38:39], v6 offset:1536
  v_mfma_f32_32x32x16_bf16 v[64:79], v[24:27], v[128:131], v[64:79]
  s_add_u32 s17, s14, 0
  s_and_b32 s17, s17, 7
  s_add_u32 s43, s45, s17
  s_lshl_b32 s43, s43, 16
  buffer_load_dwordx4 v[128:131], v3, s[24:27], s43 offen sc1
  s_waitcnt vmcnt(7)
  s_waitcnt lgkmcnt(0)
  ds_read_b64_tr_b16 v[24:25], v6 offset:2048
  ds_read_b64_tr_b16 v[26:27], v6 offset:2560
  v_mfma_f32_32x32x16_bf16 v[64:79], v[36:39], v[132:135], v[64:79]
  s_add_u32 s17, s14, 1
  s_and_b32 s17, s17, 7
  s_add_u32 s43, s45, s17
  s_lshl_b32 s43, s43, 16
  buffer_load_dwordx4 v[132:135], v3, s[24:27], s43 offen sc1
  s_xor_b32 s19, s96, 0
  s_lshl2_add_u32 s18, s19, s12
  s_add_u32 s18, s18, s63
  s_and_b32 s18, s18, 31
  s_mul_i32 s18, s18, 44032
  s_add_u32 s18, s18, s48
  s_mul_i32 s19, s19, 12288
  s_add_u32 s19, s19, s49
  s_add_u32 m0, s19, 32768
  s_nop 0
  buffer_load_dwordx4 v9, s[20:23], s18 offen lds
  s_add_u32 m0, s19, 33792
  s_nop 0
  buffer_load_dwordx4 v10, s[20:23], s18 offen lds
  s_add_u32 m0, s19, 34816
  s_nop 0
  buffer_load_dwordx4 v11, s[20:23], s18 offen lds
  s_waitcnt vmcnt(10)
  s_waitcnt lgkmcnt(0)
  ds_read_b64_tr_b16 v[36:37], v6 offset:3072
  ds_read_b64_tr_b16 v[38:39], v6 offset:3584
  v_mfma_f32_32x32x16_bf16 v[64:79], v[24:27], v[136:139], v[64:79]
  s_add_u32 s17, s14, 2
  s_and_b32 s17, s17, 7
  s_add_u32 s43, s45, s17
  s_lshl_b32 s43, s43, 16
  buffer_load_dwordx4 v[136:139], v3, s[24:27], s43 offen sc1
  s_waitcnt vmcnt(10)
  s_waitcnt lgkmcnt(0)
  ds_read_b64_tr_b16 v[24:25], v6 offset:4096
  ds_read_b64_tr_b16 v[26:27], v6 offset:4608
  v_mfma_f32_32x32x16_bf16 v[64:79], v[36:39], v[140:143], v[64:79]
  s_add_u32 s17, s14, 3
  s_and_b32 s17, s17, 7
  s_add_u32 s43, s45, s17
  s_lshl_b32 s43, s43, 16
  buffer_load_dwordx4 v[140:143], v3, s[24:27], s43 offen sc1
  s_waitcnt vmcnt(10)
  s_waitcnt lgkmcnt(0)
  ds_read_b64_tr_b16 v[36:37], v6 offset:5120
  ds_read_b64_tr_b16 v[38:39], v6 offset:5632
  v_mfma_f32_32x32x16_bf16 v[64:79], v[24:27], v[144:147], v[64:79]
  s_add_u32 s17, s14, 4
  s_and_b32 s17, s17, 7
  s_add_u32 s43, s45, s17
  s_lshl_b32 s43, s43, 16
  buffer_load_dwordx4 v[144:147], v3, s[24:27], s43 offen sc1
  s_waitcnt vmcnt(10)
  s_waitcnt lgkmcnt(0)
  ds_read_b64_tr_b16 v[24:25], v6 offset:6144
  ds_read_b64_tr_b16 v[26:27], v6 offset:6656
  v_mfma_f32_32x32x16_bf16 v[64:79], v[36:39], v[148:151], v[64:79]
  s_add_u32 s17, s14, 5
  s_and_b32 s17, s17, 7
  s_add_u32 s43, s45, s17
  s_lshl_b32 s43, s43, 16
  buffer_load_dwordx4 v[148:151], v3, s[24:27], s43 offen sc1
  s_xor_b32 s19, s96, 1
  s_lshl2_add_u32 s18, s19, s12
  s_add_u32 s18, s18, s63
  s_and_b32 s18, s18, 31
  s_mul_i32 s18, s18, 44032
  s_add_u32 s18, s18, s48
  s_mul_i32 s19, s19, 12288
  s_add_u32 s19, s19, s49
  s_add_u32 m0, s19, 32768
  s_nop 0
  buffer_load_dwordx4 v9, s[20:23], s18 offen lds
  s_add_u32 m0, s19, 33792
  s_nop 0
  buffer_load_dwordx4 v10, s[20:23], s18 offen lds
  s_add_u32 m0, s19, 34816
  s_nop 0
  buffer_load_dwordx4 v11, s[20:23], s18 offen lds
  s_waitcnt vmcnt(13)
  s_waitcnt lgkmcnt(0)
  ds_read_b64_tr_b16 v[36:37], v6 offset:7168
  ds_read_b64_tr_b16 v[38:39], v6 offset:7680
  v_mfma_f32_32x32x16_bf16 v[64:79], v[24:27], v[152:155], v[64:79]
  s_add_u32 s17, s14, 6
  s_and_b32 s17, s17, 7
  s_add_u32 s43, s45, s17
  s_lshl_b32 s43, s43, 16
  buffer_load_dwordx4 v[152:155], v3, s[24:27], s43 offen sc1
  s_waitcnt vmcnt(13)
  s_waitcnt lgkmcnt(0)
  ds_read_b64_tr_b16 v[24:25], v6 offset:8192
  ds_read_b64_tr_b16 v[26:27], v6 offset:8704
  v_mfma_f32_32x32x16_bf16 v[64:79], v[36:39], v[156:159], v[64:79]
  s_add_u32 s17, s14, 7
  s_and_b32 s17, s17, 7
  s_add_u32 s43, s45, s17
  s_lshl_b32 s43, s43, 16
  buffer_load_dwordx4 v[156:159], v3, s[24:27], s43 offen sc1
  s_waitcnt vmcnt(13)
  s_waitcnt lgkmcnt(0)
  ds_read_b64_tr_b16 v[36:37], v6 offset:9216
  ds_read_b64_tr_b16 v[38:39], v6 offset:9728
  v_mfma_f32_32x32x16_bf16 v[64:79], v[24:27], v[128:131], v[64:79]
  s_add_u32 s17, s14, 0
  s_and_b32 s17, s17, 7
  s_add_u32 s43, s46, s17
  s_lshl_b32 s43, s43, 16
  buffer_load_dwordx4 v[128:131], v4, s[24:27], s43 offen sc1
  s_waitcnt vmcnt(13)
  s_waitcnt lgkmcnt(0)
  ds_read_b64_tr_b16 v[24:25], v6 offset:10240
  ds_read_b64_tr_b16 v[26:27], v6 offset:10752
  v_mfma_f32_32x32x16_bf16 v[64:79], v[36:39], v[132:135], v[64:79]
  s_add_u32 s17, s14, 1
  s_and_b32 s17, s17, 7
  s_add_u32 s43, s46, s17
  s_lshl_b32 s43, s43, 16
  buffer_load_dwordx4 v[132:135], v4, s[24:27], s43 offen sc1
  s_xor_b32 s19, s96, 2
  s_lshl2_add_u32 s18, s19, s12
  s_add_u32 s18, s18, s63
  s_and_b32 s18, s18, 31
  s_mul_i32 s18, s18, 44032
  s_add_u32 s18, s18, s48
  s_mul_i32 s19, s19, 12288
  s_add_u32 s19, s19, s49
  s_add_u32 m0, s19, 32768
  s_nop 0
  buffer_load_dwordx4 v9, s[20:23], s18 offen lds
  s_add_u32 m0, s19, 33792
  s_nop 0
  buffer_load_dwordx4 v10, s[20:23], s18 offen lds
  s_add_u32 m0, s19, 34816
  s_nop 0
  buffer_load_dwordx4 v11, s[20:23], s18 offen lds
  s_waitcnt vmcnt(13)
  s_waitcnt lgkmcnt(0)
  ds_read_b64_tr_b16 v[36:37], v6 offset:11264
  ds_read_b64_tr_b16 v[38:39], v6 offset:11776
  v_mfma_f32_32x32x16_bf16 v[64:79], v[24:27], v[136:139], v[64:79]
  s_add_u32 s17, s14, 2
  s_and_b32 s17, s17, 7
  s_add_u32 s43, s46, s17
  s_lshl_b32 s43, s43, 16
  buffer_load_dwordx4 v[136:139], v4, s[24:27], s43 offen sc1
  s_waitcnt vmcnt(13)
  s_waitcnt lgkmcnt(0)
  ds_read_b64_tr_b16 v[24:25], v6 offset:12288
  ds_read_b64_tr_b16 v[26:27], v6 offset:12800
  v_mfma_f32_32x32x16_bf16 v[64:79], v[36:39], v[140:143], v[64:79]
  s_add_u32 s17, s14, 3
  s_and_b32 s17, s17, 7
  s_add_u32 s43, s46, s17
  s_lshl_b32 s43, s43, 16
  buffer_load_dwordx4 v[140:143], v4, s[24:27], s43 offen sc1
  s_waitcnt vmcnt(13)
  s_waitcnt lgkmcnt(0)
  ds_read_b64_tr_b16 v[36:37], v6 offset:13312
  ds_read_b64_tr_b16 v[38:39], v6 offset:13824
  v_mfma_f32_32x32x16_bf16 v[64:79], v[24:27], v[144:147], v[64:79]
  s_add_u32 s17, s14, 4
  s_and_b32 s17, s17, 7
  s_add_u32 s43, s46, s17
  s_lshl_b32 s43, s43, 16
  buffer_load_dwordx4 v[144:147], v4, s[24:27], s43 offen sc1
  s_waitcnt vmcnt(13)
  s_waitcnt lgkmcnt(0)
  ds_read_b64_tr_b16 v[24:25], v6 offset:14336
  ds_read_b64_tr_b16 v[26:27], v6 offset:14848
  v_mfma_f32_32x32x16_bf16 v[64:79], v[36:39], v[148:151], v[64:79]
  s_add_u32 s17, s14, 5
  s_and_b32 s17, s17, 7
  s_add_u32 s43, s46, s17
  s_lshl_b32 s43, s43, 16
  buffer_load_dwordx4 v[148:151], v4, s[24:27], s43 offen sc1
  s_xor_b32 s19, s96, 3
  s_lshl2_add_u32 s18, s19, s12
  s_add_u32 s18, s18, s63
  s_and_b32 s18, s18, 31
  s_mul_i32 s18, s18, 44032
  s_add_u32 s18, s18, s48
  s_mul_i32 s19, s19, 12288
  s_add_u32 s19, s19, s49
  s_add_u32 m0, s19, 32768
  s_nop 0
  buffer_load_dwordx4 v9, s[20:23], s18 offen lds
  s_add_u32 m0, s19, 33792
  s_nop 0
  buffer_load_dwordx4 v10, s[20:23], s18 offen lds
  s_add_u32 m0, s19, 34816
  s_nop 0
  buffer_load_dwordx4 v11, s[20:23], s18 offen lds
  s_waitcnt vmcnt(13)
  s_waitcnt lgkmcnt(0)
  ds_read_b64_tr_b16 v[36:37], v6 offset:15360
  ds_read_b64_tr_b16 v[38:39], v6 offset:15872
  v_mfma_f32_32x32x16_bf16 v[64:79], v[24:27], v[152:155], v[64:79]
  s_add_u32 s17, s14, 6
  s_and_b32 s17, s17, 7
  s_add_u32 s43, s46, s17
  s_lshl_b32 s43, s43, 16
  buffer_load_dwordx4 v[152:155], v4, s[24:27], s43 offen sc1
  s_waitcnt vmcnt(13)
  s_waitcnt lgkmcnt(0)
  ds_read_b64_tr_b16 v[24:25], v6 offset:16384
  ds_read_b64_tr_b16 v[26:27], v6 offset:16896
  v_mfma_f32_32x32x16_bf16 v[64:79], v[36:39], v[156:159], v[64:79]
  s_add_u32 s17, s14, 7
  s_and_b32 s17, s17, 7
  s_add_u32 s43, s46, s17
  s_lshl_b32 s43, s43, 16
  buffer_load_dwordx4 v[156:159], v4, s[24:27], s43 offen sc1
  s_waitcnt vmcnt(13)
  s_waitcnt lgkmcnt(0)
  ds_read_b64_tr_b16 v[36:37], v6 offset:17408
  ds_read_b64_tr_b16 v[38:39], v6 offset:17920
  v_mfma_f32_32x32x16_bf16 v[64:79], v[24:27], v[128:131], v[64:79]
  s_add_u32 s17, s14, 0
  s_and_b32 s17, s17, 7
  s_add_u32 s43, s47, s17
  s_lshl_b32 s43, s43, 16
  buffer_load_dwordx4 v[128:131], v5, s[24:27], s43 offen sc1
  s_waitcnt vmcnt(13)
  s_waitcnt lgkmcnt(0)
  ds_read_b64_tr_b16 v[24:25], v6 offset:18432
  ds_read_b64_tr_b16 v[26:27], v6 offset:18944
  v_mfma_f32_32x32x16_bf16 v[64:79], v[36:39], v[132:135], v[64:79]
  s_add_u32 s17, s14, 1
  s_and_b32 s17, s17, 7
  s_add_u32 s43, s47, s17
  s_lshl_b32 s43, s43, 16
  buffer_load_dwordx4 v[132:135], v5, s[24:27], s43 offen sc1
  s_waitcnt vmcnt(10)
  s_waitcnt lgkmcnt(0)
  ds_read_b64_tr_b16 v[36:37], v6 offset:19456
  ds_read_b64_tr_b16 v[38:39], v6 offset:19968
  v_mfma_f32_32x32x16_bf16 v[64:79], v[24:27], v[136:139], v[64:79]
  s_add_u32 s17, s14, 2
  s_and_b32 s17, s17, 7
  s_add_u32 s43, s47, s17
  s_lshl_b32 s43, s43, 16
  buffer_load_dwordx4 v[136:139], v5, s[24:27], s43 offen sc1
  s_waitcnt vmcnt(10)
  s_waitcnt lgkmcnt(0)
  ds_read_b64_tr_b16 v[24:25], v6 offset:20480
  ds_read_b64_tr_b16 v[26:27], v6 offset:20992
  v_mfma_f32_32x32x16_bf16 v[64:79], v[36:39], v[140:143], v[64:79]
  s_add_u32 s17, s14, 3
  s_and_b32 s17, s17, 7
  s_add_u32 s43, s47, s17
  s_lshl_b32 s43, s43, 16
  buffer_load_dwordx4 v[140:143], v5, s[24:27], s43 offen sc1
  s_waitcnt vmcnt(10)
  s_waitcnt lgkmcnt(0)
  ds_read_b64_tr_b16 v[36:37], v6 offset:21504
  ds_read_b64_tr_b16 v[38:39], v6 offset:22016
  v_mfma_f32_32x32x16_bf16 v[64:79], v[24:27], v[144:147], v[64:79]
  s_add_u32 s17, s14, 4
  s_and_b32 s17, s17, 7
  s_add_u32 s43, s47, s17
  s_lshl_b32 s43, s43, 16
  buffer_load_dwordx4 v[144:147], v5, s[24:27], s43 offen sc1
  s_waitcnt vmcnt(10)
  s_waitcnt lgkmcnt(0)
  ds_read_b64_tr_b16 v[24:25], v6 offset:22528
  ds_read_b64_tr_b16 v[26:27], v6 offset:23040
  v_mfma_f32_32x32x16_bf16 v[64:79], v[36:39], v[148:151], v[64:79]
  s_add_u32 s17, s14, 5
  s_and_b32 s17, s17, 7
  s_add_u32 s43, s47, s17
  s_lshl_b32 s43, s43, 16
  buffer_load_dwordx4 v[148:151], v5, s[24:27], s43 offen sc1
  s_waitcnt vmcnt(7)
  s_waitcnt lgkmcnt(0)
  ds_read_b64_tr_b16 v[36:37], v6 offset:23552
  ds_read_b64_tr_b16 v[38:39], v6 offset:24064
  v_mfma_f32_32x32x16_bf16 v[64:79], v[24:27], v[152:155], v[64:79]
  s_add_u32 s17, s14, 6
  s_and_b32 s17, s17, 7
  s_add_u32 s43, s47, s17
  s_lshl_b32 s43, s43, 16
  buffer_load_dwordx4 v[152:155], v5, s[24:27], s43 offen sc1
  s_waitcnt vmcnt(7)
  s_waitcnt lgkmcnt(0)
  ds_read_b64_tr_b16 v[24:25], v6 offset:24576
  ds_read_b64_tr_b16 v[26:27], v6 offset:25088
  v_mfma_f32_32x32x16_bf16 v[64:79], v[36:39], v[156:159], v[64:79]
  s_add_u32 s17, s14, 7
  s_and_b32 s17, s17, 7
  s_add_u32 s43, s47, s17
  s_lshl_b32 s43, s43, 16
  buffer_load_dwordx4 v[156:159], v5, s[24:27], s43 offen sc1
  s_waitcnt vmcnt(7)
  s_waitcnt lgkmcnt(0)
  ds_read_b64_tr_b16 v[36:37], v6 offset:25600
  ds_read_b64_tr_b16 v[38:39], v6 offset:26112
  v_mfma_f32_32x32x16_bf16 v[64:79], v[24:27], v[128:131], v[64:79]
  s_waitcnt vmcnt(6)
  s_waitcnt lgkmcnt(0)
  ds_read_b64_tr_b16 v[24:25], v6 offset:26624
  ds_read_b64_tr_b16 v[26:27], v6 offset:27136
  v_mfma_f32_32x32x16_bf16 v[64:79], v[36:39], v[132:135], v[64:79]
  s_waitcnt vmcnt(5)
  s_waitcnt lgkmcnt(0)
  ds_read_b64_tr_b16 v[36:37], v6 offset:27648
  ds_read_b64_tr_b16 v[38:39], v6 offset:28160
  v_mfma_f32_32x32x16_bf16 v[64:79], v[24:27], v[136:139], v[64:79]
  s_waitcnt vmcnt(4)
  s_waitcnt lgkmcnt(0)
  ds_read_b64_tr_b16 v[24:25], v6 offset:28672
  ds_read_b64_tr_b16 v[26:27], v6 offset:29184
  v_mfma_f32_32x32x16_bf16 v[64:79], v[36:39], v[140:143], v[64:79]
  s_waitcnt vmcnt(3)
  s_waitcnt lgkmcnt(0)
  ds_read_b64_tr_b16 v[36:37], v6 offset:29696
  ds_read_b64_tr_b16 v[38:39], v6 offset:30208
  v_mfma_f32_32x32x16_bf16 v[64:79], v[24:27], v[144:147], v[64:79]
  s_waitcnt vmcnt(2)
  s_waitcnt lgkmcnt(0)
  ds_read_b64_tr_b16 v[24:25], v6 offset:30720
  ds_read_b64_tr_b16 v[26:27], v6 offset:31232
  v_mfma_f32_32x32x16_bf16 v[64:79], v[36:39], v[148:151], v[64:79]
  s_waitcnt vmcnt(1)
  s_waitcnt lgkmcnt(0)
  ds_read_b64_tr_b16 v[36:37], v6 offset:31744
  ds_read_b64_tr_b16 v[38:39], v6 offset:32256
  v_mfma_f32_32x32x16_bf16 v[64:79], v[24:27], v[152:155], v[64:79]
  s_waitcnt vmcnt(0)
  s_waitcnt lgkmcnt(0)
  v_mfma_f32_32x32x16_bf16 v[64:79], v[36:39], v[156:159], v[64:79]
  s_setprio 2
  v_and_b32 v18, 31, v1
  s_lshl_b32 s16, s15, 5
  v_add_u32 v18, s16, v18
  v_lshrrev_b32 v19, 5, v1
  v_lshlrev_b32 v2, 15, v19
  v_lshl_add_u32 v2, v18, 4, v2
  v_lshlrev_b32 v3, 3, v18
  v_lshl_add_u32 v4, v19, 17, v3
  v_lshlrev_b32 v5, 10, v18
  v_lshl_add_u32 v5, v19, 4, v5
  s_nop 0
  v_cvt_pk_bf16_f32 v112, v64, v65
  v_cvt_pk_bf16_f32 v113, v66, v67
  v_cvt_pk_bf16_f32 v114, v68, v69
  v_cvt_pk_bf16_f32 v115, v70, v71
  v_cvt_pk_bf16_f32 v116, v72, v73
  v_cvt_pk_bf16_f32 v117, v74, v75
  v_cvt_pk_bf16_f32 v118, v76, v77
  v_cvt_pk_bf16_f32 v119, v78, v79
  s_lshl_b32 s16, s14, 17
  buffer_store_dwordx4 v[112:115], v2, s[28:31], s16 offen sc1
  s_add_u32 s16, s16, 65536
  buffer_store_dwordx4 v[116:119], v2, s[28:31], s16 offen sc1
  v_add_f32 v16, v64, v65
  v_mul_f32 v17, v64, v64
  v_fmac_f32 v17, v65, v65
  v_add_f32 v16, v16, v66
  v_fmac_f32 v17, v66, v66
  v_add_f32 v16, v16, v67
  v_fmac_f32 v17, v67, v67
  v_add_f32 v16, v16, v68
  v_fmac_f32 v17, v68, v68
  v_add_f32 v16, v16, v69
  v_fmac_f32 v17, v69, v69
  v_add_f32 v16, v16, v70
  v_fmac_f32 v17, v70, v70
  v_add_f32 v16, v16, v71
  v_fmac_f32 v17, v71, v71
  v_add_f32 v16, v16, v72
  v_fmac_f32 v17, v72, v72
  v_add_f32 v16, v16, v73
  v_fmac_f32 v17, v73, v73
  v_add_f32 v16, v16, v74
  v_fmac_f32 v17, v74, v74
  v_add_f32 v16, v16, v75
  v_fmac_f32 v17, v75, v75
  v_add_f32 v16, v16, v76
  v_fmac_f32 v17, v76, v76
  v_add_f32 v16, v16, v77
  v_fmac_f32 v17, v77, v77
  v_add_f32 v16, v16, v78
  v_fmac_f32 v17, v78, v78
  v_add_f32 v16, v16, v79
  v_fmac_f32 v17, v79, v79
  v_mov_b32 v18, v16
  s_nop 1
  v_permlane32_swap_b32 v16, v18
  v_add_f32 v16, v16, v18
  v_mov_b32 v19, v17
  s_nop 1
  v_permlane32_swap_b32 v17, v19
  v_add_f32 v17, v17, v19
  s_lshl_b32 s16, s14, 14
  buffer_store_dwordx2 v[16:17], v3, s[36:39], s16 offen sc1
  v_add_f32 v48, v48, v64
  v_add_f32 v49, v49, v65
  v_add_f32 v50, v50, v66
  v_add_f32 v51, v51, v67
  v_add_f32 v52, v52, v68
  v_add_f32 v53, v53, v69
  v_add_f32 v54, v54, v70
  v_add_f32 v55, v55, v71
  v_add_f32 v56, v56, v72
  v_add_f32 v57, v57, v73
  v_add_f32 v58, v58, v74
  v_add_f32 v59, v59, v75
  v_add_f32 v60, v60, v76
  v_add_f32 v61, v61, v77
  v_add_f32 v62, v62, v78
  v_add_f32 v63, v63, v79
  s_lshl4_add_u32 s16, s15, s14
  s_lshl_b32 s16, s16, 7
  s_add_u32 s16, s16, 0
  v_mov_b32 v18, s60
  v_mov_b32 v19, s61
  v_mov_b32 v20, s60
  v_mov_b32 v21, s61
  v_lshlrev_b32 v22, 4, v1
  s_waitcnt vmcnt(0)
  s_mov_b64 exec, 0xff
  buffer_store_dwordx4 v[18:21], v22, s[32:35], s16 offen sc1
  s_mov_b64 exec, -1
  s_setprio 0
  s_xor_b32 s19, s96, 4
  s_lshl2_add_u32 s18, s19, s12
  s_add_u32 s18, s18, s63
  s_and_b32 s18, s18, 31
  s_mul_i32 s18, s18, 44032
  s_add_u32 s18, s18, s48
  s_mul_i32 s19, s19, 12288
  s_add_u32 s19, s19, s49
  s_add_u32 m0, s19, 32768
  s_nop 0
  buffer_load_dwordx4 v9, s[20:23], s18 offen lds
  s_add_u32 m0, s19, 33792
  s_nop 0
  buffer_load_dwordx4 v10, s[20:23], s18 offen lds
  s_add_u32 m0, s19, 34816
  s_nop 0
  buffer_load_dwordx4 v11, s[20:23], s18 offen lds
  s_xor_b32 s19, s96, 5
  s_lshl2_add_u32 s18, s19, s12
  s_add_u32 s18, s18, s63
  s_and_b32 s18, s18, 31
  s_mul_i32 s18, s18, 44032
  s_add_u32 s18, s18, s48
  s_mul_i32 s19, s19, 12288
  s_add_u32 s19, s19, s49
  s_add_u32 m0, s19, 32768
  s_nop 0
  buffer_load_dwordx4 v9, s[20:23], s18 offen lds
  s_add_u32 m0, s19, 33792
  s_nop 0
  buffer_load_dwordx4 v10, s[20:23], s18 offen lds
  s_add_u32 m0, s19, 34816
  s_nop 0
  buffer_load_dwordx4 v11, s[20:23], s18 offen lds
  s_xor_b32 s19, s96, 6
  s_lshl2_add_u32 s18, s19, s12
  s_add_u32 s18, s18, s63
  s_and_b32 s18, s18, 31
  s_mul_i32 s18, s18, 44032
  s_add_u32 s18, s18, s48
  s_mul_i32 s19, s19, 12288
  s_add_u32 s19, s19, s49
  s_add_u32 m0, s19, 32768
  s_nop 0
  buffer_load_dwordx4 v9, s[20:23], s18 offen lds
  s_add_u32 m0, s19, 33792
  s_nop 0
  buffer_load_dwordx4 v10, s[20:23], s18 offen lds
  s_add_u32 m0, s19, 34816
  s_nop 0
  buffer_load_dwordx4 v11, s[20:23], s18 offen lds
  s_xor_b32 s19, s96, 7
  s_lshl2_add_u32 s18, s19, s12
  s_add_u32 s18, s18, s63
  s_and_b32 s18, s18, 31
  s_mul_i32 s18, s18, 44032
  s_add_u32 s18, s18, s48
  s_mul_i32 s19, s19, 12288
  s_add_u32 s19, s19, s49
  s_add_u32 m0, s19, 32768
  s_nop 0
  buffer_load_dwordx4 v9, s[20:23], s18 offen lds
  s_add_u32 m0, s19, 33792
  s_nop 0
  buffer_load_dwordx4 v10, s[20:23], s18 offen lds
  s_add_u32 m0, s19, 34816
  s_nop 0
  buffer_load_dwordx4 v11, s[20:23], s18 offen lds
  s_setprio 2
  v_lshrrev_b32 v18, 4, v1
  v_xor_b32 v18, v18, v1
  v_and_b32 v18, 1, v18
  v_cmp_eq_u32 vcc, 0, v18
  v_mov_b32 v18, 0x3f803f80
  s_nop 0
  v_cndmask_b32 v112, 0, v18, vcc
  v_cndmask_b32 v113, 0, v18, vcc
  v_cndmask_b32 v114, 0, v18, vcc
  v_cndmask_b32 v115, 0, v18, vcc
  s_xor_b32 s16, s96, 0
  s_mul_i32 s16, s16, 12288
  s_add_u32 s16, s16, s49
  v_add_u32 v22, s16, v7
  ds_read_b64_tr_b16 v[64:65], v22 offset:0
  ds_read_b64_tr_b16 v[66:67], v22 offset:1536
  ds_read_b64_tr_b16 v[68:69], v22 offset:64
  ds_read_b64_tr_b16 v[70:71], v22 offset:1600
  ds_read_b64_tr_b16 v[72:73], v22 offset:128
  ds_read_b64_tr_b16 v[74:75], v22 offset:1664
  s_xor_b32 s16, s96, 1
  s_mul_i32 s16, s16, 12288
  s_add_u32 s16, s16, s49
  v_add_u32 v22, s16, v7
  ds_read_b64_tr_b16 v[76:77], v22 offset:0
  ds_read_b64_tr_b16 v[78:79], v22 offset:1536
  ds_read_b64_tr_b16 v[80:81], v22 offset:64
  ds_read_b64_tr_b16 v[82:83], v22 offset:1600
  ds_read_b64_tr_b16 v[84:85], v22 offset:128
  ds_read_b64_tr_b16 v[86:87], v22 offset:1664
  s_waitcnt lgkmcnt(6)
  v_mfma_f32_16x16x32_bf16 v[116:119], v[112:115], v[64:67], 0
  v_mfma_f32_16x16x32_bf16 v[120:123], v[112:115], v[68:71], 0
  v_mfma_f32_16x16x32_bf16 v[124:127], v[112:115], v[72:75], 0
  s_xor_b32 s16, s96, 2
  s_mul_i32 s16, s16, 12288
  s_add_u32 s16, s16, s49
  v_add_u32 v22, s16, v7
  ds_read_b64_tr_b16 v[88:89], v22 offset:0
  ds_read_b64_tr_b16 v[90:91], v22 offset:1536
  ds_read_b64_tr_b16 v[92:93], v22 offset:64
  ds_read_b64_tr_b16 v[94:95], v22 offset:1600
  ds_read_b64_tr_b16 v[96:97], v22 offset:128
  ds_read_b64_tr_b16 v[98:99], v22 offset:1664
  s_waitcnt lgkmcnt(6)
  v_mfma_f32_16x16x32_bf16 v[116:119], v[112:115], v[76:79], v[116:119]
  v_mfma_f32_16x16x32_bf16 v[120:123], v[112:115], v[80:83], v[120:123]
  v_mfma_f32_16x16x32_bf16 v[124:127], v[112:115], v[84:87], v[124:127]
  s_xor_b32 s16, s96, 3
  s_mul_i32 s16, s16, 12288
  s_add_u32 s16, s16, s49
  v_add_u32 v22, s16, v7
  ds_read_b64_tr_b16 v[100:101], v22 offset:0
  ds_read_b64_tr_b16 v[102:103], v22 offset:1536
  ds_read_b64_tr_b16 v[104:105], v22 offset:64
  ds_read_b64_tr_b16 v[106:107], v22 offset:1600
  ds_read_b64_tr_b16 v[108:109], v22 offset:128
  ds_read_b64_tr_b16 v[110:111], v22 offset:1664
  s_waitcnt lgkmcnt(6)
  v_mfma_f32_16x16x32_bf16 v[116:119], v[112:115], v[88:91], v[116:119]
  v_mfma_f32_16x16x32_bf16 v[120:123], v[112:115], v[92:95], v[120:123]
  v_mfma_f32_16x16x32_bf16 v[124:127], v[112:115], v[96:99], v[124:127]
  s_waitcnt lgkmcnt(0)
  v_mfma_f32_16x16x32_bf16 v[116:119], v[112:115], v[100:103], v[116:119]
  v_mfma_f32_16x16x32_bf16 v[120:123], v[112:115], v[104:107], v[120:123]
  v_mfma_f32_16x16x32_bf16 v[124:127], v[112:115], v[108:111], v[124:127]
  s_waitcnt vmcnt(0)
  s_xor_b32 s16, s96, 4
  s_mul_i32 s16, s16, 12288
  s_add_u32 s16, s16, s49
  v_add_u32 v22, s16, v7
  ds_read_b64_tr_b16 v[64:65], v22 offset:0
  ds_read_b64_tr_b16 v[66:67], v22 offset:1536
  ds_read_b64_tr_b16 v[68:69], v22 offset:64
  ds_read_b64_tr_b16 v[70:71], v22 offset:1600
  ds_read_b64_tr_b16 v[72:73], v22 offset:128
  ds_read_b64_tr_b16 v[74:75], v22 offset:1664
  s_xor_b32 s16, s96, 5
  s_mul_i32 s16, s16, 12288
  s_add_u32 s16, s16, s49
  v_add_u32 v22, s16, v7
  ds_read_b64_tr_b16 v[76:77], v22 offset:0
  ds_read_b64_tr_b16 v[78:79], v22 offset:1536
  ds_read_b64_tr_b16 v[80:81], v22 offset:64
  ds_read_b64_tr_b16 v[82:83], v22 offset:1600
  ds_read_b64_tr_b16 v[84:85], v22 offset:128
  ds_read_b64_tr_b16 v[86:87], v22 offset:1664
  s_waitcnt lgkmcnt(6)
  v_mfma_f32_16x16x32_bf16 v[116:119], v[112:115], v[64:67], v[116:119]
  v_mfma_f32_16x16x32_bf16 v[120:123], v[112:115], v[68:71], v[120:123]
  v_mfma_f32_16x16x32_bf16 v[124:127], v[112:115], v[72:75], v[124:127]
  s_xor_b32 s16, s96, 6
  s_mul_i32 s16, s16, 12288
  s_add_u32 s16, s16, s49
  v_add_u32 v22, s16, v7
  ds_read_b64_tr_b16 v[88:89], v22 offset:0
  ds_read_b64_tr_b16 v[90:91], v22 offset:1536
  ds_read_b64_tr_b16 v[92:93], v22 offset:64
  ds_read_b64_tr_b16 v[94:95], v22 offset:1600
  ds_read_b64_tr_b16 v[96:97], v22 offset:128
  ds_read_b64_tr_b16 v[98:99], v22 offset:1664
  s_waitcnt lgkmcnt(6)
  v_mfma_f32_16x16x32_bf16 v[116:119], v[112:115], v[76:79], v[116:119]
  v_mfma_f32_16x16x32_bf16 v[120:123], v[112:115], v[80:83], v[120:123]
  v_mfma_f32_16x16x32_bf16 v[124:127], v[112:115], v[84:87], v[124:127]
  s_xor_b32 s16, s96, 7
  s_mul_i32 s16, s16, 12288
  s_add_u32 s16, s16, s49
  v_add_u32 v22, s16, v7
  ds_read_b64_tr_b16 v[100:101], v22 offset:0
  ds_read_b64_tr_b16 v[102:103], v22 offset:1536
  ds_read_b64_tr_b16 v[104:105], v22 offset:64
  ds_read_b64_tr_b16 v[106:107], v22 offset:1600
  ds_read_b64_tr_b16 v[108:109], v22 offset:128
  ds_read_b64_tr_b16 v[110:111], v22 offset:1664
  s_waitcnt lgkmcnt(6)
  v_mfma_f32_16x16x32_bf16 v[116:119], v[112:115], v[88:91], v[116:119]
  v_mfma_f32_16x16x32_bf16 v[120:123], v[112:115], v[92:95], v[120:123]
  v_mfma_f32_16x16x32_bf16 v[124:127], v[112:115], v[96:99], v[124:127]
  s_waitcnt lgkmcnt(0)
  v_mfma_f32_16x16x32_bf16 v[116:119], v[112:115], v[100:103], v[116:119]
  v_mfma_f32_16x16x32_bf16 v[120:123], v[112:115], v[104:107], v[120:123]
  v_mfma_f32_16x16x32_bf16 v[124:127], v[112:115], v[108:111], v[124:127]
  v_and_b32 v18, 31, v1
  v_lshlrev_b32 v19, 4, v18
  v_add_u32 v19, 156128, v19
  s_lshl_b32 s16, s12, 9
  v_add_u32 v20, s16, v19
  v_cmp_gt_u32 vcc, 16, v18
  s_nop 1
  v_cndmask_b32 v112, v117, v116, vcc
  v_cndmask_b32 v113, v121, v120, vcc
  v_cndmask_b32 v114, v125, v124, vcc
  ds_write_b128 v20, v[112:115]
  s_waitcnt lgkmcnt(0)
  s_mov_b64 exec, 1
  ds_add_u32 v14, v13 offset:16
  s_mov_b64 exec, -1
  v_mov_b32 v23, v19
  s_add_u32 s24, s10, 0x800000
  s_addc_u32 s25, s11, 0
  s_mov_b32 s26, 0x200000
  s_mov_b32 s27, 0x20000
  s_add_u32 s28, s10, 0xc00000
  s_addc_u32 s29, s11, 0
  s_mov_b32 s30, 0x560000
  s_mov_b32 s31, 0x20000
  s_mov_b32 s20, s56
  s_mov_b32 s21, s57
  s_mov_b32 s22, 0x158000
  s_mov_b32 s23, 0x20000
  s_setprio 0
  s_lshl_b32 s16, s15, 11
  s_add_u32 s16, s16, 0
  v_and_b32 v12, 15, v1
  v_lshlrev_b32 v12, 7, v12
b_h1:
  buffer_load_dwordx2 v[18:19], v12, s[32:35], s16 offen sc1
  s_waitcnt vmcnt(0)
  v_cmp_eq_u64 vcc, s[60:61], v[18:19]
  s_nop 0
  s_cmp_eq_u64 vcc, -1
  s_cbranch_scc1 b_h1_ok
  s_sleep 2
  s_sub_u32 s62, s62, 1
  s_cbranch_scc0 b_h1
  s_mov_b32 s62, 0
b_h1_ok:
  s_mov_b32 s16, 0
  buffer_load_dwordx2 v[24:25], v4, s[36:39], s16 offen sc1
  s_mov_b32 s16, 16384
  buffer_load_dwordx2 v[26:27], v4, s[36:39], s16 offen sc1
  s_mov_b32 s16, 32768
  buffer_load_dwordx2 v[28:29], v4, s[36:39], s16 offen sc1
  s_mov_b32 s16, 49152
  buffer_load_dwordx2 v[30:31], v4, s[36:39], s16 offen sc1
  s_mov_b32 s16, 65536
  buffer_load_dwordx2 v[32:33], v4, s[36:39], s16 offen sc1
  s_mov_b32 s16, 81920
  buffer_load_dwordx2 v[34:35], v4, s[36:39], s16 offen sc1
  s_mov_b32 s16, 98304
  buffer_load_dwordx2 v[36:37], v4, s[36:39], s16 offen sc1
  s_mov_b32 s16, 114688
  buffer_load_dwordx2 v[38:39], v4, s[36:39], s16 offen sc1
  s_mov_b32 s43, s63
  s_lshl_b32 s18, s43, 16
  buffer_load_dwordx4 v[128:131], v2, s[24:27], s18 offen sc1
  s_add_u32 s43, s43, 1
  s_and_b32 s43, s43, 31
  s_lshl_b32 s18, s43, 16
  buffer_load_dwordx4 v[132:135], v2, s[24:27], s18 offen sc1
  s_add_u32 s43, s43, 1
  s_and_b32 s43, s43, 31
  s_lshl_b32 s18, s43, 16
  buffer_load_dwordx4 v[136:139], v2, s[24:27], s18 offen sc1
  s_add_u32 s43, s43, 1
  s_and_b32 s43, s43, 31
  s_lshl_b32 s18, s43, 16
  buffer_load_dwordx4 v[140:143], v2, s[24:27], s18 offen sc1
  s_add_u32 s43, s43, 1
  s_and_b32 s43, s43, 31
  s_lshl_b32 s18, s43, 16
  buffer_load_dwordx4 v[144:147], v2, s[24:27], s18 offen sc1
  s_add_u32 s43, s43, 1
  s_and_b32 s43, s43, 31
  s_lshl_b32 s18, s43, 16
  buffer_load_dwordx4 v[148:151], v2, s[24:27], s18 offen sc1
  s_add_u32 s43, s43, 1
  s_and_b32 s43, s43, 31
  s_lshl_b32 s18, s43, 16
  buffer_load_dwordx4 v[152:155], v2, s[24:27], s18 offen sc1
  s_add_u32 s43, s43, 1
  s_and_b32 s43, s43, 31
  s_lshl_b32 s18, s43, 16
  buffer_load_dwordx4 v[156:159], v2, s[24:27], s18 offen sc1
  s_add_u32 s43, s43, 1
  s_and_b32 s43, s43, 31
  s_setprio 2
b_s3:
  ds_read_b32 v18, v14 offset:16
  s_waitcnt lgkmcnt(0)
  v_readfirstlane_b32 s16, v18
  s_nop 0
  s_cmp_ge_u32 s16, 4
  s_cbranch_scc1 b_s3_ok
  s_sleep 1
  s_sub_u32 s62, s62, 1
  s_cbranch_scc0 b_s3
  s_mov_b32 s62, 0
b_s3_ok:
  ds_read_b128 v[112:115], v23 offset:0
  ds_read_b128 v[116:119], v23 offset:512
  ds_read_b128 v[120:123], v23 offset:1024
  ds_read_b128 v[124:127], v23 offset:1536
  s_waitcnt lgkmcnt(0)
  s_setprio 2
  v_add_f32 v112, v112, v116
  v_add_f32 v120, v120, v124
  v_add_f32 v112, -v112, -v120
  v_add_f32 v113, v113, v117
  v_add_f32 v121, v121, v125
  v_add_f32 v113, -v113, -v121
  v_add_f32 v114, v114, v118
  v_add_f32 v122, v122, v126
  v_add_f32 v114, -v114, -v122
  v_cvt_pk_bf16_f32 v116, v112, v112
  v_and_b32 v117, 0xffff0000, v116
  v_sub_f32 v117, v112, v117
  v_cvt_pk_bf16_f32 v117, v117, 0
  v_cvt_pk_bf16_f32 v118, v113, v113
  v_and_b32 v119, 0xffff0000, v118
  v_sub_f32 v119, v113, v119
  v_cvt_pk_bf16_f32 v119, v119, 0
  v_cvt_pk_bf16_f32 v120, v114, v114
  v_and_b32 v121, 0xffff0000, v120
  v_sub_f32 v121, v114, v121
  v_cvt_pk_bf16_f32 v121, v121, 0
  s_waitcnt vmcnt(8)
  v_add_f32 v24, v24, v26
  v_add_f32 v25, v25, v27
  v_add_f32 v28, v28, v30
  v_add_f32 v29, v29, v31
  v_add_f32 v32, v32, v34
  v_add_f32 v33, v33, v35
  v_add_f32 v36, v36, v38
  v_add_f32 v37, v37, v39
  v_add_f32 v24, v24, v28
  v_add_f32 v32, v32, v36
  v_add_f32 v25, v25, v29
  v_add_f32 v33, v33, v37
  v_add_f32 v16, v24, v32
  v_add_f32 v17, v25, v33
  v_mov_b32 v18, v16
  s_nop 1
  v_permlane32_swap_b32 v16, v18
  v_add_f32 v16, v16, v18
  v_mov_b32 v19, v17
  s_nop 1
  v_permlane32_swap_b32 v17, v19
  v_add_f32 v17, v17, v19
  v_mul_f32 v16, 0x3b000000, v16
  v_mul_f32 v17, 0x3b000000, v17
  v_fma_f32 v17, -v16, v16, v17
  v_max_f32 v17, 0, v17
  v_add_f32 v17, 0x3727c5ac, v17
  v_rsq_f32 v17, v17
  v_cmp_gt_u32 vcc, 32, v1
  s_nop 1
  v_cndmask_b32 v16, 0, v16, vcc
  v_cvt_pk_bf16_f32 v123, v16, v16
  v_and_b32 v18, 0xffff0000, v123
  v_sub_f32 v18, v16, v18
  v_cvt_pk_bf16_f32 v122, v16, v18
  v_and_b32 v123, 0xffff, v123
  s_nop 1
  v_mfma_f32_32x32x8_bf16 v[64:79], v[116:117], v[122:123], 0
  v_mfma_f32_32x32x8_bf16 v[80:95], v[118:119], v[122:123], 0
  v_mfma_f32_32x32x8_bf16 v[96:111], v[120:121], v[122:123], 0
  v_add_u32 v22, 49152, v7
  s_setprio 0
  s_lshr_b32 s19, s14, 1
  s_and_b32 s45, s14, 1
  s_mul_i32 s45, s45, 42
  s_lshr_b32 s46, s12, 1
  s_add_u32 s46, s46, s45
  s_lshl_b32 s46, s46, 14
  s_lshl_b32 s19, s19, 7
  s_add_u32 s46, s46, s19
  s_and_b32 s19, s12, 1
  s_lshl_b32 s19, s19, 13
  s_add_u32 s46, s46, s19
  s_cmp_eq_u32 s14, 15
  s_cbranch_scc0 b_w3_go
  s_xor_b32 s19, s96, 0
  s_lshl_b32 s18, s19, 15
  s_add_u32 s18, s18, s46
  s_lshl_b32 s19, s19, 12
  s_add_u32 m0, s19, s40
  s_nop 0
  buffer_load_dwordx4 v15, s[20:23], s18 offen lds
  s_xor_b32 s19, s96, 1
  s_lshl_b32 s18, s19, 15
  s_add_u32 s18, s18, s46
  s_lshl_b32 s19, s19, 12
  s_add_u32 m0, s19, s40
  s_nop 0
  buffer_load_dwordx4 v15, s[20:23], s18 offen lds
  s_xor_b32 s19, s96, 2
  s_lshl_b32 s18, s19, 15
  s_add_u32 s18, s18, s46
  s_lshl_b32 s19, s19, 12
  s_add_u32 m0, s19, s40
  s_nop 0
  buffer_load_dwordx4 v15, s[20:23], s18 offen lds
  s_xor_b32 s19, s96, 3
  s_lshl_b32 s18, s19, 15
  s_add_u32 s18, s18, s46
  s_lshl_b32 s19, s19, 12
  s_add_u32 m0, s19, s40
  s_nop 0
  buffer_load_dwordx4 v15, s[20:23], s18 offen lds
  s_xor_b32 s19, s96, 4
  s_lshl_b32 s18, s19, 15
  s_add_u32 s18, s18, s46
  s_lshl_b32 s19, s19, 12
  s_add_u32 m0, s19, s40
  s_nop 0
  buffer_load_dwordx4 v15, s[20:23], s18 offen lds
  s_xor_b32 s19, s96, 5
  s_lshl_b32 s18, s19, 15
  s_add_u32 s18, s18, s46
  s_lshl_b32 s19, s19, 12
  s_add_u32 m0, s19, s40
  s_nop 0
  buffer_load_dwordx4 v15, s[20:23], s18 offen lds
  s_xor_b32 s19, s96, 6
  s_lshl_b32 s18, s19, 15
  s_add_u32 s18, s18, s46
  s_lshl_b32 s19, s19, 12
  s_add_u32 m0, s19, s40
  s_nop 0
  buffer_load_dwordx4 v15, s[20:23], s18 offen lds
  s_xor_b32 s19, s96, 7
  s_lshl_b32 s18, s19, 15
  s_add_u32 s18, s18, s46
  s_lshl_b32 s19, s19, 12
  s_add_u32 m0, s19, s40
  s_nop 0
  buffer_load_dwordx4 v15, s[20:23], s18 offen lds
  s_branch b_w3_done
b_w3_go:
  s_setprio 0
  ds_read_b64_tr_b16 v[24:25], v7 offset:0
  ds_read_b64_tr_b16 v[26:27], v7 offset:1536
  ds_read_b64_tr_b16 v[28:29], v7 offset:64
  ds_read_b64_tr_b16 v[30:31], v7 offset:1600
  ds_read_b64_tr_b16 v[32:33], v7 offset:128
  ds_read_b64_tr_b16 v[34:35], v7 offset:1664
  s_waitcnt vmcnt(7)
  s_waitcnt lgkmcnt(0)
  ds_read_b64_tr_b16 v[36:37], v7 offset:3072
  ds_read_b64_tr_b16 v[38:39], v7 offset:4608
  ds_read_b64_tr_b16 v[40:41], v7 offset:3136
  ds_read_b64_tr_b16 v[42:43], v7 offset:4672
  ds_read_b64_tr_b16 v[44:45], v7 offset:3200
  ds_read_b64_tr_b16 v[46:47], v7 offset:4736
  v_mfma_f32_32x32x16_bf16 v[64:79], v[24:27], v[128:131], v[64:79]
  v_mfma_f32_32x32x16_bf16 v[80:95], v[28:31], v[128:131], v[80:95]
  v_mfma_f32_32x32x16_bf16 v[96:111], v[32:35], v[128:131], v[96:111]
  s_lshl_b32 s18, s43, 16
  buffer_load_dwordx4 v[128:131], v2, s[24:27], s18 offen sc1
  s_add_u32 s43, s43, 1
  s_and_b32 s43, s43, 31
  s_waitcnt vmcnt(7)
  s_waitcnt lgkmcnt(0)
  ds_read_b64_tr_b16 v[24:25], v7 offset:6144
  ds_read_b64_tr_b16 v[26:27], v7 offset:7680
  ds_read_b64_tr_b16 v[28:29], v7 offset:6208
  ds_read_b64_tr_b16 v[30:31], v7 offset:7744
  ds_read_b64_tr_b16 v[32:33], v7 offset:6272
  ds_read_b64_tr_b16 v[34:35], v7 offset:7808
  v_mfma_f32_32x32x16_bf16 v[64:79], v[36:39], v[132:135], v[64:79]
  v_mfma_f32_32x32x16_bf16 v[80:95], v[40:43], v[132:135], v[80:95]
  v_mfma_f32_32x32x16_bf16 v[96:111], v[44:47], v[132:135], v[96:111]
  s_lshl_b32 s18, s43, 16
  buffer_load_dwordx4 v[132:135], v2, s[24:27], s18 offen sc1
  s_add_u32 s43, s43, 1
  s_and_b32 s43, s43, 31
  s_waitcnt vmcnt(7)
  s_waitcnt lgkmcnt(0)
  ds_read_b64_tr_b16 v[36:37], v7 offset:9216
  ds_read_b64_tr_b16 v[38:39], v7 offset:10752
  ds_read_b64_tr_b16 v[40:41], v7 offset:9280
  ds_read_b64_tr_b16 v[42:43], v7 offset:10816
  ds_read_b64_tr_b16 v[44:45], v7 offset:9344
  ds_read_b64_tr_b16 v[46:47], v7 offset:10880
  v_mfma_f32_32x32x16_bf16 v[64:79], v[24:27], v[136:139], v[64:79]
  v_mfma_f32_32x32x16_bf16 v[80:95], v[28:31], v[136:139], v[80:95]
  v_mfma_f32_32x32x16_bf16 v[96:111], v[32:35], v[136:139], v[96:111]
  s_lshl_b32 s18, s43, 16
  buffer_load_dwordx4 v[136:139], v2, s[24:27], s18 offen sc1
  s_add_u32 s43, s43, 1
  s_and_b32 s43, s43, 31
  s_waitcnt vmcnt(7)
  s_waitcnt lgkmcnt(0)
  ds_read_b64_tr_b16 v[24:25], v7 offset:12288
  ds_read_b64_tr_b16 v[26:27], v7 offset:13824
  ds_read_b64_tr_b16 v[28:29], v7 offset:12352
  ds_read_b64_tr_b16 v[30:31], v7 offset:13888
  ds_read_b64_tr_b16 v[32:33], v7 offset:12416
  ds_read_b64_tr_b16 v[34:35], v7 offset:13952
  v_mfma_f32_32x32x16_bf16 v[64:79], v[36:39], v[140:143], v[64:79]
  v_mfma_f32_32x32x16_bf16 v[80:95], v[40:43], v[140:143], v[80:95]
  v_mfma_f32_32x32x16_bf16 v[96:111], v[44:47], v[140:143], v[96:111]
  s_lshl_b32 s18, s43, 16
  buffer_load_dwordx4 v[140:143], v2, s[24:27], s18 offen sc1
  s_add_u32 s43, s43, 1
  s_and_b32 s43, s43, 31
  s_waitcnt vmcnt(7)
  s_waitcnt lgkmcnt(0)
  ds_read_b64_tr_b16 v[36:37], v7 offset:15360
  ds_read_b64_tr_b16 v[38:39], v7 offset:16896
  ds_read_b64_tr_b16 v[40:41], v7 offset:15424
  ds_read_b64_tr_b16 v[42:43], v7 offset:16960
  ds_read_b64_tr_b16 v[44:45], v7 offset:15488
  ds_read_b64_tr_b16 v[46:47], v7 offset:17024
  v_mfma_f32_32x32x16_bf16 v[64:79], v[24:27], v[144:147], v[64:79]
  v_mfma_f32_32x32x16_bf16 v[80:95], v[28:31], v[144:147], v[80:95]
  v_mfma_f32_32x32x16_bf16 v[96:111], v[32:35], v[144:147], v[96:111]
  s_lshl_b32 s18, s43, 16
  buffer_load_dwordx4 v[144:147], v2, s[24:27], s18 offen sc1
  s_add_u32 s43, s43, 1
  s_and_b32 s43, s43, 31
  s_waitcnt vmcnt(7)
  s_waitcnt lgkmcnt(0)
  ds_read_b64_tr_b16 v[24:25], v7 offset:18432
  ds_read_b64_tr_b16 v[26:27], v7 offset:19968
  ds_read_b64_tr_b16 v[28:29], v7 offset:18496
  ds_read_b64_tr_b16 v[30:31], v7 offset:20032
  ds_read_b64_tr_b16 v[32:33], v7 offset:18560
  ds_read_b64_tr_b16 v[34:35], v7 offset:20096
  v_mfma_f32_32x32x16_bf16 v[64:79], v[36:39], v[148:151], v[64:79]
  v_mfma_f32_32x32x16_bf16 v[80:95], v[40:43], v[148:151], v[80:95]
  v_mfma_f32_32x32x16_bf16 v[96:111], v[44:47], v[148:151], v[96:111]
  s_lshl_b32 s18, s43, 16
  buffer_load_dwordx4 v[148:151], v2, s[24:27], s18 offen sc1
  s_add_u32 s43, s43, 1
  s_and_b32 s43, s43, 31
  s_waitcnt vmcnt(7)
  s_waitcnt lgkmcnt(0)
  ds_read_b64_tr_b16 v[36:37], v7 offset:21504
  ds_read_b64_tr_b16 v[38:39], v7 offset:23040
  ds_read_b64_tr_b16 v[40:41], v7 offset:21568
  ds_read_b64_tr_b16 v[42:43], v7 offset:23104
  ds_read_b64_tr_b16 v[44:45], v7 offset:21632
  ds_read_b64_tr_b16 v[46:47], v7 offset:23168
  v_mfma_f32_32x32x16_bf16 v[64:79], v[24:27], v[152:155], v[64:79]
  v_mfma_f32_32x32x16_bf16 v[80:95], v[28:31], v[152:155], v[80:95]
  v_mfma_f32_32x32x16_bf16 v[96:111], v[32:35], v[152:155], v[96:111]
  s_lshl_b32 s18, s43, 16
  buffer_load_dwordx4 v[152:155], v2, s[24:27], s18 offen sc1
  s_add_u32 s43, s43, 1
  s_and_b32 s43, s43, 31
  s_waitcnt vmcnt(7)
  s_waitcnt lgkmcnt(0)
  ds_read_b64_tr_b16 v[24:25], v7 offset:24576
  ds_read_b64_tr_b16 v[26:27], v7 offset:26112
  ds_read_b64_tr_b16 v[28:29], v7 offset:24640
  ds_read_b64_tr_b16 v[30:31], v7 offset:26176
  ds_read_b64_tr_b16 v[32:33], v7 offset:24704
  ds_read_b64_tr_b16 v[34:35], v7 offset:26240
  v_mfma_f32_32x32x16_bf16 v[64:79], v[36:39], v[156:159], v[64:79]
  v_mfma_f32_32x32x16_bf16 v[80:95], v[40:43], v[156:159], v[80:95]
  v_mfma_f32_32x32x16_bf16 v[96:111], v[44:47], v[156:159], v[96:111]
  s_lshl_b32 s18, s43, 16
  buffer_load_dwordx4 v[156:159], v2, s[24:27], s18 offen sc1
  s_add_u32 s43, s43, 1
  s_and_b32 s43, s43, 31
  s_waitcnt vmcnt(7)
  s_waitcnt lgkmcnt(0)
  ds_read_b64_tr_b16 v[36:37], v7 offset:27648
  ds_read_b64_tr_b16 v[38:39], v7 offset:29184
  ds_read_b64_tr_b16 v[40:41], v7 offset:27712
  ds_read_b64_tr_b16 v[42:43], v7 offset:29248
  ds_read_b64_tr_b16 v[44:45], v7 offset:27776
  ds_read_b64_tr_b16 v[46:47], v7 offset:29312
  v_mfma_f32_32x32x16_bf16 v[64:79], v[24:27], v[128:131], v[64:79]
  v_mfma_f32_32x32x16_bf16 v[80:95], v[28:31], v[128:131], v[80:95]
  v_mfma_f32_32x32x16_bf16 v[96:111], v[32:35], v[128:131], v[96:111]
  s_lshl_b32 s18, s43, 16
  buffer_load_dwordx4 v[128:131], v2, s[24:27], s18 offen sc1
  s_add_u32 s43, s43, 1
  s_and_b32 s43, s43, 31
  s_waitcnt vmcnt(7)
  s_waitcnt lgkmcnt(0)
  ds_read_b64_tr_b16 v[24:25], v7 offset:30720
  ds_read_b64_tr_b16 v[26:27], v7 offset:32256
  ds_read_b64_tr_b16 v[28:29], v7 offset:30784
  ds_read_b64_tr_b16 v[30:31], v7 offset:32320
  ds_read_b64_tr_b16 v[32:33], v7 offset:30848
  ds_read_b64_tr_b16 v[34:35], v7 offset:32384
  v_mfma_f32_32x32x16_bf16 v[64:79], v[36:39], v[132:135], v[64:79]
  v_mfma_f32_32x32x16_bf16 v[80:95], v[40:43], v[132:135], v[80:95]
  v_mfma_f32_32x32x16_bf16 v[96:111], v[44:47], v[132:135], v[96:111]
  s_lshl_b32 s18, s43, 16
  buffer_load_dwordx4 v[132:135], v2, s[24:27], s18 offen sc1
  s_add_u32 s43, s43, 1
  s_and_b32 s43, s43, 31
  s_waitcnt vmcnt(7)
  s_waitcnt lgkmcnt(0)
  ds_read_b64_tr_b16 v[36:37], v7 offset:33792
  ds_read_b64_tr_b16 v[38:39], v7 offset:35328
  ds_read_b64_tr_b16 v[40:41], v7 offset:33856
  ds_read_b64_tr_b16 v[42:43], v7 offset:35392
  ds_read_b64_tr_b16 v[44:45], v7 offset:33920
  ds_read_b64_tr_b16 v[46:47], v7 offset:35456
  v_mfma_f32_32x32x16_bf16 v[64:79], v[24:27], v[136:139], v[64:79]
  v_mfma_f32_32x32x16_bf16 v[80:95], v[28:31], v[136:139], v[80:95]
  v_mfma_f32_32x32x16_bf16 v[96:111], v[32:35], v[136:139], v[96:111]
  s_lshl_b32 s18, s43, 16
  buffer_load_dwordx4 v[136:139], v2, s[24:27], s18 offen sc1
  s_add_u32 s43, s43, 1
  s_and_b32 s43, s43, 31
  s_waitcnt vmcnt(7)
  s_waitcnt lgkmcnt(0)
  ds_read_b64_tr_b16 v[24:25], v7 offset:36864
  ds_read_b64_tr_b16 v[26:27], v7 offset:38400
  ds_read_b64_tr_b16 v[28:29], v7 offset:36928
  ds_read_b64_tr_b16 v[30:31], v7 offset:38464
  ds_read_b64_tr_b16 v[32:33], v7 offset:36992
  ds_read_b64_tr_b16 v[34:35], v7 offset:38528
  v_mfma_f32_32x32x16_bf16 v[64:79], v[36:39], v[140:143], v[64:79]
  v_mfma_f32_32x32x16_bf16 v[80:95], v[40:43], v[140:143], v[80:95]
  v_mfma_f32_32x32x16_bf16 v[96:111], v[44:47], v[140:143], v[96:111]
  s_lshl_b32 s18, s43, 16
  buffer_load_dwordx4 v[140:143], v2, s[24:27], s18 offen sc1
  s_add_u32 s43, s43, 1
  s_and_b32 s43, s43, 31
  s_waitcnt vmcnt(7)
  s_waitcnt lgkmcnt(0)
  ds_read_b64_tr_b16 v[36:37], v7 offset:39936
  ds_read_b64_tr_b16 v[38:39], v7 offset:41472
  ds_read_b64_tr_b16 v[40:41], v7 offset:40000
  ds_read_b64_tr_b16 v[42:43], v7 offset:41536
  ds_read_b64_tr_b16 v[44:45], v7 offset:40064
  ds_read_b64_tr_b16 v[46:47], v7 offset:41600
  v_mfma_f32_32x32x16_bf16 v[64:79], v[24:27], v[144:147], v[64:79]
  v_mfma_f32_32x32x16_bf16 v[80:95], v[28:31], v[144:147], v[80:95]
  v_mfma_f32_32x32x16_bf16 v[96:111], v[32:35], v[144:147], v[96:111]
  s_lshl_b32 s18, s43, 16
  buffer_load_dwordx4 v[144:147], v2, s[24:27], s18 offen sc1
  s_add_u32 s43, s43, 1
  s_and_b32 s43, s43, 31
  s_waitcnt vmcnt(7)
  s_waitcnt lgkmcnt(0)
  ds_read_b64_tr_b16 v[24:25], v7 offset:43008
  ds_read_b64_tr_b16 v[26:27], v7 offset:44544
  ds_read_b64_tr_b16 v[28:29], v7 offset:43072
  ds_read_b64_tr_b16 v[30:31], v7 offset:44608
  ds_read_b64_tr_b16 v[32:33], v7 offset:43136
  ds_read_b64_tr_b16 v[34:35], v7 offset:44672
  v_mfma_f32_32x32x16_bf16 v[64:79], v[36:39], v[148:151], v[64:79]
  v_mfma_f32_32x32x16_bf16 v[80:95], v[40:43], v[148:151], v[80:95]
  v_mfma_f32_32x32x16_bf16 v[96:111], v[44:47], v[148:151], v[96:111]
  s_lshl_b32 s18, s43, 16
  buffer_load_dwordx4 v[148:151], v2, s[24:27], s18 offen sc1
  s_add_u32 s43, s43, 1
  s_and_b32 s43, s43, 31
  s_waitcnt vmcnt(7)
  s_waitcnt lgkmcnt(0)
  ds_read_b64_tr_b16 v[36:37], v7 offset:46080
  ds_read_b64_tr_b16 v[38:39], v7 offset:47616
  ds_read_b64_tr_b16 v[40:41], v7 offset:46144
  ds_read_b64_tr_b16 v[42:43], v7 offset:47680
  ds_read_b64_tr_b16 v[44:45], v7 offset:46208
  ds_read_b64_tr_b16 v[46:47], v7 offset:47744
  v_mfma_f32_32x32x16_bf16 v[64:79], v[24:27], v[152:155], v[64:79]
  v_mfma_f32_32x32x16_bf16 v[80:95], v[28:31], v[152:155], v[80:95]
  v_mfma_f32_32x32x16_bf16 v[96:111], v[32:35], v[152:155], v[96:111]
  s_lshl_b32 s18, s43, 16
  buffer_load_dwordx4 v[152:155], v2, s[24:27], s18 offen sc1
  s_add_u32 s43, s43, 1
  s_and_b32 s43, s43, 31
  s_xor_b32 s19, s96, 0
  s_lshl_b32 s18, s19, 15
  s_add_u32 s18, s18, s46
  s_lshl_b32 s19, s19, 12
  s_add_u32 m0, s19, s40
  s_nop 0
  buffer_load_dwordx4 v15, s[20:23], s18 offen lds
  s_waitcnt vmcnt(8)
  s_waitcnt lgkmcnt(0)
  ds_read_b64_tr_b16 v[24:25], v22 offset:0
  ds_read_b64_tr_b16 v[26:27], v22 offset:1536
  ds_read_b64_tr_b16 v[28:29], v22 offset:64
  ds_read_b64_tr_b16 v[30:31], v22 offset:1600
  ds_read_b64_tr_b16 v[32:33], v22 offset:128
  ds_read_b64_tr_b16 v[34:35], v22 offset:1664
  v_mfma_f32_32x32x16_bf16 v[64:79], v[36:39], v[156:159], v[64:79]
  v_mfma_f32_32x32x16_bf16 v[80:95], v[40:43], v[156:159], v[80:95]
  v_mfma_f32_32x32x16_bf16 v[96:111], v[44:47], v[156:159], v[96:111]
  s_lshl_b32 s18, s43, 16
  buffer_load_dwordx4 v[156:159], v2, s[24:27], s18 offen sc1
  s_add_u32 s43, s43, 1
  s_and_b32 s43, s43, 31
  s_waitcnt vmcnt(8)
  s_waitcnt lgkmcnt(0)
  ds_read_b64_tr_b16 v[36:37], v22 offset:3072
  ds_read_b64_tr_b16 v[38:39], v22 offset:4608
  ds_read_b64_tr_b16 v[40:41], v22 offset:3136
  ds_read_b64_tr_b16 v[42:43], v22 offset:4672
  ds_read_b64_tr_b16 v[44:45], v22 offset:3200
  ds_read_b64_tr_b16 v[46:47], v22 offset:4736
  v_mfma_f32_32x32x16_bf16 v[64:79], v[24:27], v[128:131], v[64:79]
  v_mfma_f32_32x32x16_bf16 v[80:95], v[28:31], v[128:131], v[80:95]
  v_mfma_f32_32x32x16_bf16 v[96:111], v[32:35], v[128:131], v[96:111]
  s_lshl_b32 s18, s43, 16
  buffer_load_dwordx4 v[128:131], v2, s[24:27], s18 offen sc1
  s_add_u32 s43, s43, 1
  s_and_b32 s43, s43, 31
  s_xor_b32 s19, s96, 1
  s_lshl_b32 s18, s19, 15
  s_add_u32 s18, s18, s46
  s_lshl_b32 s19, s19, 12
  s_add_u32 m0, s19, s40
  s_nop 0
  buffer_load_dwordx4 v15, s[20:23], s18 offen lds
  s_waitcnt vmcnt(9)
  s_waitcnt lgkmcnt(0)
  ds_read_b64_tr_b16 v[24:25], v22 offset:6144
  ds_read_b64_tr_b16 v[26:27], v22 offset:7680
  ds_read_b64_tr_b16 v[28:29], v22 offset:6208
  ds_read_b64_tr_b16 v[30:31], v22 offset:7744
  ds_read_b64_tr_b16 v[32:33], v22 offset:6272
  ds_read_b64_tr_b16 v[34:35], v22 offset:7808
  v_mfma_f32_32x32x16_bf16 v[64:79], v[36:39], v[132:135], v[64:79]
  v_mfma_f32_32x32x16_bf16 v[80:95], v[40:43], v[132:135], v[80:95]
  v_mfma_f32_32x32x16_bf16 v[96:111], v[44:47], v[132:135], v[96:111]
  s_lshl_b32 s18, s43, 16
  buffer_load_dwordx4 v[132:135], v2, s[24:27], s18 offen sc1
  s_add_u32 s43, s43, 1
  s_and_b32 s43, s43, 31
  s_waitcnt vmcnt(9)
  s_waitcnt lgkmcnt(0)
  ds_read_b64_tr_b16 v[36:37], v22 offset:9216
  ds_read_b64_tr_b16 v[38:39], v22 offset:10752
  ds_read_b64_tr_b16 v[40:41], v22 offset:9280
  ds_read_b64_tr_b16 v[42:43], v22 offset:10816
  ds_read_b64_tr_b16 v[44:45], v22 offset:9344
  ds_read_b64_tr_b16 v[46:47], v22 offset:10880
  v_mfma_f32_32x32x16_bf16 v[64:79], v[24:27], v[136:139], v[64:79]
  v_mfma_f32_32x32x16_bf16 v[80:95], v[28:31], v[136:139], v[80:95]
  v_mfma_f32_32x32x16_bf16 v[96:111], v[32:35], v[136:139], v[96:111]
  s_lshl_b32 s18, s43, 16
  buffer_load_dwordx4 v[136:139], v2, s[24:27], s18 offen sc1
  s_add_u32 s43, s43, 1
  s_and_b32 s43, s43, 31
  s_xor_b32 s19, s96, 2
  s_lshl_b32 s18, s19, 15
  s_add_u32 s18, s18, s46
  s_lshl_b32 s19, s19, 12
  s_add_u32 m0, s19, s40
  s_nop 0
  buffer_load_dwordx4 v15, s[20:23], s18 offen lds
  s_waitcnt vmcnt(10)
  s_waitcnt lgkmcnt(0)
  ds_read_b64_tr_b16 v[24:25], v22 offset:12288
  ds_read_b64_tr_b16 v[26:27], v22 offset:13824
  ds_read_b64_tr_b16 v[28:29], v22 offset:12352
  ds_read_b64_tr_b16 v[30:31], v22 offset:13888
  ds_read_b64_tr_b16 v[32:33], v22 offset:12416
  ds_read_b64_tr_b16 v[34:35], v22 offset:13952
  v_mfma_f32_32x32x16_bf16 v[64:79], v[36:39], v[140:143], v[64:79]
  v_mfma_f32_32x32x16_bf16 v[80:95], v[40:43], v[140:143], v[80:95]
  v_mfma_f32_32x32x16_bf16 v[96:111], v[44:47], v[140:143], v[96:111]
  s_lshl_b32 s18, s43, 16
  buffer_load_dwordx4 v[140:143], v2, s[24:27], s18 offen sc1
  s_add_u32 s43, s43, 1
  s_and_b32 s43, s43, 31
  s_waitcnt vmcnt(10)
  s_waitcnt lgkmcnt(0)
  ds_read_b64_tr_b16 v[36:37], v22 offset:15360
  ds_read_b64_tr_b16 v[38:39], v22 offset:16896
  ds_read_b64_tr_b16 v[40:41], v22 offset:15424
  ds_read_b64_tr_b16 v[42:43], v22 offset:16960
  ds_read_b64_tr_b16 v[44:45], v22 offset:15488
  ds_read_b64_tr_b16 v[46:47], v22 offset:17024
  v_mfma_f32_32x32x16_bf16 v[64:79], v[24:27], v[144:147], v[64:79]
  v_mfma_f32_32x32x16_bf16 v[80:95], v[28:31], v[144:147], v[80:95]
  v_mfma_f32_32x32x16_bf16 v[96:111], v[32:35], v[144:147], v[96:111]
  s_lshl_b32 s18, s43, 16
  buffer_load_dwordx4 v[144:147], v2, s[24:27], s18 offen sc1
  s_add_u32 s43, s43, 1
  s_and_b32 s43, s43, 31
  s_xor_b32 s19, s96, 3
  s_lshl_b32 s18, s19, 15
  s_add_u32 s18, s18, s46
  s_lshl_b32 s19, s19, 12
  s_add_u32 m0, s19, s40
  s_nop 0
  buffer_load_dwordx4 v15, s[20:23], s18 offen lds
  s_waitcnt vmcnt(11)
  s_waitcnt lgkmcnt(0)
  ds_read_b64_tr_b16 v[24:25], v22 offset:18432
  ds_read_b64_tr_b16 v[26:27], v22 offset:19968
  ds_read_b64_tr_b16 v[28:29], v22 offset:18496
  ds_read_b64_tr_b16 v[30:31], v22 offset:20032
  ds_read_b64_tr_b16 v[32:33], v22 offset:18560
  ds_read_b64_tr_b16 v[34:35], v22 offset:20096
  v_mfma_f32_32x32x16_bf16 v[64:79], v[36:39], v[148:151], v[64:79]
  v_mfma_f32_32x32x16_bf16 v[80:95], v[40:43], v[148:151], v[80:95]
  v_mfma_f32_32x32x16_bf16 v[96:111], v[44:47], v[148:151], v[96:111]
  s_lshl_b32 s18, s43, 16
  buffer_load_dwordx4 v[148:151], v2, s[24:27], s18 offen sc1
  s_add_u32 s43, s43, 1
  s_and_b32 s43, s43, 31
  s_waitcnt vmcnt(11)
  s_waitcnt lgkmcnt(0)
  ds_read_b64_tr_b16 v[36:37], v22 offset:21504
  ds_read_b64_tr_b16 v[38:39], v22 offset:23040
  ds_read_b64_tr_b16 v[40:41], v22 offset:21568
  ds_read_b64_tr_b16 v[42:43], v22 offset:23104
  ds_read_b64_tr_b16 v[44:45], v22 offset:21632
  ds_read_b64_tr_b16 v[46:47], v22 offset:23168
  v_mfma_f32_32x32x16_bf16 v[64:79], v[24:27], v[152:155], v[64:79]
  v_mfma_f32_32x32x16_bf16 v[80:95], v[28:31], v[152:155], v[80:95]
  v_mfma_f32_32x32x16_bf16 v[96:111], v[32:35], v[152:155], v[96:111]
  s_lshl_b32 s18, s43, 16
  buffer_load_dwordx4 v[152:155], v2, s[24:27], s18 offen sc1
  s_add_u32 s43, s43, 1
  s_and_b32 s43, s43, 31
  s_xor_b32 s19, s96, 4
  s_lshl_b32 s18, s19, 15
  s_add_u32 s18, s18, s46
  s_lshl_b32 s19, s19, 12
  s_add_u32 m0, s19, s40
  s_nop 0
  buffer_load_dwordx4 v15, s[20:23], s18 offen lds
  s_waitcnt vmcnt(11)
  s_waitcnt lgkmcnt(0)
  ds_read_b64_tr_b16 v[24:25], v22 offset:24576
  ds_read_b64_tr_b16 v[26:27], v22 offset:26112
  ds_read_b64_tr_b16 v[28:29], v22 offset:24640
  ds_read_b64_tr_b16 v[30:31], v22 offset:26176
  ds_read_b64_tr_b16 v[32:33], v22 offset:24704
  ds_read_b64_tr_b16 v[34:35], v22 offset:26240
  v_mfma_f32_32x32x16_bf16 v[64:79], v[36:39], v[156:159], v[64:79]
  v_mfma_f32_32x32x16_bf16 v[80:95], v[40:43], v[156:159], v[80:95]
  v_mfma_f32_32x32x16_bf16 v[96:111], v[44:47], v[156:159], v[96:111]
  s_lshl_b32 s18, s43, 16
  buffer_load_dwordx4 v[156:159], v2, s[24:27], s18 offen sc1
  s_add_u32 s43, s43, 1
  s_and_b32 s43, s43, 31
  s_waitcnt vmcnt(11)
  s_waitcnt lgkmcnt(0)
  ds_read_b64_tr_b16 v[36:37], v22 offset:27648
  ds_read_b64_tr_b16 v[38:39], v22 offset:29184
  ds_read_b64_tr_b16 v[40:41], v22 offset:27712
  ds_read_b64_tr_b16 v[42:43], v22 offset:29248
  ds_read_b64_tr_b16 v[44:45], v22 offset:27776
  ds_read_b64_tr_b16 v[46:47], v22 offset:29312
  v_mfma_f32_32x32x16_bf16 v[64:79], v[24:27], v[128:131], v[64:79]
  v_mfma_f32_32x32x16_bf16 v[80:95], v[28:31], v[128:131], v[80:95]
  v_mfma_f32_32x32x16_bf16 v[96:111], v[32:35], v[128:131], v[96:111]
  s_xor_b32 s19, s96, 5
  s_lshl_b32 s18, s19, 15
  s_add_u32 s18, s18, s46
  s_lshl_b32 s19, s19, 12
  s_add_u32 m0, s19, s40
  s_nop 0
  buffer_load_dwordx4 v15, s[20:23], s18 offen lds
  s_waitcnt vmcnt(10)
  s_waitcnt lgkmcnt(0)
  ds_read_b64_tr_b16 v[24:25], v22 offset:30720
  ds_read_b64_tr_b16 v[26:27], v22 offset:32256
  ds_read_b64_tr_b16 v[28:29], v22 offset:30784
  ds_read_b64_tr_b16 v[30:31], v22 offset:32320
  ds_read_b64_tr_b16 v[32:33], v22 offset:30848
  ds_read_b64_tr_b16 v[34:35], v22 offset:32384
  v_mfma_f32_32x32x16_bf16 v[64:79], v[36:39], v[132:135], v[64:79]
  v_mfma_f32_32x32x16_bf16 v[80:95], v[40:43], v[132:135], v[80:95]
  v_mfma_f32_32x32x16_bf16 v[96:111], v[44:47], v[132:135], v[96:111]
  s_waitcnt vmcnt(9)
  s_waitcnt lgkmcnt(0)
  ds_read_b64_tr_b16 v[36:37], v22 offset:33792
  ds_read_b64_tr_b16 v[38:39], v22 offset:35328
  ds_read_b64_tr_b16 v[40:41], v22 offset:33856
  ds_read_b64_tr_b16 v[42:43], v22 offset:35392
  ds_read_b64_tr_b16 v[44:45], v22 offset:33920
  ds_read_b64_tr_b16 v[46:47], v22 offset:35456
  v_mfma_f32_32x32x16_bf16 v[64:79], v[24:27], v[136:139], v[64:79]
  v_mfma_f32_32x32x16_bf16 v[80:95], v[28:31], v[136:139], v[80:95]
  v_mfma_f32_32x32x16_bf16 v[96:111], v[32:35], v[136:139], v[96:111]
  s_xor_b32 s19, s96, 6
  s_lshl_b32 s18, s19, 15
  s_add_u32 s18, s18, s46
  s_lshl_b32 s19, s19, 12
  s_add_u32 m0, s19, s40
  s_nop 0
  buffer_load_dwordx4 v15, s[20:23], s18 offen lds
  s_waitcnt vmcnt(8)
  s_waitcnt lgkmcnt(0)
  ds_read_b64_tr_b16 v[24:25], v22 offset:36864
  ds_read_b64_tr_b16 v[26:27], v22 offset:38400
  ds_read_b64_tr_b16 v[28:29], v22 offset:36928
  ds_read_b64_tr_b16 v[30:31], v22 offset:38464
  ds_read_b64_tr_b16 v[32:33], v22 offset:36992
  ds_read_b64_tr_b16 v[34:35], v22 offset:38528
  v_mfma_f32_32x32x16_bf16 v[64:79], v[36:39], v[140:143], v[64:79]
  v_mfma_f32_32x32x16_bf16 v[80:95], v[40:43], v[140:143], v[80:95]
  v_mfma_f32_32x32x16_bf16 v[96:111], v[44:47], v[140:143], v[96:111]
  s_waitcnt vmcnt(7)
  s_waitcnt lgkmcnt(0)
  ds_read_b64_tr_b16 v[36:37], v22 offset:39936
  ds_read_b64_tr_b16 v[38:39], v22 offset:41472
  ds_read_b64_tr_b16 v[40:41], v22 offset:40000
  ds_read_b64_tr_b16 v[42:43], v22 offset:41536
  ds_read_b64_tr_b16 v[44:45], v22 offset:40064
  ds_read_b64_tr_b16 v[46:47], v22 offset:41600
  v_mfma_f32_32x32x16_bf16 v[64:79], v[24:27], v[144:147], v[64:79]
  v_mfma_f32_32x32x16_bf16 v[80:95], v[28:31], v[144:147], v[80:95]
  v_mfma_f32_32x32x16_bf16 v[96:111], v[32:35], v[144:147], v[96:111]
  s_xor_b32 s19, s96, 7
  s_lshl_b32 s18, s19, 15
  s_add_u32 s18, s18, s46
  s_lshl_b32 s19, s19, 12
  s_add_u32 m0, s19, s40
  s_nop 0
  buffer_load_dwordx4 v15, s[20:23], s18 offen lds
  s_waitcnt vmcnt(6)
  s_waitcnt lgkmcnt(0)
  ds_read_b64_tr_b16 v[24:25], v22 offset:43008
  ds_read_b64_tr_b16 v[26:27], v22 offset:44544
  ds_read_b64_tr_b16 v[28:29], v22 offset:43072
  ds_read_b64_tr_b16 v[30:31], v22 offset:44608
  ds_read_b64_tr_b16 v[32:33], v22 offset:43136
  ds_read_b64_tr_b16 v[34:35], v22 offset:44672
  v_mfma_f32_32x32x16_bf16 v[64:79], v[36:39], v[148:151], v[64:79]
  v_mfma_f32_32x32x16_bf16 v[80:95], v[40:43], v[148:151], v[80:95]
  v_mfma_f32_32x32x16_bf16 v[96:111], v[44:47], v[148:151], v[96:111]
  s_waitcnt vmcnt(5)
  s_waitcnt lgkmcnt(0)
  ds_read_b64_tr_b16 v[36:37], v22 offset:46080
  ds_read_b64_tr_b16 v[38:39], v22 offset:47616
  ds_read_b64_tr_b16 v[40:41], v22 offset:46144
  ds_read_b64_tr_b16 v[42:43], v22 offset:47680
  ds_read_b64_tr_b16 v[44:45], v22 offset:46208
  ds_read_b64_tr_b16 v[46:47], v22 offset:47744
  v_mfma_f32_32x32x16_bf16 v[64:79], v[24:27], v[152:155], v[64:79]
  v_mfma_f32_32x32x16_bf16 v[80:95], v[28:31], v[152:155], v[80:95]
  v_mfma_f32_32x32x16_bf16 v[96:111], v[32:35], v[152:155], v[96:111]
  s_waitcnt vmcnt(3)
  s_waitcnt lgkmcnt(0)
  v_mfma_f32_32x32x16_bf16 v[64:79], v[36:39], v[156:159], v[64:79]
  v_mfma_f32_32x32x16_bf16 v[80:95], v[40:43], v[156:159], v[80:95]
  v_mfma_f32_32x32x16_bf16 v[96:111], v[44:47], v[156:159], v[96:111]
b_w3_done:
  s_mov_b64 exec, 1
  ds_add_u32 v14, v13 offset:20
  s_mov_b64 exec, -1
  s_setprio 2
  v_rcp_f32 v20, v17
  v_mul_f32 v18, v17, v17
  v_mul_f32 v18, v18, v17
  v_mul_f32 v18, 0xbdd2d3e8, v18
  v_mul_f32 v19, 0xc0135761, v17
  s_mul_i32 s16, s14, 393216
  s_cmp_ge_u32 s16, 5636096
  s_cbranch_scc1 b_gelu_done
  v_pk_mul_f32 v[112:113], v[64:65], v[64:65]
  v_pk_mul_f32 v[114:115], v[66:67], v[66:67]
  v_pk_mul_f32 v[116:117], v[68:69], v[68:69]
  v_pk_mul_f32 v[118:119], v[70:71], v[70:71]
  v_pk_mul_f32 v[120:121], v[72:73], v[72:73]
  v_pk_mul_f32 v[122:123], v[74:75], v[74:75]
  v_pk_mul_f32 v[124:125], v[76:77], v[76:77]
  v_pk_mul_f32 v[126:127], v[78:79], v[78:79]
  v_pk_fma_f32 v[112:113], v[112:113], v[18:19], v[18:19] op_sel:[0,0,1] op_sel_hi:[1,0,1]
  v_pk_fma_f32 v[114:115], v[114:115], v[18:19], v[18:19] op_sel:[0,0,1] op_sel_hi:[1,0,1]
  v_pk_fma_f32 v[116:117], v[116:117], v[18:19], v[18:19] op_sel:[0,0,1] op_sel_hi:[1,0,1]
  v_pk_fma_f32 v[118:119], v[118:119], v[18:19], v[18:19] op_sel:[0,0,1] op_sel_hi:[1,0,1]
  v_pk_fma_f32 v[120:121], v[120:121], v[18:19], v[18:19] op_sel:[0,0,1] op_sel_hi:[1,0,1]
  v_pk_fma_f32 v[122:123], v[122:123], v[18:19], v[18:19] op_sel:[0,0,1] op_sel_hi:[1,0,1]
  v_pk_fma_f32 v[124:125], v[124:125], v[18:19], v[18:19] op_sel:[0,0,1] op_sel_hi:[1,0,1]
  v_pk_fma_f32 v[126:127], v[126:127], v[18:19], v[18:19] op_sel:[0,0,1] op_sel_hi:[1,0,1]
  v_pk_mul_f32 v[112:113], v[112:113], v[64:65]
  v_pk_mul_f32 v[114:115], v[114:115], v[66:67]
  v_pk_mul_f32 v[116:117], v[116:117], v[68:69]
  v_pk_mul_f32 v[118:119], v[118:119], v[70:71]
  v_pk_mul_f32 v[120:121], v[120:121], v[72:73]
  v_pk_mul_f32 v[122:123], v[122:123], v[74:75]
  v_pk_mul_f32 v[124:125], v[124:125], v[76:77]
  v_pk_mul_f32 v[126:127], v[126:127], v[78:79]
  v_exp_f32 v112, v112
  v_exp_f32 v113, v113
  v_exp_f32 v114, v114
  v_exp_f32 v115, v115
  v_exp_f32 v116, v116
  v_exp_f32 v117, v117
  v_exp_f32 v118, v118
  v_exp_f32 v119, v119
  v_exp_f32 v120, v120
  v_exp_f32 v121, v121
  v_exp_f32 v122, v122
  v_exp_f32 v123, v123
  v_exp_f32 v124, v124
  v_exp_f32 v125, v125
  v_exp_f32 v126, v126
  v_exp_f32 v127, v127
  v_pk_fma_f32 v[112:113], v[112:113], v[20:21], v[20:21] op_sel_hi:[1,0,0]
  v_pk_fma_f32 v[114:115], v[114:115], v[20:21], v[20:21] op_sel_hi:[1,0,0]
  v_pk_fma_f32 v[116:117], v[116:117], v[20:21], v[20:21] op_sel_hi:[1,0,0]
  v_pk_fma_f32 v[118:119], v[118:119], v[20:21], v[20:21] op_sel_hi:[1,0,0]
  v_pk_fma_f32 v[120:121], v[120:121], v[20:21], v[20:21] op_sel_hi:[1,0,0]
  v_pk_fma_f32 v[122:123], v[122:123], v[20:21], v[20:21] op_sel_hi:[1,0,0]
  v_pk_fma_f32 v[124:125], v[124:125], v[20:21], v[20:21] op_sel_hi:[1,0,0]
  v_pk_fma_f32 v[126:127], v[126:127], v[20:21], v[20:21] op_sel_hi:[1,0,0]
  v_rcp_f32 v112, v112
  v_rcp_f32 v113, v113
  v_rcp_f32 v114, v114
  v_rcp_f32 v115, v115
  v_rcp_f32 v116, v116
  v_rcp_f32 v117, v117
  v_rcp_f32 v118, v118
  v_rcp_f32 v119, v119
  v_rcp_f32 v120, v120
  v_rcp_f32 v121, v121
  v_rcp_f32 v122, v122
  v_rcp_f32 v123, v123
  v_rcp_f32 v124, v124
  v_rcp_f32 v125, v125
  v_rcp_f32 v126, v126
  v_rcp_f32 v127, v127
  v_pk_mul_f32 v[64:65], v[64:65], v[112:113]
  v_pk_mul_f32 v[66:67], v[66:67], v[114:115]
  v_pk_mul_f32 v[68:69], v[68:69], v[116:117]
  v_pk_mul_f32 v[70:71], v[70:71], v[118:119]
  v_pk_mul_f32 v[72:73], v[72:73], v[120:121]
  v_pk_mul_f32 v[74:75], v[74:75], v[122:123]
  v_pk_mul_f32 v[76:77], v[76:77], v[124:125]
  v_pk_mul_f32 v[78:79], v[78:79], v[126:127]
  v_cvt_pk_bf16_f32 v128, v64, v65
  v_cvt_pk_bf16_f32 v129, v66, v67
  v_cvt_pk_bf16_f32 v130, v68, v69
  v_cvt_pk_bf16_f32 v131, v70, v71
  v_cvt_pk_bf16_f32 v132, v72, v73
  v_cvt_pk_bf16_f32 v133, v74, v75
  v_cvt_pk_bf16_f32 v134, v76, v77
  v_cvt_pk_bf16_f32 v135, v78, v79
  buffer_store_dwordx4 v[128:131], v2, s[28:31], s16 offen sc1
  s_add_u32 s16, s16, 65536
  buffer_store_dwordx4 v[132:135], v2, s[28:31], s16 offen sc1
  s_add_u32 s16, s16, 65536
  s_cmp_ge_u32 s16, 5636096
  s_cbranch_scc1 b_gelu_done
  v_pk_mul_f32 v[112:113], v[80:81], v[80:81]
  v_pk_mul_f32 v[114:115], v[82:83], v[82:83]
  v_pk_mul_f32 v[116:117], v[84:85], v[84:85]
  v_pk_mul_f32 v[118:119], v[86:87], v[86:87]
  v_pk_mul_f32 v[120:121], v[88:89], v[88:89]
  v_pk_mul_f32 v[122:123], v[90:91], v[90:91]
  v_pk_mul_f32 v[124:125], v[92:93], v[92:93]
  v_pk_mul_f32 v[126:127], v[94:95], v[94:95]
  v_pk_fma_f32 v[112:113], v[112:113], v[18:19], v[18:19] op_sel:[0,0,1] op_sel_hi:[1,0,1]
  v_pk_fma_f32 v[114:115], v[114:115], v[18:19], v[18:19] op_sel:[0,0,1] op_sel_hi:[1,0,1]
  v_pk_fma_f32 v[116:117], v[116:117], v[18:19], v[18:19] op_sel:[0,0,1] op_sel_hi:[1,0,1]
  v_pk_fma_f32 v[118:119], v[118:119], v[18:19], v[18:19] op_sel:[0,0,1] op_sel_hi:[1,0,1]
  v_pk_fma_f32 v[120:121], v[120:121], v[18:19], v[18:19] op_sel:[0,0,1] op_sel_hi:[1,0,1]
  v_pk_fma_f32 v[122:123], v[122:123], v[18:19], v[18:19] op_sel:[0,0,1] op_sel_hi:[1,0,1]
  v_pk_fma_f32 v[124:125], v[124:125], v[18:19], v[18:19] op_sel:[0,0,1] op_sel_hi:[1,0,1]
  v_pk_fma_f32 v[126:127], v[126:127], v[18:19], v[18:19] op_sel:[0,0,1] op_sel_hi:[1,0,1]
  v_pk_mul_f32 v[112:113], v[112:113], v[80:81]
  v_pk_mul_f32 v[114:115], v[114:115], v[82:83]
  v_pk_mul_f32 v[116:117], v[116:117], v[84:85]
  v_pk_mul_f32 v[118:119], v[118:119], v[86:87]
  v_pk_mul_f32 v[120:121], v[120:121], v[88:89]
  v_pk_mul_f32 v[122:123], v[122:123], v[90:91]
  v_pk_mul_f32 v[124:125], v[124:125], v[92:93]
  v_pk_mul_f32 v[126:127], v[126:127], v[94:95]
  v_exp_f32 v112, v112
  v_exp_f32 v113, v113
  v_exp_f32 v114, v114
  v_exp_f32 v115, v115
  v_exp_f32 v116, v116
  v_exp_f32 v117, v117
  v_exp_f32 v118, v118
  v_exp_f32 v119, v119
  v_exp_f32 v120, v120
  v_exp_f32 v121, v121
  v_exp_f32 v122, v122
  v_exp_f32 v123, v123
  v_exp_f32 v124, v124
  v_exp_f32 v125, v125
  v_exp_f32 v126, v126
  v_exp_f32 v127, v127
  v_pk_fma_f32 v[112:113], v[112:113], v[20:21], v[20:21] op_sel_hi:[1,0,0]
  v_pk_fma_f32 v[114:115], v[114:115], v[20:21], v[20:21] op_sel_hi:[1,0,0]
  v_pk_fma_f32 v[116:117], v[116:117], v[20:21], v[20:21] op_sel_hi:[1,0,0]
  v_pk_fma_f32 v[118:119], v[118:119], v[20:21], v[20:21] op_sel_hi:[1,0,0]
  v_pk_fma_f32 v[120:121], v[120:121], v[20:21], v[20:21] op_sel_hi:[1,0,0]
  v_pk_fma_f32 v[122:123], v[122:123], v[20:21], v[20:21] op_sel_hi:[1,0,0]
  v_pk_fma_f32 v[124:125], v[124:125], v[20:21], v[20:21] op_sel_hi:[1,0,0]
  v_pk_fma_f32 v[126:127], v[126:127], v[20:21], v[20:21] op_sel_hi:[1,0,0]
  v_rcp_f32 v112, v112
  v_rcp_f32 v113, v113
  v_rcp_f32 v114, v114
  v_rcp_f32 v115, v115
  v_rcp_f32 v116, v116
  v_rcp_f32 v117, v117
  v_rcp_f32 v118, v118
  v_rcp_f32 v119, v119
  v_rcp_f32 v120, v120
  v_rcp_f32 v121, v121
  v_rcp_f32 v122, v122
  v_rcp_f32 v123, v123
  v_rcp_f32 v124, v124
  v_rcp_f32 v125, v125
  v_rcp_f32 v126, v126
  v_rcp_f32 v127, v127
  v_pk_mul_f32 v[80:81], v[80:81], v[112:113]
  v_pk_mul_f32 v[82:83], v[82:83], v[114:115]
  v_pk_mul_f32 v[84:85], v[84:85], v[116:117]
  v_pk_mul_f32 v[86:87], v[86:87], v[118:119]
  v_pk_mul_f32 v[88:89], v[88:89], v[120:121]
  v_pk_mul_f32 v[90:91], v[90:91], v[122:123]
  v_pk_mul_f32 v[92:93], v[92:93], v[124:125]
  v_pk_mul_f32 v[94:95], v[94:95], v[126:127]
  v_cvt_pk_bf16_f32 v136, v80, v81
  v_cvt_pk_bf16_f32 v137, v82, v83
  v_cvt_pk_bf16_f32 v138, v84, v85
  v_cvt_pk_bf16_f32 v139, v86, v87
  v_cvt_pk_bf16_f32 v140, v88, v89
  v_cvt_pk_bf16_f32 v141, v90, v91
  v_cvt_pk_bf16_f32 v142, v92, v93
  v_cvt_pk_bf16_f32 v143, v94, v95
  buffer_store_dwordx4 v[136:139], v2, s[28:31], s16 offen sc1
  s_add_u32 s16, s16, 65536
  buffer_store_dwordx4 v[140:143], v2, s[28:31], s16 offen sc1
  s_add_u32 s16, s16, 65536
  s_cmp_ge_u32 s16, 5636096
  s_cbranch_scc1 b_gelu_done
  v_pk_mul_f32 v[112:113], v[96:97], v[96:97]
  v_pk_mul_f32 v[114:115], v[98:99], v[98:99]
  v_pk_mul_f32 v[116:117], v[100:101], v[100:101]
  v_pk_mul_f32 v[118:119], v[102:103], v[102:103]
  v_pk_mul_f32 v[120:121], v[104:105], v[104:105]
  v_pk_mul_f32 v[122:123], v[106:107], v[106:107]
  v_pk_mul_f32 v[124:125], v[108:109], v[108:109]
  v_pk_mul_f32 v[126:127], v[110:111], v[110:111]
  v_pk_fma_f32 v[112:113], v[112:113], v[18:19], v[18:19] op_sel:[0,0,1] op_sel_hi:[1,0,1]
  v_pk_fma_f32 v[114:115], v[114:115], v[18:19], v[18:19] op_sel:[0,0,1] op_sel_hi:[1,0,1]
  v_pk_fma_f32 v[116:117], v[116:117], v[18:19], v[18:19] op_sel:[0,0,1] op_sel_hi:[1,0,1]
  v_pk_fma_f32 v[118:119], v[118:119], v[18:19], v[18:19] op_sel:[0,0,1] op_sel_hi:[1,0,1]
  v_pk_fma_f32 v[120:121], v[120:121], v[18:19], v[18:19] op_sel:[0,0,1] op_sel_hi:[1,0,1]
  v_pk_fma_f32 v[122:123], v[122:123], v[18:19], v[18:19] op_sel:[0,0,1] op_sel_hi:[1,0,1]
  v_pk_fma_f32 v[124:125], v[124:125], v[18:19], v[18:19] op_sel:[0,0,1] op_sel_hi:[1,0,1]
  v_pk_fma_f32 v[126:127], v[126:127], v[18:19], v[18:19] op_sel:[0,0,1] op_sel_hi:[1,0,1]
  v_pk_mul_f32 v[112:113], v[112:113], v[96:97]
  v_pk_mul_f32 v[114:115], v[114:115], v[98:99]
  v_pk_mul_f32 v[116:117], v[116:117], v[100:101]
  v_pk_mul_f32 v[118:119], v[118:119], v[102:103]
  v_pk_mul_f32 v[120:121], v[120:121], v[104:105]
  v_pk_mul_f32 v[122:123], v[122:123], v[106:107]
  v_pk_mul_f32 v[124:125], v[124:125], v[108:109]
  v_pk_mul_f32 v[126:127], v[126:127], v[110:111]
  v_exp_f32 v112, v112
  v_exp_f32 v113, v113
  v_exp_f32 v114, v114
  v_exp_f32 v115, v115
  v_exp_f32 v116, v116
  v_exp_f32 v117, v117
  v_exp_f32 v118, v118
  v_exp_f32 v119, v119
  v_exp_f32 v120, v120
  v_exp_f32 v121, v121
  v_exp_f32 v122, v122
  v_exp_f32 v123, v123
  v_exp_f32 v124, v124
  v_exp_f32 v125, v125
  v_exp_f32 v126, v126
  v_exp_f32 v127, v127
  v_pk_fma_f32 v[112:113], v[112:113], v[20:21], v[20:21] op_sel_hi:[1,0,0]
  v_pk_fma_f32 v[114:115], v[114:115], v[20:21], v[20:21] op_sel_hi:[1,0,0]
  v_pk_fma_f32 v[116:117], v[116:117], v[20:21], v[20:21] op_sel_hi:[1,0,0]
  v_pk_fma_f32 v[118:119], v[118:119], v[20:21], v[20:21] op_sel_hi:[1,0,0]
  v_pk_fma_f32 v[120:121], v[120:121], v[20:21], v[20:21] op_sel_hi:[1,0,0]
  v_pk_fma_f32 v[122:123], v[122:123], v[20:21], v[20:21] op_sel_hi:[1,0,0]
  v_pk_fma_f32 v[124:125], v[124:125], v[20:21], v[20:21] op_sel_hi:[1,0,0]
  v_pk_fma_f32 v[126:127], v[126:127], v[20:21], v[20:21] op_sel_hi:[1,0,0]
  v_rcp_f32 v112, v112
  v_rcp_f32 v113, v113
  v_rcp_f32 v114, v114
  v_rcp_f32 v115, v115
  v_rcp_f32 v116, v116
  v_rcp_f32 v117, v117
  v_rcp_f32 v118, v118
  v_rcp_f32 v119, v119
  v_rcp_f32 v120, v120
  v_rcp_f32 v121, v121
  v_rcp_f32 v122, v122
  v_rcp_f32 v123, v123
  v_rcp_f32 v124, v124
  v_rcp_f32 v125, v125
  v_rcp_f32 v126, v126
  v_rcp_f32 v127, v127
  v_pk_mul_f32 v[96:97], v[96:97], v[112:113]
  v_pk_mul_f32 v[98:99], v[98:99], v[114:115]
  v_pk_mul_f32 v[100:101], v[100:101], v[116:117]
  v_pk_mul_f32 v[102:103], v[102:103], v[118:119]
  v_pk_mul_f32 v[104:105], v[104:105], v[120:121]
  v_pk_mul_f32 v[106:107], v[106:107], v[122:123]
  v_pk_mul_f32 v[108:109], v[108:109], v[124:125]
  v_pk_mul_f32 v[110:111], v[110:111], v[126:127]
  v_cvt_pk_bf16_f32 v144, v96, v97
  v_cvt_pk_bf16_f32 v145, v98, v99
  v_cvt_pk_bf16_f32 v146, v100, v101
  v_cvt_pk_bf16_f32 v147, v102, v103
  v_cvt_pk_bf16_f32 v148, v104, v105
  v_cvt_pk_bf16_f32 v149, v106, v107
  v_cvt_pk_bf16_f32 v150, v108, v109
  v_cvt_pk_bf16_f32 v151, v110, v111
  buffer_store_dwordx4 v[144:147], v2, s[28:31], s16 offen sc1
  s_add_u32 s16, s16, 65536
  buffer_store_dwordx4 v[148:151], v2, s[28:31], s16 offen sc1
  s_add_u32 s16, s16, 65536
b_gelu_done:
  s_lshl4_add_u32 s16, s15, s14
  s_lshl_b32 s16, s16, 7
  s_add_u32 s16, s16, 131072
  v_mov_b32 v18, s60
  v_mov_b32 v19, s61
  v_mov_b32 v20, s60
  v_mov_b32 v21, s61
  v_lshlrev_b32 v22, 4, v1
  s_waitcnt vmcnt(0)
  s_mov_b64 exec, 0xff
  buffer_store_dwordx4 v[18:21], v22, s[32:35], s16 offen sc1
  s_mov_b64 exec, -1
  s_setprio 0
  s_add_u32 s24, s10, 0xc00000
  s_addc_u32 s25, s11, 0
  s_mov_b32 s26, 0x560000
  s_mov_b32 s27, 0x20000
  s_add_u32 s28, s10, 0x1400000
  s_addc_u32 s29, s11, 0
  s_mov_b32 s30, 0x400000
  s_mov_b32 s31, 0x20000
  v_bfe_u32 v20, v1, 2, 2
  v_lshrrev_b32 v21, 5, v1
  v_lshl_add_u32 v20, v21, 2, v20
  v_lshlrev_b32 v20, 7, v20
  v_bfe_u32 v21, v1, 3, 1
  v_xor_b32 v21, s14, v21
  v_and_b32 v21, 1, v21
  v_lshl_add_u32 v20, v21, 6, v20
  v_and_b32 v21, 63, v6
  v_add_u32 v126, v20, v21
  v_xor_b32 v127, 64, v126
  v_and_b32 v12, 15, v1
  v_lshlrev_b32 v12, 7, v12
  s_lshl_b32 s42, s15, 11
  s_add_u32 s42, s42, 131072
  s_mov_b32 s44, 0x7f
  s_mov_b32 s43, 0
  s_and_b32 s48, s14, 1
  s_mul_i32 s48, s48, 7
  s_and_b32 s49, s14, 6
  buffer_load_dwordx2 v[16:17], v12, s[32:35], s42 offen sc1
b_s4:
  ds_read_b32 v18, v14 offset:20
  s_waitcnt lgkmcnt(0)
  v_readfirstlane_b32 s16, v18
  s_nop 0
  s_cmp_ge_u32 s16, 4
  s_cbranch_scc1 b_s4_ok
  s_sleep 1
  s_sub_u32 s62, s62, 1
  s_cbranch_scc0 b_s4
  s_mov_b32 s62, 0
b_s4_ok:
  s_lshl1_add_u32 s19, s96, 8
  s_sub_u32 s17, s19, 14
  s_cmp_ge_u32 s19, 22
  s_cselect_b32 s19, s17, s19
  s_lshl_b32 s18, s19, 15
  s_add_u32 s18, s18, s46
  s_lshl_b32 s19, s19, 12
  s_add_u32 m0, s19, s40
  s_nop 0
  buffer_load_dwordx4 v15, s[20:23], s18 offen lds
  s_lshl1_add_u32 s19, s96, 9
  s_sub_u32 s17, s19, 14
  s_cmp_ge_u32 s19, 22
  s_cselect_b32 s19, s17, s19
  s_lshl_b32 s18, s19, 15
  s_add_u32 s18, s18, s46
  s_lshl_b32 s19, s19, 12
  s_add_u32 m0, s19, s40
  s_nop 0
  buffer_load_dwordx4 v15, s[20:23], s18 offen lds
  s_lshl1_add_u32 s19, s96, 10
  s_sub_u32 s17, s19, 14
  s_cmp_ge_u32 s19, 22
  s_cselect_b32 s19, s17, s19
  s_lshl_b32 s18, s19, 15
  s_add_u32 s18, s18, s46
  s_lshl_b32 s19, s19, 12
  s_add_u32 m0, s19, s40
  s_nop 0
  buffer_load_dwordx4 v15, s[20:23], s18 offen lds
  s_lshl1_add_u32 s19, s96, 11
  s_sub_u32 s17, s19, 14
  s_cmp_ge_u32 s19, 22
  s_cselect_b32 s19, s17, s19
  s_lshl_b32 s18, s19, 15
  s_add_u32 s18, s18, s46
  s_lshl_b32 s19, s19, 12
  s_add_u32 m0, s19, s40
  s_nop 0
  buffer_load_dwordx4 v15, s[20:23], s18 offen lds
  s_lshl1_add_u32 s19, s96, 12
  s_sub_u32 s17, s19, 14
  s_cmp_ge_u32 s19, 22
  s_cselect_b32 s19, s17, s19
  s_lshl_b32 s18, s19, 15
  s_add_u32 s18, s18, s46
  s_lshl_b32 s19, s19, 12
  s_add_u32 m0, s19, s40
  s_nop 0
  buffer_load_dwordx4 v15, s[20:23], s18 offen lds
  s_lshl1_add_u32 s19, s96, 13
  s_sub_u32 s17, s19, 14
  s_cmp_ge_u32 s19, 22
  s_cselect_b32 s19, s17, s19
  s_lshl_b32 s18, s19, 15
  s_add_u32 s18, s18, s46
  s_lshl_b32 s19, s19, 12
  s_add_u32 m0, s19, s40
  s_nop 0
  buffer_load_dwordx4 v15, s[20:23], s18 offen lds
  s_lshl1_add_u32 s19, s96, 14
  s_sub_u32 s17, s19, 14
  s_cmp_ge_u32 s19, 22
  s_cselect_b32 s19, s17, s19
  s_lshl_b32 s18, s19, 15
  s_add_u32 s18, s18, s46
  s_lshl_b32 s19, s19, 12
  s_add_u32 m0, s19, s40
  s_nop 0
  buffer_load_dwordx4 v15, s[20:23], s18 offen lds
  s_lshl1_add_u32 s19, s96, 15
  s_sub_u32 s17, s19, 14
  s_cmp_ge_u32 s19, 22
  s_cselect_b32 s19, s17, s19
  s_lshl_b32 s18, s19, 15
  s_add_u32 s18, s18, s46
  s_lshl_b32 s19, s19, 12
  s_add_u32 m0, s19, s40
  s_nop 0
  buffer_load_dwordx4 v15, s[20:23], s18 offen lds
  s_lshl1_add_u32 s19, s96, 16
  s_sub_u32 s17, s19, 14
  s_cmp_ge_u32 s19, 22
  s_cselect_b32 s19, s17, s19
  s_lshl_b32 s18, s19, 15
  s_add_u32 s18, s18, s46
  s_lshl_b32 s19, s19, 12
  s_add_u32 m0, s19, s40
  s_nop 0
  buffer_load_dwordx4 v15, s[20:23], s18 offen lds
  s_lshl1_add_u32 s19, s96, 17
  s_sub_u32 s17, s19, 14
  s_cmp_ge_u32 s19, 22
  s_cselect_b32 s19, s17, s19
  s_lshl_b32 s18, s19, 15
  s_add_u32 s18, s18, s46
  s_lshl_b32 s19, s19, 12
  s_add_u32 m0, s19, s40
  s_nop 0
  buffer_load_dwordx4 v15, s[20:23], s18 offen lds
  s_lshl1_add_u32 s19, s96, 18
  s_sub_u32 s17, s19, 14
  s_cmp_ge_u32 s19, 22
  s_cselect_b32 s19, s17, s19
  s_lshl_b32 s18, s19, 15
  s_add_u32 s18, s18, s46
  s_lshl_b32 s19, s19, 12
  s_add_u32 m0, s19, s40
  s_nop 0
  buffer_load_dwordx4 v15, s[20:23], s18 offen lds
  s_lshl1_add_u32 s19, s96, 19
  s_sub_u32 s17, s19, 14
  s_cmp_ge_u32 s19, 22
  s_cselect_b32 s19, s17, s19
  s_lshl_b32 s18, s19, 15
  s_add_u32 s18, s18, s46
  s_lshl_b32 s19, s19, 12
  s_add_u32 m0, s19, s40
  s_nop 0
  buffer_load_dwordx4 v15, s[20:23], s18 offen lds
  s_lshl1_add_u32 s19, s96, 20
  s_sub_u32 s17, s19, 14
  s_cmp_ge_u32 s19, 22
  s_cselect_b32 s19, s17, s19
  s_lshl_b32 s18, s19, 15
  s_add_u32 s18, s18, s46
  s_lshl_b32 s19, s19, 12
  s_add_u32 m0, s19, s40
  s_nop 0
  buffer_load_dwordx4 v15, s[20:23], s18 offen lds
  s_lshl1_add_u32 s19, s96, 21
  s_sub_u32 s17, s19, 14
  s_cmp_ge_u32 s19, 22
  s_cselect_b32 s19, s17, s19
  s_lshl_b32 s18, s19, 15
  s_add_u32 s18, s18, s46
  s_lshl_b32 s19, s19, 12
  s_add_u32 m0, s19, s40
  s_nop 0
  buffer_load_dwordx4 v15, s[20:23], s18 offen lds
  s_mov_b32 s20, s58
  s_mov_b32 s21, s59
  s_mov_b32 s22, 0x80000
  s_mov_b32 s23, 0x20000
  s_waitcnt vmcnt(14)
  v_cmp_eq_u64 vcc, s[60:61], v[16:17]
  s_nop 0
  s_lshr_b32 s16, vcc_lo, s48
  s_and_b32 s43, s16, s44
  s_and_b32 s46, s16, 0x80
  s_cmp_lg_u32 s43, 0
  s_cbranch_scc1 b_h2_0_ok
b_h2_0:
  buffer_load_dwordx2 v[16:17], v12, s[32:35], s42 offen sc1
  s_waitcnt vmcnt(0)
  v_cmp_eq_u64 vcc, s[60:61], v[16:17]
  s_nop 0
  s_lshr_b32 s16, vcc_lo, s48
  s_and_b32 s43, s16, s44
  s_and_b32 s46, s16, 0x80
  s_cmp_lg_u32 s43, 0
  s_cbranch_scc1 b_h2_0_ok
  s_sleep 2
  s_sub_u32 s62, s62, 1
  s_cbranch_scc0 b_h2_0
  s_mov_b32 s62, 0
  s_mov_b32 s43, s44
b_h2_0_ok:
  s_lshr_b32 s16, s43, s49
  s_lshl_b32 s16, s16, s49
  s_cselect_b32 s16, s16, s43
  s_ff1_i32_b32 s16, s16
  s_bitset0_b32 s44, s16
  s_bitset0_b32 s43, s16
  s_mul_i32 s17, s16, 12288
  v_add_u32 v120, s17, v126
  v_add_u32 v121, s17, v127
  s_mul_i32 s17, s16, 6
  s_add_u32 s17, s17, s45
  s_lshl_b32 s3, s17, 16
  s_add_u32 s18, s3, 0
  buffer_load_dwordx4 v[128:131], v2, s[24:27], s18 offen sc1
  s_add_u32 s18, s3, 65536
  buffer_load_dwordx4 v[132:135], v2, s[24:27], s18 offen sc1
  s_add_u32 s18, s3, 131072
  buffer_load_dwordx4 v[136:139], v2, s[24:27], s18 offen sc1
  s_add_u32 s18, s3, 196608
  buffer_load_dwordx4 v[140:143], v2, s[24:27], s18 offen sc1
  s_add_u32 s18, s3, 262144
  buffer_load_dwordx4 v[144:147], v2, s[24:27], s18 offen sc1
  s_add_u32 s18, s3, 327680
  buffer_load_dwordx4 v[148:151], v2, s[24:27], s18 offen sc1
  s_waitcnt vmcnt(6)
  s_mov_b64 exec, 1
  ds_add_u32 v14, v13 offset:24
  s_mov_b64 exec, -1
  s_cmp_lg_u32 s43, 0
  s_cbranch_scc1 b_h2_1_ok
b_h2_1:
  buffer_load_dwordx2 v[16:17], v12, s[32:35], s42 offen sc1
  s_waitcnt vmcnt(0)
  v_cmp_eq_u64 vcc, s[60:61], v[16:17]
  s_nop 0
  s_lshr_b32 s16, vcc_lo, s48
  s_and_b32 s43, s16, s44
  s_and_b32 s46, s16, 0x80
  s_cmp_lg_u32 s43, 0
  s_cbranch_scc1 b_h2_1_ok
  s_sleep 2
  s_sub_u32 s62, s62, 1
  s_cbranch_scc0 b_h2_1
  s_mov_b32 s62, 0
  s_mov_b32 s43, s44
b_h2_1_ok:
  s_lshr_b32 s16, s43, s49
  s_lshl_b32 s16, s16, s49
  s_cselect_b32 s16, s16, s43
  s_ff1_i32_b32 s16, s16
  s_bitset0_b32 s44, s16
  s_bitset0_b32 s43, s16
  s_mul_i32 s17, s16, 12288
  v_add_u32 v122, s17, v126
  v_add_u32 v123, s17, v127
  s_mul_i32 s17, s16, 6
  s_add_u32 s17, s17, s45
  s_lshl_b32 s8, s17, 16
  s_add_u32 s18, s8, 0
  buffer_load_dwordx4 v[152:155], v2, s[24:27], s18 offen sc1
  s_add_u32 s18, s8, 65536
  buffer_load_dwordx4 v[156:159], v2, s[24:27], s18 offen sc1
  s_add_u32 s18, s8, 131072
  buffer_load_dwordx4 v[160:163], v2, s[24:27], s18 offen sc1
  s_lshl_b32 s47, s15, 4
  s_add_u32 s47, s47, s14
  s_lshl_b32 s47, s47, 11
  s_lshr_b32 s16, s15, 1
  s_lshl_b32 s16, s16, 12
  s_add_u32 s16, s16, 262144
  v_lshl_add_u32 v21, v1, 7, s16
  s_lshr_b32 s16, s47, 4
  s_add_u32 s16, s16, 491520
  v_mov_b32 v20, s16
  v_cmp_gt_u32 vcc, 32, v1
  s_nop 1
  v_cndmask_b32 v21, v20, v21, vcc
  v_lshlrev_b32 v23, 4, v1
b_s5:
  ds_read_b32 v18, v14 offset:24
  s_waitcnt lgkmcnt(0)
  v_readfirstlane_b32 s16, v18
  s_nop 0
  s_cmp_ge_u32 s16, 4
  s_cbranch_scc1 b_s5_ok
  s_sleep 1
  s_sub_u32 s62, s62, 1
  s_cbranch_scc0 b_s5
  s_mov_b32 s62, 0
b_s5_ok:
  s_setprio 0
  ds_read_b64_tr_b16 v[24:25], v120 offset:0
  ds_read_b64_tr_b16 v[26:27], v120 offset:1024
  ds_read_b64_tr_b16 v[28:29], v121 offset:0
  ds_read_b64_tr_b16 v[30:31], v121 offset:1024
  s_waitcnt vmcnt(8)
  s_waitcnt lgkmcnt(0)
  ds_read_b64_tr_b16 v[36:37], v120 offset:2048
  ds_read_b64_tr_b16 v[38:39], v120 offset:3072
  ds_read_b64_tr_b16 v[40:41], v121 offset:2048
  ds_read_b64_tr_b16 v[42:43], v121 offset:3072
  v_mfma_f32_32x32x16_bf16 v[48:63], v[24:27], v[128:131], v[48:63]
  v_mfma_f32_32x32x16_bf16 v[64:79], v[28:31], v[128:131], 0
  s_add_u32 s18, s8, 196608
  buffer_load_dwordx4 v[164:167], v2, s[24:27], s18 offen sc1
  s_waitcnt vmcnt(8)
  s_waitcnt lgkmcnt(0)
  ds_read_b64_tr_b16 v[24:25], v120 offset:4096
  ds_read_b64_tr_b16 v[26:27], v120 offset:5120
  ds_read_b64_tr_b16 v[28:29], v121 offset:4096
  ds_read_b64_tr_b16 v[30:31], v121 offset:5120
  v_mfma_f32_32x32x16_bf16 v[48:63], v[36:39], v[132:135], v[48:63]
  v_mfma_f32_32x32x16_bf16 v[64:79], v[40:43], v[132:135], v[64:79]
  s_add_u32 s18, s8, 262144
  buffer_load_dwordx4 v[80:83], v2, s[24:27], s18 offen sc1
  s_xor_b32 s19, s96, 0
  s_lshl2_add_u32 s18, s19, s12
  s_lshl_b32 s19, s19, 12
  s_add_u32 s19, s19, s40
  s_lshl_b32 s18, s18, 14
  s_add_u32 m0, s19, 90112
  s_add_u32 s18, s18, s41
  buffer_load_dwordx4 v8, s[20:23], s18 offen lds
  s_waitcnt vmcnt(9)
  s_waitcnt lgkmcnt(0)
  ds_read_b64_tr_b16 v[36:37], v120 offset:6144
  ds_read_b64_tr_b16 v[38:39], v120 offset:7168
  ds_read_b64_tr_b16 v[40:41], v121 offset:6144
  ds_read_b64_tr_b16 v[42:43], v121 offset:7168
  v_mfma_f32_32x32x16_bf16 v[48:63], v[24:27], v[136:139], v[48:63]
  v_mfma_f32_32x32x16_bf16 v[64:79], v[28:31], v[136:139], v[64:79]
  s_add_u32 s18, s8, 327680
  buffer_load_dwordx4 v[84:87], v2, s[24:27], s18 offen sc1
  s_waitcnt vmcnt(9)
  s_waitcnt lgkmcnt(0)
  ds_read_b64_tr_b16 v[24:25], v120 offset:8192
  ds_read_b64_tr_b16 v[26:27], v120 offset:9216
  ds_read_b64_tr_b16 v[28:29], v121 offset:8192
  ds_read_b64_tr_b16 v[30:31], v121 offset:9216
  v_mfma_f32_32x32x16_bf16 v[48:63], v[36:39], v[140:143], v[48:63]
  v_mfma_f32_32x32x16_bf16 v[64:79], v[40:43], v[140:143], v[64:79]
  s_cmp_lg_u32 s43, 0
  s_cbranch_scc1 b_h2_2_ok
b_h2_2:
  buffer_load_dwordx2 v[16:17], v12, s[32:35], s42 offen sc1
  s_waitcnt vmcnt(0)
  v_cmp_eq_u64 vcc, s[60:61], v[16:17]
  s_nop 0
  s_lshr_b32 s16, vcc_lo, s48
  s_and_b32 s43, s16, s44
  s_and_b32 s46, s16, 0x80
  s_cmp_lg_u32 s43, 0
  s_cbranch_scc1 b_h2_2_ok
  s_sleep 2
  s_sub_u32 s62, s62, 1
  s_cbranch_scc0 b_h2_2
  s_mov_b32 s62, 0
  s_mov_b32 s43, s44
b_h2_2_ok:
  s_lshr_b32 s16, s43, s49
  s_lshl_b32 s16, s16, s49
  s_cselect_b32 s16, s16, s43
  s_ff1_i32_b32 s16, s16
  s_bitset0_b32 s44, s16
  s_bitset0_b32 s43, s16
  s_mul_i32 s17, s16, 12288
  v_add_u32 v124, s17, v126
  v_add_u32 v125, s17, v127
  s_mul_i32 s17, s16, 6
  s_add_u32 s17, s17, s45
  s_lshl_b32 s9, s17, 16
  s_add_u32 s18, s9, 0
  buffer_load_dwordx4 v[128:131], v2, s[24:27], s18 offen sc1
  s_waitcnt vmcnt(9)
  s_waitcnt lgkmcnt(0)
  ds_read_b64_tr_b16 v[36:37], v120 offset:10240
  ds_read_b64_tr_b16 v[38:39], v120 offset:11264
  ds_read_b64_tr_b16 v[40:41], v121 offset:10240
  ds_read_b64_tr_b16 v[42:43], v121 offset:11264
  v_mfma_f32_32x32x16_bf16 v[48:63], v[24:27], v[144:147], v[48:63]
  v_mfma_f32_32x32x16_bf16 v[64:79], v[28:31], v[144:147], v[64:79]
  s_add_u32 s18, s9, 65536
  buffer_load_dwordx4 v[132:135], v2, s[24:27], s18 offen sc1
  s_waitcnt vmcnt(9)
  s_waitcnt lgkmcnt(0)
  ds_read_b64_tr_b16 v[24:25], v122 offset:0
  ds_read_b64_tr_b16 v[26:27], v122 offset:1024
  ds_read_b64_tr_b16 v[28:29], v123 offset:0
  ds_read_b64_tr_b16 v[30:31], v123 offset:1024
  v_mfma_f32_32x32x16_bf16 v[48:63], v[36:39], v[148:151], v[48:63]
  v_mfma_f32_32x32x16_bf16 v[64:79], v[40:43], v[148:151], v[64:79]
  s_add_u32 s18, s9, 131072
  buffer_load_dwordx4 v[136:139], v2, s[24:27], s18 offen sc1
  s_xor_b32 s19, s96, 1
  s_lshl2_add_u32 s18, s19, s12
  s_lshl_b32 s19, s19, 12
  s_add_u32 s19, s19, s40
  s_lshl_b32 s18, s18, 14
  s_add_u32 m0, s19, 90112
  s_add_u32 s18, s18, s41
  buffer_load_dwordx4 v8, s[20:23], s18 offen lds
  s_waitcnt vmcnt(10)
  s_waitcnt lgkmcnt(0)
  ds_read_b64_tr_b16 v[36:37], v122 offset:2048
  ds_read_b64_tr_b16 v[38:39], v122 offset:3072
  ds_read_b64_tr_b16 v[40:41], v123 offset:2048
  ds_read_b64_tr_b16 v[42:43], v123 offset:3072
  v_mfma_f32_32x32x16_bf16 v[48:63], v[24:27], v[152:155], v[48:63]
  v_mfma_f32_32x32x16_bf16 v[64:79], v[28:31], v[152:155], v[64:79]
  s_add_u32 s18, s9, 196608
  buffer_load_dwordx4 v[140:143], v2, s[24:27], s18 offen sc1
  s_waitcnt vmcnt(10)
  s_waitcnt lgkmcnt(0)
  ds_read_b64_tr_b16 v[24:25], v122 offset:4096
  ds_read_b64_tr_b16 v[26:27], v122 offset:5120
  ds_read_b64_tr_b16 v[28:29], v123 offset:4096
  ds_read_b64_tr_b16 v[30:31], v123 offset:5120
  v_mfma_f32_32x32x16_bf16 v[48:63], v[36:39], v[156:159], v[48:63]
  v_mfma_f32_32x32x16_bf16 v[64:79], v[40:43], v[156:159], v[64:79]
  s_add_u32 s18, s9, 262144
  buffer_load_dwordx4 v[144:147], v2, s[24:27], s18 offen sc1
  s_waitcnt vmcnt(10)
  s_waitcnt lgkmcnt(0)
  ds_read_b64_tr_b16 v[36:37], v122 offset:6144
  ds_read_b64_tr_b16 v[38:39], v122 offset:7168
  ds_read_b64_tr_b16 v[40:41], v123 offset:6144
  ds_read_b64_tr_b16 v[42:43], v123 offset:7168
  v_mfma_f32_32x32x16_bf16 v[48:63], v[24:27], v[160:163], v[48:63]
  v_mfma_f32_32x32x16_bf16 v[64:79], v[28:31], v[160:163], v[64:79]
  s_add_u32 s18, s9, 327680
  buffer_load_dwordx4 v[148:151], v2, s[24:27], s18 offen sc1
  s_waitcnt vmcnt(10)
  s_waitcnt lgkmcnt(0)
  ds_read_b64_tr_b16 v[24:25], v122 offset:8192
  ds_read_b64_tr_b16 v[26:27], v122 offset:9216
  ds_read_b64_tr_b16 v[28:29], v123 offset:8192
  ds_read_b64_tr_b16 v[30:31], v123 offset:9216
  v_mfma_f32_32x32x16_bf16 v[48:63], v[36:39], v[164:167], v[48:63]
  v_mfma_f32_32x32x16_bf16 v[64:79], v[40:43], v[164:167], v[64:79]
  s_cmp_lg_u32 s43, 0
  s_cbranch_scc1 b_h2_3_ok
b_h2_3:
  buffer_load_dwordx2 v[16:17], v12, s[32:35], s42 offen sc1
  s_waitcnt vmcnt(0)
  v_cmp_eq_u64 vcc, s[60:61], v[16:17]
  s_nop 0
  s_lshr_b32 s16, vcc_lo, s48
  s_and_b32 s43, s16, s44
  s_and_b32 s46, s16, 0x80
  s_cmp_lg_u32 s43, 0
  s_cbranch_scc1 b_h2_3_ok
  s_sleep 2
  s_sub_u32 s62, s62, 1
  s_cbranch_scc0 b_h2_3
  s_mov_b32 s62, 0
  s_mov_b32 s43, s44
b_h2_3_ok:
  s_lshr_b32 s16, s43, s49
  s_lshl_b32 s16, s16, s49
  s_cselect_b32 s16, s16, s43
  s_ff1_i32_b32 s16, s16
  s_bitset0_b32 s44, s16
  s_bitset0_b32 s43, s16
  s_mul_i32 s17, s16, 12288
  v_add_u32 v120, s17, v126
  v_add_u32 v121, s17, v127
  s_mul_i32 s17, s16, 6
  s_add_u32 s17, s17, s45
  s_lshl_b32 s3, s17, 16
  s_add_u32 s18, s3, 0
  buffer_load_dwordx4 v[152:155], v2, s[24:27], s18 offen sc1
  s_xor_b32 s19, s96, 2
  s_lshl2_add_u32 s18, s19, s12
  s_lshl_b32 s19, s19, 12
  s_add_u32 s19, s19, s40
  s_lshl_b32 s18, s18, 14
  s_add_u32 m0, s19, 90112
  s_add_u32 s18, s18, s41
  buffer_load_dwordx4 v8, s[20:23], s18 offen lds
  s_waitcnt vmcnt(11)
  s_waitcnt lgkmcnt(0)
  ds_read_b64_tr_b16 v[36:37], v122 offset:10240
  ds_read_b64_tr_b16 v[38:39], v122 offset:11264
  ds_read_b64_tr_b16 v[40:41], v123 offset:10240
  ds_read_b64_tr_b16 v[42:43], v123 offset:11264
  v_mfma_f32_32x32x16_bf16 v[48:63], v[24:27], v[80:83], v[48:63]
  v_mfma_f32_32x32x16_bf16 v[64:79], v[28:31], v[80:83], v[64:79]
  s_add_u32 s18, s3, 65536
  buffer_load_dwordx4 v[156:159], v2, s[24:27], s18 offen sc1
  s_waitcnt vmcnt(10)
  s_waitcnt lgkmcnt(0)
  ds_read_b64_tr_b16 v[24:25], v124 offset:0
  ds_read_b64_tr_b16 v[26:27], v124 offset:1024
  ds_read_b64_tr_b16 v[28:29], v125 offset:0
  ds_read_b64_tr_b16 v[30:31], v125 offset:1024
  v_mfma_f32_32x32x16_bf16 v[48:63], v[36:39], v[84:87], v[48:63]
  v_mfma_f32_32x32x16_bf16 v[64:79], v[40:43], v[84:87], v[64:79]
  s_add_u32 s18, s3, 131072
  buffer_load_dwordx4 v[160:163], v2, s[24:27], s18 offen sc1
  s_waitcnt vmcnt(10)
  s_waitcnt lgkmcnt(0)
  ds_read_b64_tr_b16 v[36:37], v124 offset:2048
  ds_read_b64_tr_b16 v[38:39], v124 offset:3072
  ds_read_b64_tr_b16 v[40:41], v125 offset:2048
  ds_read_b64_tr_b16 v[42:43], v125 offset:3072
  v_mfma_f32_32x32x16_bf16 v[48:63], v[24:27], v[128:131], v[48:63]
  v_mfma_f32_32x32x16_bf16 v[64:79], v[28:31], v[128:131], v[64:79]
  s_add_u32 s18, s3, 196608
  buffer_load_dwordx4 v[164:167], v2, s[24:27], s18 offen sc1
  s_waitcnt vmcnt(10)
  s_waitcnt lgkmcnt(0)
  ds_read_b64_tr_b16 v[24:25], v124 offset:4096
  ds_read_b64_tr_b16 v[26:27], v124 offset:5120
  ds_read_b64_tr_b16 v[28:29], v125 offset:4096
  ds_read_b64_tr_b16 v[30:31], v125 offset:5120
  v_mfma_f32_32x32x16_bf16 v[48:63], v[36:39], v[132:135], v[48:63]
  v_mfma_f32_32x32x16_bf16 v[64:79], v[40:43], v[132:135], v[64:79]
  s_add_u32 s18, s3, 262144
  buffer_load_dwordx4 v[80:83], v2, s[24:27], s18 offen sc1
  s_xor_b32 s19, s96, 3
  s_lshl2_add_u32 s18, s19, s12
  s_lshl_b32 s19, s19, 12
  s_add_u32 s19, s19, s40
  s_lshl_b32 s18, s18, 14
  s_add_u32 m0, s19, 90112
  s_add_u32 s18, s18, s41
  buffer_load_dwordx4 v8, s[20:23], s18 offen lds
  s_waitcnt vmcnt(11)
  s_waitcnt lgkmcnt(0)
  ds_read_b64_tr_b16 v[36:37], v124 offset:6144
  ds_read_b64_tr_b16 v[38:39], v124 offset:7168
  ds_read_b64_tr_b16 v[40:41], v125 offset:6144
  ds_read_b64_tr_b16 v[42:43], v125 offset:7168
  v_mfma_f32_32x32x16_bf16 v[48:63], v[24:27], v[136:139], v[48:63]
  v_mfma_f32_32x32x16_bf16 v[64:79], v[28:31], v[136:139], v[64:79]
  s_add_u32 s18, s3, 327680
  buffer_load_dwordx4 v[84:87], v2, s[24:27], s18 offen sc1
  s_waitcnt vmcnt(10)
  s_waitcnt lgkmcnt(0)
  ds_read_b64_tr_b16 v[24:25], v124 offset:8192
  ds_read_b64_tr_b16 v[26:27], v124 offset:9216
  ds_read_b64_tr_b16 v[28:29], v125 offset:8192
  ds_read_b64_tr_b16 v[30:31], v125 offset:9216
  v_mfma_f32_32x32x16_bf16 v[48:63], v[36:39], v[140:143], v[48:63]
  v_mfma_f32_32x32x16_bf16 v[64:79], v[40:43], v[140:143], v[64:79]
  s_cmp_lg_u32 s43, 0
  s_cbranch_scc1 b_h2_4_ok
b_h2_4:
  buffer_load_dwordx2 v[16:17], v12, s[32:35], s42 offen sc1
  s_waitcnt vmcnt(0)
  v_cmp_eq_u64 vcc, s[60:61], v[16:17]
  s_nop 0
  s_lshr_b32 s16, vcc_lo, s48
  s_and_b32 s43, s16, s44
  s_and_b32 s46, s16, 0x80
  s_cmp_lg_u32 s43, 0
  s_cbranch_scc1 b_h2_4_ok
  s_sleep 2
  s_sub_u32 s62, s62, 1
  s_cbranch_scc0 b_h2_4
  s_mov_b32 s62, 0
  s_mov_b32 s43, s44
b_h2_4_ok:
  s_lshr_b32 s16, s43, s49
  s_lshl_b32 s16, s16, s49
  s_cselect_b32 s16, s16, s43
  s_ff1_i32_b32 s16, s16
  s_bitset0_b32 s44, s16
  s_bitset0_b32 s43, s16
  s_mul_i32 s17, s16, 12288
  v_add_u32 v122, s17, v126
  v_add_u32 v123, s17, v127
  s_mul_i32 s17, s16, 6
  s_add_u32 s17, s17, s45
  s_lshl_b32 s8, s17, 16
  s_add_u32 s18, s8, 0
  buffer_load_dwordx4 v[128:131], v2, s[24:27], s18 offen sc1
  s_waitcnt vmcnt(10)
  s_waitcnt lgkmcnt(0)
  ds_read_b64_tr_b16 v[36:37], v124 offset:10240
  ds_read_b64_tr_b16 v[38:39], v124 offset:11264
  ds_read_b64_tr_b16 v[40:41], v125 offset:10240
  ds_read_b64_tr_b16 v[42:43], v125 offset:11264
  v_mfma_f32_32x32x16_bf16 v[48:63], v[24:27], v[144:147], v[48:63]
  v_mfma_f32_32x32x16_bf16 v[64:79], v[28:31], v[144:147], v[64:79]
  s_add_u32 s18, s8, 65536
  buffer_load_dwordx4 v[132:135], v2, s[24:27], s18 offen sc1
  s_waitcnt vmcnt(10)
  s_waitcnt lgkmcnt(0)
  ds_read_b64_tr_b16 v[24:25], v120 offset:0
  ds_read_b64_tr_b16 v[26:27], v120 offset:1024
  ds_read_b64_tr_b16 v[28:29], v121 offset:0
  ds_read_b64_tr_b16 v[30:31], v121 offset:1024
  v_mfma_f32_32x32x16_bf16 v[48:63], v[36:39], v[148:151], v[48:63]
  v_mfma_f32_32x32x16_bf16 v[64:79], v[40:43], v[148:151], v[64:79]
  s_add_u32 s18, s8, 131072
  buffer_load_dwordx4 v[136:139], v2, s[24:27], s18 offen sc1
  s_xor_b32 s19, s96, 4
  s_lshl2_add_u32 s18, s19, s12
  s_lshl_b32 s19, s19, 12
  s_add_u32 s19, s19, s40
  s_lshl_b32 s18, s18, 14
  s_add_u32 m0, s19, 90112
  s_add_u32 s18, s18, s41
  buffer_load_dwordx4 v8, s[20:23], s18 offen lds
  s_waitcnt vmcnt(11)
  s_waitcnt lgkmcnt(0)
  ds_read_b64_tr_b16 v[36:37], v120 offset:2048
  ds_read_b64_tr_b16 v[38:39], v120 offset:3072
  ds_read_b64_tr_b16 v[40:41], v121 offset:2048
  ds_read_b64_tr_b16 v[42:43], v121 offset:3072
  v_mfma_f32_32x32x16_bf16 v[48:63], v[24:27], v[152:155], v[48:63]
  v_mfma_f32_32x32x16_bf16 v[64:79], v[28:31], v[152:155], v[64:79]
  s_add_u32 s18, s8, 196608
  buffer_load_dwordx4 v[140:143], v2, s[24:27], s18 offen sc1
  s_waitcnt vmcnt(10)
  s_waitcnt lgkmcnt(0)
  ds_read_b64_tr_b16 v[24:25], v120 offset:4096
  ds_read_b64_tr_b16 v[26:27], v120 offset:5120
  ds_read_b64_tr_b16 v[28:29], v121 offset:4096
  ds_read_b64_tr_b16 v[30:31], v121 offset:5120
  v_mfma_f32_32x32x16_bf16 v[48:63], v[36:39], v[156:159], v[48:63]
  v_mfma_f32_32x32x16_bf16 v[64:79], v[40:43], v[156:159], v[64:79]
  s_add_u32 s18, s8, 262144
  buffer_load_dwordx4 v[144:147], v2, s[24:27], s18 offen sc1
  s_waitcnt vmcnt(10)
  s_waitcnt lgkmcnt(0)
  ds_read_b64_tr_b16 v[36:37], v120 offset:6144
  ds_read_b64_tr_b16 v[38:39], v120 offset:7168
  ds_read_b64_tr_b16 v[40:41], v121 offset:6144
  ds_read_b64_tr_b16 v[42:43], v121 offset:7168
  v_mfma_f32_32x32x16_bf16 v[48:63], v[24:27], v[160:163], v[48:63]
  v_mfma_f32_32x32x16_bf16 v[64:79], v[28:31], v[160:163], v[64:79]
  s_add_u32 s18, s8, 327680
  buffer_load_dwordx4 v[148:151], v2, s[24:27], s18 offen sc1
  s_waitcnt vmcnt(10)
  s_waitcnt lgkmcnt(0)
  ds_read_b64_tr_b16 v[24:25], v120 offset:8192
  ds_read_b64_tr_b16 v[26:27], v120 offset:9216
  ds_read_b64_tr_b16 v[28:29], v121 offset:8192
  ds_read_b64_tr_b16 v[30:31], v121 offset:9216
  v_mfma_f32_32x32x16_bf16 v[48:63], v[36:39], v[164:167], v[48:63]
  v_mfma_f32_32x32x16_bf16 v[64:79], v[40:43], v[164:167], v[64:79]
  s_cmp_lg_u32 s43, 0
  s_cbranch_scc1 b_h2_5_ok
b_h2_5:
  buffer_load_dwordx2 v[16:17], v12, s[32:35], s42 offen sc1
  s_waitcnt vmcnt(0)
  v_cmp_eq_u64 vcc, s[60:61], v[16:17]
  s_nop 0
  s_lshr_b32 s16, vcc_lo, s48
  s_and_b32 s43, s16, s44
  s_and_b32 s46, s16, 0x80
  s_cmp_lg_u32 s43, 0
  s_cbranch_scc1 b_h2_5_ok
  s_sleep 2
  s_sub_u32 s62, s62, 1
  s_cbranch_scc0 b_h2_5
  s_mov_b32 s62, 0
  s_mov_b32 s43, s44
b_h2_5_ok:
  s_lshr_b32 s16, s43, s49
  s_lshl_b32 s16, s16, s49
  s_cselect_b32 s16, s16, s43
  s_ff1_i32_b32 s16, s16
  s_bitset0_b32 s44, s16
  s_bitset0_b32 s43, s16
  s_mul_i32 s17, s16, 12288
  v_add_u32 v124, s17, v126
  v_add_u32 v125, s17, v127
  s_mul_i32 s17, s16, 6
  s_add_u32 s17, s17, s45
  s_lshl_b32 s9, s17, 16
  s_add_u32 s18, s9, 0
  buffer_load_dwordx4 v[152:155], v2, s[24:27], s18 offen sc1
  s_xor_b32 s19, s96, 5
  s_lshl2_add_u32 s18, s19, s12
  s_lshl_b32 s19, s19, 12
  s_add_u32 s19, s19, s40
  s_lshl_b32 s18, s18, 14
  s_add_u32 m0, s19, 90112
  s_add_u32 s18, s18, s41
  buffer_load_dwordx4 v8, s[20:23], s18 offen lds
  s_waitcnt vmcnt(11)
  s_waitcnt lgkmcnt(0)
  ds_read_b64_tr_b16 v[36:37], v120 offset:10240
  ds_read_b64_tr_b16 v[38:39], v120 offset:11264
  ds_read_b64_tr_b16 v[40:41], v121 offset:10240
  ds_read_b64_tr_b16 v[42:43], v121 offset:11264
  v_mfma_f32_32x32x16_bf16 v[48:63], v[24:27], v[80:83], v[48:63]
  v_mfma_f32_32x32x16_bf16 v[64:79], v[28:31], v[80:83], v[64:79]
  s_add_u32 s18, s9, 65536
  buffer_load_dwordx4 v[156:159], v2, s[24:27], s18 offen sc1
  s_waitcnt vmcnt(10)
  s_waitcnt lgkmcnt(0)
  ds_read_b64_tr_b16 v[24:25], v122 offset:0
  ds_read_b64_tr_b16 v[26:27], v122 offset:1024
  ds_read_b64_tr_b16 v[28:29], v123 offset:0
  ds_read_b64_tr_b16 v[30:31], v123 offset:1024
  v_mfma_f32_32x32x16_bf16 v[48:63], v[36:39], v[84:87], v[48:63]
  v_mfma_f32_32x32x16_bf16 v[64:79], v[40:43], v[84:87], v[64:79]
  s_add_u32 s18, s9, 131072
  buffer_load_dwordx4 v[160:163], v2, s[24:27], s18 offen sc1
  s_waitcnt vmcnt(10)
  s_waitcnt lgkmcnt(0)
  ds_read_b64_tr_b16 v[36:37], v122 offset:2048
  ds_read_b64_tr_b16 v[38:39], v122 offset:3072
  ds_read_b64_tr_b16 v[40:41], v123 offset:2048
  ds_read_b64_tr_b16 v[42:43], v123 offset:3072
  v_mfma_f32_32x32x16_bf16 v[48:63], v[24:27], v[128:131], v[48:63]
  v_mfma_f32_32x32x16_bf16 v[64:79], v[28:31], v[128:131], v[64:79]
  s_add_u32 s18, s9, 196608
  buffer_load_dwordx4 v[164:167], v2, s[24:27], s18 offen sc1
  s_waitcnt vmcnt(10)
  s_waitcnt lgkmcnt(0)
  ds_read_b64_tr_b16 v[24:25], v122 offset:4096
  ds_read_b64_tr_b16 v[26:27], v122 offset:5120
  ds_read_b64_tr_b16 v[28:29], v123 offset:4096
  ds_read_b64_tr_b16 v[30:31], v123 offset:5120
  v_mfma_f32_32x32x16_bf16 v[48:63], v[36:39], v[132:135], v[48:63]
  v_mfma_f32_32x32x16_bf16 v[64:79], v[40:43], v[132:135], v[64:79]
  s_add_u32 s18, s9, 262144
  buffer_load_dwordx4 v[80:83], v2, s[24:27], s18 offen sc1
  s_xor_b32 s19, s96, 6
  s_lshl2_add_u32 s18, s19, s12
  s_lshl_b32 s19, s19, 12
  s_add_u32 s19, s19, s40
  s_lshl_b32 s18, s18, 14
  s_add_u32 m0, s19, 90112
  s_add_u32 s18, s18, s41
  buffer_load_dwordx4 v8, s[20:23], s18 offen lds
  s_waitcnt vmcnt(11)
  s_waitcnt lgkmcnt(0)
  ds_read_b64_tr_b16 v[36:37], v122 offset:6144
  ds_read_b64_tr_b16 v[38:39], v122 offset:7168
  ds_read_b64_tr_b16 v[40:41], v123 offset:6144
  ds_read_b64_tr_b16 v[42:43], v123 offset:7168
  v_mfma_f32_32x32x16_bf16 v[48:63], v[24:27], v[136:139], v[48:63]
  v_mfma_f32_32x32x16_bf16 v[64:79], v[28:31], v[136:139], v[64:79]
  s_add_u32 s18, s9, 327680
  buffer_load_dwordx4 v[84:87], v2, s[24:27], s18 offen sc1
  s_waitcnt vmcnt(10)
  s_waitcnt lgkmcnt(0)
  ds_read_b64_tr_b16 v[24:25], v122 offset:8192
  ds_read_b64_tr_b16 v[26:27], v122 offset:9216
  ds_read_b64_tr_b16 v[28:29], v123 offset:8192
  ds_read_b64_tr_b16 v[30:31], v123 offset:9216
  v_mfma_f32_32x32x16_bf16 v[48:63], v[36:39], v[140:143], v[48:63]
  v_mfma_f32_32x32x16_bf16 v[64:79], v[40:43], v[140:143], v[64:79]
  s_cmp_lg_u32 s43, 0
  s_cbranch_scc1 b_h2_6_ok
b_h2_6:
  buffer_load_dwordx2 v[16:17], v12, s[32:35], s42 offen sc1
  s_waitcnt vmcnt(0)
  v_cmp_eq_u64 vcc, s[60:61], v[16:17]
  s_nop 0
  s_lshr_b32 s16, vcc_lo, s48
  s_and_b32 s43, s16, s44
  s_and_b32 s46, s16, 0x80
  s_cmp_lg_u32 s43, 0
  s_cbranch_scc1 b_h2_6_ok
  s_sleep 2
  s_sub_u32 s62, s62, 1
  s_cbranch_scc0 b_h2_6
  s_mov_b32 s62, 0
  s_mov_b32 s43, s44
b_h2_6_ok:
  s_lshr_b32 s16, s43, s49
  s_lshl_b32 s16, s16, s49
  s_cselect_b32 s16, s16, s43
  s_ff1_i32_b32 s16, s16
  s_bitset0_b32 s44, s16
  s_bitset0_b32 s43, s16
  s_mul_i32 s17, s16, 12288
  v_add_u32 v120, s17, v126
  v_add_u32 v121, s17, v127
  s_mul_i32 s17, s16, 6
  s_add_u32 s17, s17, s45
  s_lshl_b32 s3, s17, 16
  s_add_u32 s18, s3, 0
  buffer_load_dwordx4 v[128:131], v2, s[24:27], s18 offen sc1
  s_waitcnt vmcnt(10)
  s_waitcnt lgkmcnt(0)
  ds_read_b64_tr_b16 v[36:37], v122 offset:10240
  ds_read_b64_tr_b16 v[38:39], v122 offset:11264
  ds_read_b64_tr_b16 v[40:41], v123 offset:10240
  ds_read_b64_tr_b16 v[42:43], v123 offset:11264
  v_mfma_f32_32x32x16_bf16 v[48:63], v[24:27], v[144:147], v[48:63]
  v_mfma_f32_32x32x16_bf16 v[64:79], v[28:31], v[144:147], v[64:79]
  s_add_u32 s18, s3, 65536
  buffer_load_dwordx4 v[132:135], v2, s[24:27], s18 offen sc1
  s_waitcnt vmcnt(10)
  s_waitcnt lgkmcnt(0)
  ds_read_b64_tr_b16 v[24:25], v124 offset:0
  ds_read_b64_tr_b16 v[26:27], v124 offset:1024
  ds_read_b64_tr_b16 v[28:29], v125 offset:0
  ds_read_b64_tr_b16 v[30:31], v125 offset:1024
  v_mfma_f32_32x32x16_bf16 v[48:63], v[36:39], v[148:151], v[48:63]
  v_mfma_f32_32x32x16_bf16 v[64:79], v[40:43], v[148:151], v[64:79]
  s_add_u32 s18, s3, 131072
  buffer_load_dwordx4 v[136:139], v2, s[24:27], s18 offen sc1
  s_xor_b32 s19, s96, 7
  s_lshl2_add_u32 s18, s19, s12
  s_lshl_b32 s19, s19, 12
  s_add_u32 s19, s19, s40
  s_lshl_b32 s18, s18, 14
  s_add_u32 m0, s19, 90112
  s_add_u32 s18, s18, s41
  buffer_load_dwordx4 v8, s[20:23], s18 offen lds
  s_waitcnt vmcnt(11)
  s_waitcnt lgkmcnt(0)
  ds_read_b64_tr_b16 v[36:37], v124 offset:2048
  ds_read_b64_tr_b16 v[38:39], v124 offset:3072
  ds_read_b64_tr_b16 v[40:41], v125 offset:2048
  ds_read_b64_tr_b16 v[42:43], v125 offset:3072
  v_mfma_f32_32x32x16_bf16 v[48:63], v[24:27], v[152:155], v[48:63]
  v_mfma_f32_32x32x16_bf16 v[64:79], v[28:31], v[152:155], v[64:79]
  s_add_u32 s18, s3, 196608
  buffer_load_dwordx4 v[140:143], v2, s[24:27], s18 offen sc1
  s_waitcnt vmcnt(10)
  s_waitcnt lgkmcnt(0)
  ds_read_b64_tr_b16 v[24:25], v124 offset:4096
  ds_read_b64_tr_b16 v[26:27], v124 offset:5120
  ds_read_b64_tr_b16 v[28:29], v125 offset:4096
  ds_read_b64_tr_b16 v[30:31], v125 offset:5120
  v_mfma_f32_32x32x16_bf16 v[48:63], v[36:39], v[156:159], v[48:63]
  v_mfma_f32_32x32x16_bf16 v[64:79], v[40:43], v[156:159], v[64:79]
  s_add_u32 s18, s3, 262144
  buffer_load_dwordx4 v[144:147], v2, s[24:27], s18 offen sc1
  s_waitcnt vmcnt(10)
  s_waitcnt lgkmcnt(0)
  ds_read_b64_tr_b16 v[36:37], v124 offset:6144
  ds_read_b64_tr_b16 v[38:39], v124 offset:7168
  ds_read_b64_tr_b16 v[40:41], v125 offset:6144
  ds_read_b64_tr_b16 v[42:43], v125 offset:7168
  v_mfma_f32_32x32x16_bf16 v[48:63], v[24:27], v[160:163], v[48:63]
  v_mfma_f32_32x32x16_bf16 v[64:79], v[28:31], v[160:163], v[64:79]
  s_add_u32 s18, s3, 327680
  buffer_load_dwordx4 v[148:151], v2, s[24:27], s18 offen sc1
  s_waitcnt vmcnt(10)
  s_waitcnt lgkmcnt(0)
  ds_read_b64_tr_b16 v[24:25], v124 offset:8192
  ds_read_b64_tr_b16 v[26:27], v124 offset:9216
  ds_read_b64_tr_b16 v[28:29], v125 offset:8192
  ds_read_b64_tr_b16 v[30:31], v125 offset:9216
  v_mfma_f32_32x32x16_bf16 v[48:63], v[36:39], v[164:167], v[48:63]
  v_mfma_f32_32x32x16_bf16 v[64:79], v[40:43], v[164:167], v[64:79]
  s_cmp_eq_u32 s48, 0
  s_cselect_b32 s46, 1, s46
  s_cmp_lg_u32 s46, 0
  s_cbranch_scc1 b_h2_7_ok
b_h2_7:
  buffer_load_dwordx2 v[16:17], v12, s[32:35], s42 offen sc1
  s_waitcnt vmcnt(0)
  v_cmp_eq_u64 vcc, s[60:61], v[16:17]
  s_nop 0
  s_lshr_b32 s16, vcc_lo, s48
  s_and_b32 s43, s16, s44
  s_and_b32 s46, s16, 0x80
  s_cmp_lg_u32 s46, 0
  s_cbranch_scc1 b_h2_7_ok
  s_sleep 2
  s_sub_u32 s62, s62, 1
  s_cbranch_scc0 b_h2_7
  s_mov_b32 s62, 0
  s_mov_b32 s43, s44
b_h2_7_ok:
  s_mov_b32 s16, 7
  s_mul_i32 s17, s16, 12288
  v_add_u32 v122, s17, v126
  v_add_u32 v123, s17, v127
  s_mul_i32 s17, s16, 6
  s_add_u32 s17, s17, s45
  s_lshl_b32 s8, s17, 16
  s_cmp_eq_u32 s48, 0
  s_cselect_b32 s8, 0x7ff00000, s8
  s_add_u32 s18, s8, 0
  buffer_load_dwordx4 v[152:155], v2, s[24:27], s18 offen sc1
  s_waitcnt vmcnt(10)
  s_waitcnt lgkmcnt(0)
  ds_read_b64_tr_b16 v[36:37], v124 offset:10240
  ds_read_b64_tr_b16 v[38:39], v124 offset:11264
  ds_read_b64_tr_b16 v[40:41], v125 offset:10240
  ds_read_b64_tr_b16 v[42:43], v125 offset:11264
  v_mfma_f32_32x32x16_bf16 v[48:63], v[24:27], v[80:83], v[48:63]
  v_mfma_f32_32x32x16_bf16 v[64:79], v[28:31], v[80:83], v[64:79]
  s_add_u32 s18, s8, 65536
  buffer_load_dwordx4 v[156:159], v2, s[24:27], s18 offen sc1
  s_waitcnt vmcnt(9)
  s_waitcnt lgkmcnt(0)
  ds_read_b64_tr_b16 v[24:25], v120 offset:0
  ds_read_b64_tr_b16 v[26:27], v120 offset:1024
  ds_read_b64_tr_b16 v[28:29], v121 offset:0
  ds_read_b64_tr_b16 v[30:31], v121 offset:1024
  v_mfma_f32_32x32x16_bf16 v[48:63], v[36:39], v[84:87], v[48:63]
  v_mfma_f32_32x32x16_bf16 v[64:79], v[40:43], v[84:87], v[64:79]
  s_waitcnt vmcnt(8)
  s_waitcnt lgkmcnt(0)
  ds_read_b64_tr_b16 v[36:37], v120 offset:2048
  ds_read_b64_tr_b16 v[38:39], v120 offset:3072
  ds_read_b64_tr_b16 v[40:41], v121 offset:2048
  ds_read_b64_tr_b16 v[42:43], v121 offset:3072
  v_mfma_f32_32x32x16_bf16 v[48:63], v[24:27], v[128:131], v[48:63]
  v_mfma_f32_32x32x16_bf16 v[64:79], v[28:31], v[128:131], v[64:79]
  s_waitcnt vmcnt(7)
  s_waitcnt lgkmcnt(0)
  ds_read_b64_tr_b16 v[24:25], v120 offset:4096
  ds_read_b64_tr_b16 v[26:27], v120 offset:5120
  ds_read_b64_tr_b16 v[28:29], v121 offset:4096
  ds_read_b64_tr_b16 v[30:31], v121 offset:5120
  v_mfma_f32_32x32x16_bf16 v[48:63], v[36:39], v[132:135], v[48:63]
  v_mfma_f32_32x32x16_bf16 v[64:79], v[40:43], v[132:135], v[64:79]
  s_waitcnt vmcnt(6)
  s_waitcnt lgkmcnt(0)
  ds_read_b64_tr_b16 v[36:37], v120 offset:6144
  ds_read_b64_tr_b16 v[38:39], v120 offset:7168
  ds_read_b64_tr_b16 v[40:41], v121 offset:6144
  ds_read_b64_tr_b16 v[42:43], v121 offset:7168
  v_mfma_f32_32x32x16_bf16 v[48:63], v[24:27], v[136:139], v[48:63]
  v_mfma_f32_32x32x16_bf16 v[64:79], v[28:31], v[136:139], v[64:79]
  s_waitcnt vmcnt(4)
  s_waitcnt lgkmcnt(0)
  ds_read_b64_tr_b16 v[24:25], v120 offset:8192
  ds_read_b64_tr_b16 v[26:27], v120 offset:9216
  ds_read_b64_tr_b16 v[28:29], v121 offset:8192
  ds_read_b64_tr_b16 v[30:31], v121 offset:9216
  v_mfma_f32_32x32x16_bf16 v[48:63], v[36:39], v[140:143], v[48:63]
  v_mfma_f32_32x32x16_bf16 v[64:79], v[40:43], v[140:143], v[64:79]
  s_waitcnt vmcnt(3)
  s_waitcnt lgkmcnt(0)
  ds_read_b64_tr_b16 v[36:37], v120 offset:10240
  ds_read_b64_tr_b16 v[38:39], v120 offset:11264
  ds_read_b64_tr_b16 v[40:41], v121 offset:10240
  ds_read_b64_tr_b16 v[42:43], v121 offset:11264
  v_mfma_f32_32x32x16_bf16 v[48:63], v[24:27], v[144:147], v[48:63]
  v_mfma_f32_32x32x16_bf16 v[64:79], v[28:31], v[144:147], v[64:79]
  s_waitcnt vmcnt(2)
  s_waitcnt lgkmcnt(0)
  ds_read_b64_tr_b16 v[24:25], v122 offset:0
  ds_read_b64_tr_b16 v[26:27], v122 offset:1024
  ds_read_b64_tr_b16 v[28:29], v123 offset:0
  ds_read_b64_tr_b16 v[30:31], v123 offset:1024
  v_mfma_f32_32x32x16_bf16 v[48:63], v[36:39], v[148:151], v[48:63]
  v_mfma_f32_32x32x16_bf16 v[64:79], v[40:43], v[148:151], v[64:79]
  s_mov_b64 exec, 1
  ds_add_u32 v14, v13 offset:36
  s_mov_b64 exec, -1
  s_cmp_eq_u32 s48, 0
  s_cbranch_scc1 b_w4_done
  s_waitcnt vmcnt(1)
  s_waitcnt lgkmcnt(0)
  ds_read_b64_tr_b16 v[36:37], v122 offset:2048
  ds_read_b64_tr_b16 v[38:39], v122 offset:3072
  ds_read_b64_tr_b16 v[40:41], v123 offset:2048
  ds_read_b64_tr_b16 v[42:43], v123 offset:3072
  v_mfma_f32_32x32x16_bf16 v[48:63], v[24:27], v[152:155], v[48:63]
  v_mfma_f32_32x32x16_bf16 v[64:79], v[28:31], v[152:155], v[64:79]
  s_waitcnt vmcnt(0)
  s_waitcnt lgkmcnt(0)
  v_mfma_f32_32x32x16_bf16 v[48:63], v[36:39], v[156:159], v[48:63]
  v_mfma_f32_32x32x16_bf16 v[64:79], v[40:43], v[156:159], v[64:79]
b_w4_done:
  v_mov_b32 v12, v21
  s_setprio 2
  s_add_u32 s24, s10, 0xa00000
  s_addc_u32 s25, s11, 0
  s_mov_b32 s26, 0x200000
  s_mov_b32 s27, 0x20000
  s_mov_b32 s36, s50
  s_mov_b32 s37, s51
  s_mov_b32 s38, 0x200000
  s_mov_b32 s39, 0x20000
  s_xor_b32 s18, s47, 2048
  s_nop 0
  v_cvt_pk_bf16_f32 v112, v64, v65
  v_cvt_pk_bf16_f32 v113, v66, v67
  v_cvt_pk_bf16_f32 v114, v68, v69
  v_cvt_pk_bf16_f32 v115, v70, v71
  v_cvt_pk_bf16_f32 v116, v72, v73
  v_cvt_pk_bf16_f32 v117, v74, v75
  v_cvt_pk_bf16_f32 v118, v76, v77
  v_cvt_pk_bf16_f32 v119, v78, v79
  buffer_store_dwordx4 v[112:115], v23, s[28:31], s18 offen offset:0 sc1
  buffer_store_dwordx4 v[116:119], v23, s[28:31], s18 offen offset:1024 sc1
  s_mov_b32 s44, 0x11111111
  s_mov_b32 s42, 0
  s_lshr_b32 s43, s18, 4
  s_add_u32 s43, s43, 491520
  v_mov_b32 v96, s60
  v_mov_b32 v97, s61
  v_mov_b32 v98, s60
  v_mov_b32 v99, s61
  v_lshlrev_b32 v100, 4, v1
  s_lshl_b32 s16, s12, 2
  s_add_u32 s16, s16, 156104
  v_mov_b32 v20, s16
  ds_read_b32 v18, v20
  s_waitcnt lgkmcnt(0)
  v_readfirstlane_b32 s16, v18
  s_nop 0
  s_cmp_ge_u32 s16, 18
  s_cbranch_scc1 b_pgate_ok
  s_waitcnt vmcnt(0)
  s_cmp_lg_u32 s42, 0
  s_cbranch_scc1 b_early_told
  s_mov_b64 exec, 0xff
  buffer_store_dwordx4 v[96:99], v100, s[32:35], s43 offen sc1
  s_mov_b64 exec, -1
  s_mov_b32 s42, 1
b_early_told:
b_pgate:
  ds_read_b32 v18, v20 offset:0
  s_waitcnt lgkmcnt(0)
  v_readfirstlane_b32 s16, v18
  s_nop 0
  s_cmp_ge_u32 s16, 18
  s_cbranch_scc1 b_pgate_ok
  s_sleep 2
  s_sub_u32 s62, s62, 1
  s_cbranch_scc0 b_pgate
  s_mov_b32 s62, 0
b_pgate_ok:
  s_mov_b32 s45, 0
  s_mov_b32 s46, 0
  s_cmp_lg_u32 s45, 0
  s_cbranch_scc1 b_h3_0_ok
b_h3_0:
  buffer_load_dwordx2 v[16:17], v12, s[32:35], 0 offen sc1
  s_waitcnt vmcnt(0)
  s_cmp_lg_u32 s42, 0
  s_cbranch_scc1 b_h3_0_told
  s_mov_b64 exec, 0xff
  buffer_store_dwordx4 v[96:99], v100, s[32:35], s43 offen sc1
  s_mov_b64 exec, -1
  s_mov_b32 s42, 1
b_h3_0_told:
  v_cmp_eq_u64 vcc, s[60:61], v[16:17]
  s_nop 0
  s_lshr_b32 s16, vcc_lo, 1
  s_and_b32 s16, s16, vcc_lo
  s_lshr_b32 s17, s16, 2
  s_and_b32 s16, s16, s17
  s_and_b32 s45, s16, s44
  s_mov_b32 s46, vcc_hi
  s_cmp_lg_u32 s45, 0
  s_cbranch_scc1 b_h3_0_ok
  s_sleep 4
  s_sub_u32 s62, s62, 1
  s_cbranch_scc0 b_h3_0
  s_mov_b32 s62, 0
  s_mov_b32 s45, s44
b_h3_0_ok:
  s_lshr_b32 s16, s45, s63
  s_lshl_b32 s16, s16, s63
  s_cselect_b32 s16, s16, s45
  s_ff1_i32_b32 s16, s16
  s_bitset0_b32 s44, s16
  s_bitset0_b32 s45, s16
  s_lshl_b32 s18, s16, 16
  buffer_load_dwordx4 v[128:131], v2, s[24:27], s18 offen sc1
  s_add_u32 s18, s18, 65536
  buffer_load_dwordx4 v[132:135], v2, s[24:27], s18 offen sc1
  s_add_u32 s18, s18, 65536
  buffer_load_dwordx4 v[136:139], v2, s[24:27], s18 offen sc1
  s_add_u32 s18, s18, 65536
  buffer_load_dwordx4 v[140:143], v2, s[24:27], s18 offen sc1
  s_lshl_b32 s16, s16, 10
  s_add_u32 s16, s16, 90112
  v_add_u32 v20, s16, v6
  s_cmp_lg_u32 s45, 0
  s_cbranch_scc1 b_h3_1_ok
b_h3_1:
  buffer_load_dwordx2 v[16:17], v12, s[32:35], 0 offen sc1
  s_waitcnt vmcnt(0)
  s_cmp_lg_u32 s42, 0
  s_cbranch_scc1 b_h3_1_told
  s_mov_b64 exec, 0xff
  buffer_store_dwordx4 v[96:99], v100, s[32:35], s43 offen sc1
  s_mov_b64 exec, -1
  s_mov_b32 s42, 1
b_h3_1_told:
  v_cmp_eq_u64 vcc, s[60:61], v[16:17]
  s_nop 0
  s_lshr_b32 s16, vcc_lo, 1
  s_and_b32 s16, s16, vcc_lo
  s_lshr_b32 s17, s16, 2
  s_and_b32 s16, s16, s17
  s_and_b32 s45, s16, s44
  s_mov_b32 s46, vcc_hi
  s_cmp_lg_u32 s45, 0
  s_cbranch_scc1 b_h3_1_ok
  s_sleep 4
  s_sub_u32 s62, s62, 1
  s_cbranch_scc0 b_h3_1
  s_mov_b32 s62, 0
  s_mov_b32 s45, s44
b_h3_1_ok:
  s_lshr_b32 s16, s45, s63
  s_lshl_b32 s16, s16, s63
  s_cselect_b32 s16, s16, s45
  s_ff1_i32_b32 s16, s16
  s_bitset0_b32 s44, s16
  s_bitset0_b32 s45, s16
  s_lshl_b32 s18, s16, 16
  buffer_load_dwordx4 v[144:147], v2, s[24:27], s18 offen sc1
  s_add_u32 s18, s18, 65536
  buffer_load_dwordx4 v[148:151], v2, s[24:27], s18 offen sc1
  s_add_u32 s18, s18, 65536
  buffer_load_dwordx4 v[152:155], v2, s[24:27], s18 offen sc1
  s_add_u32 s18, s18, 65536
  buffer_load_dwordx4 v[156:159], v2, s[24:27], s18 offen sc1
  s_lshl_b32 s16, s16, 10
  s_add_u32 s16, s16, 90112
  v_add_u32 v21, s16, v6
  s_cmp_lg_u32 s45, 0
  s_cbranch_scc1 b_h3_2_ok
b_h3_2:
  buffer_load_dwordx2 v[16:17], v12, s[32:35], 0 offen sc1
  s_waitcnt vmcnt(0)
  s_cmp_lg_u32 s42, 0
  s_cbranch_scc1 b_h3_2_told
  s_mov_b64 exec, 0xff
  buffer_store_dwordx4 v[96:99], v100, s[32:35], s43 offen sc1
  s_mov_b64 exec, -1
  s_mov_b32 s42, 1
b_h3_2_told:
  v_cmp_eq_u64 vcc, s[60:61], v[16:17]
  s_nop 0
  s_lshr_b32 s16, vcc_lo, 1
  s_and_b32 s16, s16, vcc_lo
  s_lshr_b32 s17, s16, 2
  s_and_b32 s16, s16, s17
  s_and_b32 s45, s16, s44
  s_mov_b32 s46, vcc_hi
  s_cmp_lg_u32 s45, 0
  s_cbranch_scc1 b_h3_2_ok
  s_sleep 4
  s_sub_u32 s62, s62, 1
  s_cbranch_scc0 b_h3_2
  s_mov_b32 s62, 0
  s_mov_b32 s45, s44
b_h3_2_ok:
  s_lshr_b32 s16, s45, s63
  s_lshl_b32 s16, s16, s63
  s_cselect_b32 s16, s16, s45
  s_ff1_i32_b32 s16, s16
  s_bitset0_b32 s44, s16
  s_bitset0_b32 s45, s16
  s_lshl_b32 s18, s16, 16
  buffer_load_dwordx4 v[64:67], v2, s[24:27], s18 offen sc1
  s_add_u32 s18, s18, 65536
  buffer_load_dwordx4 v[68:71], v2, s[24:27], s18 offen sc1
  s_add_u32 s18, s18, 65536
  buffer_load_dwordx4 v[72:75], v2, s[24:27], s18 offen sc1
  s_add_u32 s18, s18, 65536
  buffer_load_dwordx4 v[76:79], v2, s[24:27], s18 offen sc1
  s_lshl_b32 s16, s16, 10
  s_add_u32 s16, s16, 90112
  v_add_u32 v22, s16, v6
b_s6:
  ds_read_b32 v18, v14 offset:36
  s_waitcnt lgkmcnt(0)
  v_readfirstlane_b32 s16, v18
  s_nop 0
  s_cmp_ge_u32 s16, 4
  s_cbranch_scc1 b_s6_ok
  s_sleep 1
  s_sub_u32 s62, s62, 1
  s_cbranch_scc0 b_s6
  s_mov_b32 s62, 0
b_s6_ok:
  ds_read_b64_tr_b16 v[24:25], v20 offset:0
  ds_read_b64_tr_b16 v[26:27], v20 offset:512
  ds_read_b64_tr_b16 v[28:29], v20 offset:1024
  ds_read_b64_tr_b16 v[30:31], v20 offset:1536
  ds_read_b64_tr_b16 v[32:33], v20 offset:2048
  ds_read_b64_tr_b16 v[34:35], v20 offset:2560
  ds_read_b64_tr_b16 v[36:37], v20 offset:3072
  ds_read_b64_tr_b16 v[38:39], v20 offset:3584
  s_waitcnt vmcnt(8)
  s_cmp_lg_u32 s42, 0
  s_cbranch_scc1 b_first_told
  s_mov_b64 exec, 0xff
  buffer_store_dwordx4 v[96:99], v100, s[32:35], s43 offen sc1
  s_mov_b64 exec, -1
  s_mov_b32 s42, 1
b_first_told:
  s_waitcnt lgkmcnt(0)
  ds_read_b64_tr_b16 v[80:81], v21 offset:0
  ds_read_b64_tr_b16 v[82:83], v21 offset:512
  ds_read_b64_tr_b16 v[84:85], v21 offset:1024
  ds_read_b64_tr_b16 v[86:87], v21 offset:1536
  ds_read_b64_tr_b16 v[88:89], v21 offset:2048
  ds_read_b64_tr_b16 v[90:91], v21 offset:2560
  ds_read_b64_tr_b16 v[92:93], v21 offset:3072
  ds_read_b64_tr_b16 v[94:95], v21 offset:3584
  v_mfma_f32_32x32x16_bf16 v[48:63], v[24:27], v[128:131], v[48:63]
  v_mfma_f32_32x32x16_bf16 v[48:63], v[28:31], v[132:135], v[48:63]
  v_mfma_f32_32x32x16_bf16 v[48:63], v[32:35], v[136:139], v[48:63]
  v_mfma_f32_32x32x16_bf16 v[48:63], v[36:39], v[140:143], v[48:63]
  s_cmp_lg_u32 s45, 0
  s_cbranch_scc1 b_h3_3_ok
b_h3_3:
  buffer_load_dwordx2 v[16:17], v12, s[32:35], 0 offen sc1
  s_waitcnt vmcnt(0)
  s_cmp_lg_u32 s42, 0
  s_cbranch_scc1 b_h3_3_told
  s_mov_b64 exec, 0xff
  buffer_store_dwordx4 v[96:99], v100, s[32:35], s43 offen sc1
  s_mov_b64 exec, -1
  s_mov_b32 s42, 1
b_h3_3_told:
  v_cmp_eq_u64 vcc, s[60:61], v[16:17]
  s_nop 0
  s_lshr_b32 s16, vcc_lo, 1
  s_and_b32 s16, s16, vcc_lo
  s_lshr_b32 s17, s16, 2
  s_and_b32 s16, s16, s17
  s_and_b32 s45, s16, s44
  s_mov_b32 s46, vcc_hi
  s_cmp_lg_u32 s45, 0
  s_cbranch_scc1 b_h3_3_ok
  s_sleep 4
  s_sub_u32 s62, s62, 1
  s_cbranch_scc0 b_h3_3
  s_mov_b32 s62, 0
  s_mov_b32 s45, s44
b_h3_3_ok:
  s_lshr_b32 s16, s45, s63
  s_lshl_b32 s16, s16, s63
  s_cselect_b32 s16, s16, s45
  s_ff1_i32_b32 s16, s16
  s_bitset0_b32 s44, s16
  s_bitset0_b32 s45, s16
  s_lshl_b32 s18, s16, 16
  buffer_load_dwordx4 v[128:131], v2, s[24:27], s18 offen sc1
  s_add_u32 s18, s18, 65536
  buffer_load_dwordx4 v[132:135], v2, s[24:27], s18 offen sc1
  s_add_u32 s18, s18, 65536
  buffer_load_dwordx4 v[136:139], v2, s[24:27], s18 offen sc1
  s_add_u32 s18, s18, 65536
  buffer_load_dwordx4 v[140:143], v2, s[24:27], s18 offen sc1
  s_lshl_b32 s16, s16, 10
  s_add_u32 s16, s16, 90112
  v_add_u32 v20, s16, v6
  s_waitcnt vmcnt(8)
  s_waitcnt lgkmcnt(0)
  ds_read_b64_tr_b16 v[24:25], v22 offset:0
  ds_read_b64_tr_b16 v[26:27], v22 offset:512
  ds_read_b64_tr_b16 v[28:29], v22 offset:1024
  ds_read_b64_tr_b16 v[30:31], v22 offset:1536
  ds_read_b64_tr_b16 v[32:33], v22 offset:2048
  ds_read_b64_tr_b16 v[34:35], v22 offset:2560
  ds_read_b64_tr_b16 v[36:37], v22 offset:3072
  ds_read_b64_tr_b16 v[38:39], v22 offset:3584
  v_mfma_f32_32x32x16_bf16 v[48:63], v[80:83], v[144:147], v[48:63]
  v_mfma_f32_32x32x16_bf16 v[48:63], v[84:87], v[148:151], v[48:63]
  v_mfma_f32_32x32x16_bf16 v[48:63], v[88:91], v[152:155], v[48:63]
  v_mfma_f32_32x32x16_bf16 v[48:63], v[92:95], v[156:159], v[48:63]
  s_cmp_lg_u32 s45, 0
  s_cbranch_scc1 b_h3_4_ok
b_h3_4:
  buffer_load_dwordx2 v[16:17], v12, s[32:35], 0 offen sc1
  s_waitcnt vmcnt(0)
  s_cmp_lg_u32 s42, 0
  s_cbranch_scc1 b_h3_4_told
  s_mov_b64 exec, 0xff
  buffer_store_dwordx4 v[96:99], v100, s[32:35], s43 offen sc1
  s_mov_b64 exec, -1
  s_mov_b32 s42, 1
b_h3_4_told:
  v_cmp_eq_u64 vcc, s[60:61], v[16:17]
  s_nop 0
  s_lshr_b32 s16, vcc_lo, 1
  s_and_b32 s16, s16, vcc_lo
  s_lshr_b32 s17, s16, 2
  s_and_b32 s16, s16, s17
  s_and_b32 s45, s16, s44
  s_mov_b32 s46, vcc_hi
  s_cmp_lg_u32 s45, 0
  s_cbranch_scc1 b_h3_4_ok
  s_sleep 4
  s_sub_u32 s62, s62, 1
  s_cbranch_scc0 b_h3_4
  s_mov_b32 s62, 0
  s_mov_b32 s45, s44
b_h3_4_ok:
  s_lshr_b32 s16, s45, s63
  s_lshl_b32 s16, s16, s63
  s_cselect_b32 s16, s16, s45
  s_ff1_i32_b32 s16, s16
  s_bitset0_b32 s44, s16
  s_bitset0_b32 s45, s16
  s_lshl_b32 s18, s16, 16
  buffer_load_dwordx4 v[144:147], v2, s[24:27], s18 offen sc1
  s_add_u32 s18, s18, 65536
  buffer_load_dwordx4 v[148:151], v2, s[24:27], s18 offen sc1
  s_add_u32 s18, s18, 65536
  buffer_load_dwordx4 v[152:155], v2, s[24:27], s18 offen sc1
  s_add_u32 s18, s18, 65536
  buffer_load_dwordx4 v[156:159], v2, s[24:27], s18 offen sc1
  s_lshl_b32 s16, s16, 10
  s_add_u32 s16, s16, 90112
  v_add_u32 v21, s16, v6
  s_waitcnt vmcnt(8)
  s_waitcnt lgkmcnt(0)
  ds_read_b64_tr_b16 v[80:81], v20 offset:0
  ds_read_b64_tr_b16 v[82:83], v20 offset:512
  ds_read_b64_tr_b16 v[84:85], v20 offset:1024
  ds_read_b64_tr_b16 v[86:87], v20 offset:1536
  ds_read_b64_tr_b16 v[88:89], v20 offset:2048
  ds_read_b64_tr_b16 v[90:91], v20 offset:2560
  ds_read_b64_tr_b16 v[92:93], v20 offset:3072
  ds_read_b64_tr_b16 v[94:95], v20 offset:3584
  v_mfma_f32_32x32x16_bf16 v[48:63], v[24:27], v[64:67], v[48:63]
  v_mfma_f32_32x32x16_bf16 v[48:63], v[28:31], v[68:71], v[48:63]
  v_mfma_f32_32x32x16_bf16 v[48:63], v[32:35], v[72:75], v[48:63]
  v_mfma_f32_32x32x16_bf16 v[48:63], v[36:39], v[76:79], v[48:63]
  s_cmp_lg_u32 s45, 0
  s_cbranch_scc1 b_h3_5_ok
b_h3_5:
  buffer_load_dwordx2 v[16:17], v12, s[32:35], 0 offen sc1
  s_waitcnt vmcnt(0)
  s_cmp_lg_u32 s42, 0
  s_cbranch_scc1 b_h3_5_told
  s_mov_b64 exec, 0xff
  buffer_store_dwordx4 v[96:99], v100, s[32:35], s43 offen sc1
  s_mov_b64 exec, -1
  s_mov_b32 s42, 1
b_h3_5_told:
  v_cmp_eq_u64 vcc, s[60:61], v[16:17]
  s_nop 0
  s_lshr_b32 s16, vcc_lo, 1
  s_and_b32 s16, s16, vcc_lo
  s_lshr_b32 s17, s16, 2
  s_and_b32 s16, s16, s17
  s_and_b32 s45, s16, s44
  s_mov_b32 s46, vcc_hi
  s_cmp_lg_u32 s45, 0
  s_cbranch_scc1 b_h3_5_ok
  s_sleep 4
  s_sub_u32 s62, s62, 1
  s_cbranch_scc0 b_h3_5
  s_mov_b32 s62, 0
  s_mov_b32 s45, s44
b_h3_5_ok:
  s_lshr_b32 s16, s45, s63
  s_lshl_b32 s16, s16, s63
  s_cselect_b32 s16, s16, s45
  s_ff1_i32_b32 s16, s16
  s_bitset0_b32 s44, s16
  s_bitset0_b32 s45, s16
  s_lshl_b32 s18, s16, 16
  buffer_load_dwordx4 v[64:67], v2, s[24:27], s18 offen sc1
  s_add_u32 s18, s18, 65536
  buffer_load_dwordx4 v[68:71], v2, s[24:27], s18 offen sc1
  s_add_u32 s18, s18, 65536
  buffer_load_dwordx4 v[72:75], v2, s[24:27], s18 offen sc1
  s_add_u32 s18, s18, 65536
  buffer_load_dwordx4 v[76:79], v2, s[24:27], s18 offen sc1
  s_lshl_b32 s16, s16, 10
  s_add_u32 s16, s16, 90112
  v_add_u32 v22, s16, v6
  s_waitcnt vmcnt(8)
  s_waitcnt lgkmcnt(0)
  ds_read_b64_tr_b16 v[24:25], v21 offset:0
  ds_read_b64_tr_b16 v[26:27], v21 offset:512
  ds_read_b64_tr_b16 v[28:29], v21 offset:1024
  ds_read_b64_tr_b16 v[30:31], v21 offset:1536
  ds_read_b64_tr_b16 v[32:33], v21 offset:2048
  ds_read_b64_tr_b16 v[34:35], v21 offset:2560
  ds_read_b64_tr_b16 v[36:37], v21 offset:3072
  ds_read_b64_tr_b16 v[38:39], v21 offset:3584
  v_mfma_f32_32x32x16_bf16 v[48:63], v[80:83], v[128:131], v[48:63]
  v_mfma_f32_32x32x16_bf16 v[48:63], v[84:87], v[132:135], v[48:63]
  v_mfma_f32_32x32x16_bf16 v[48:63], v[88:91], v[136:139], v[48:63]
  v_mfma_f32_32x32x16_bf16 v[48:63], v[92:95], v[140:143], v[48:63]
  s_cmp_lg_u32 s45, 0
  s_cbranch_scc1 b_h3_6_ok
b_h3_6:
  buffer_load_dwordx2 v[16:17], v12, s[32:35], 0 offen sc1
  s_waitcnt vmcnt(0)
  s_cmp_lg_u32 s42, 0
  s_cbranch_scc1 b_h3_6_told
  s_mov_b64 exec, 0xff
  buffer_store_dwordx4 v[96:99], v100, s[32:35], s43 offen sc1
  s_mov_b64 exec, -1
  s_mov_b32 s42, 1
b_h3_6_told:
  v_cmp_eq_u64 vcc, s[60:61], v[16:17]
  s_nop 0
  s_lshr_b32 s16, vcc_lo, 1
  s_and_b32 s16, s16, vcc_lo
  s_lshr_b32 s17, s16, 2
  s_and_b32 s16, s16, s17
  s_and_b32 s45, s16, s44
  s_mov_b32 s46, vcc_hi
  s_cmp_lg_u32 s45, 0
  s_cbranch_scc1 b_h3_6_ok
  s_sleep 4
  s_sub_u32 s62, s62, 1
  s_cbranch_scc0 b_h3_6
  s_mov_b32 s62, 0
  s_mov_b32 s45, s44
b_h3_6_ok:
  s_lshr_b32 s16, s45, s63
  s_lshl_b32 s16, s16, s63
  s_cselect_b32 s16, s16, s45
  s_ff1_i32_b32 s16, s16
  s_bitset0_b32 s44, s16
  s_bitset0_b32 s45, s16
  s_lshl_b32 s18, s16, 16
  buffer_load_dwordx4 v[128:131], v2, s[24:27], s18 offen sc1
  s_add_u32 s18, s18, 65536
  buffer_load_dwordx4 v[132:135], v2, s[24:27], s18 offen sc1
  s_add_u32 s18, s18, 65536
  buffer_load_dwordx4 v[136:139], v2, s[24:27], s18 offen sc1
  s_add_u32 s18, s18, 65536
  buffer_load_dwordx4 v[140:143], v2, s[24:27], s18 offen sc1
  s_lshl_b32 s16, s16, 10
  s_add_u32 s16, s16, 90112
  v_add_u32 v20, s16, v6
  s_waitcnt vmcnt(8)
  s_waitcnt lgkmcnt(0)
  ds_read_b64_tr_b16 v[80:81], v22 offset:0
  ds_read_b64_tr_b16 v[82:83], v22 offset:512
  ds_read_b64_tr_b16 v[84:85], v22 offset:1024
  ds_read_b64_tr_b16 v[86:87], v22 offset:1536
  ds_read_b64_tr_b16 v[88:89], v22 offset:2048
  ds_read_b64_tr_b16 v[90:91], v22 offset:2560
  ds_read_b64_tr_b16 v[92:93], v22 offset:3072
  ds_read_b64_tr_b16 v[94:95], v22 offset:3584
  v_mfma_f32_32x32x16_bf16 v[48:63], v[24:27], v[144:147], v[48:63]
  v_mfma_f32_32x32x16_bf16 v[48:63], v[28:31], v[148:151], v[48:63]
  v_mfma_f32_32x32x16_bf16 v[48:63], v[32:35], v[152:155], v[48:63]
  v_mfma_f32_32x32x16_bf16 v[48:63], v[36:39], v[156:159], v[48:63]
  s_cmp_lg_u32 s45, 0
  s_cbranch_scc1 b_h3_7_ok
b_h3_7:
  buffer_load_dwordx2 v[16:17], v12, s[32:35], 0 offen sc1
  s_waitcnt vmcnt(0)
  s_cmp_lg_u32 s42, 0
  s_cbranch_scc1 b_h3_7_told
  s_mov_b64 exec, 0xff
  buffer_store_dwordx4 v[96:99], v100, s[32:35], s43 offen sc1
  s_mov_b64 exec, -1
  s_mov_b32 s42, 1
b_h3_7_told:
  v_cmp_eq_u64 vcc, s[60:61], v[16:17]
  s_nop 0
  s_lshr_b32 s16, vcc_lo, 1
  s_and_b32 s16, s16, vcc_lo
  s_lshr_b32 s17, s16, 2
  s_and_b32 s16, s16, s17
  s_and_b32 s45, s16, s44
  s_mov_b32 s46, vcc_hi
  s_cmp_lg_u32 s45, 0
  s_cbranch_scc1 b_h3_7_ok
  s_sleep 4
  s_sub_u32 s62, s62, 1
  s_cbranch_scc0 b_h3_7
  s_mov_b32 s62, 0
  s_mov_b32 s45, s44
b_h3_7_ok:
  s_lshr_b32 s16, s45, s63
  s_lshl_b32 s16, s16, s63
  s_cselect_b32 s16, s16, s45
  s_ff1_i32_b32 s16, s16
  s_bitset0_b32 s44, s16
  s_bitset0_b32 s45, s16
  s_lshl_b32 s18, s16, 16
  buffer_load_dwordx4 v[144:147], v2, s[24:27], s18 offen sc1
  s_add_u32 s18, s18, 65536
  buffer_load_dwordx4 v[148:151], v2, s[24:27], s18 offen sc1
  s_add_u32 s18, s18, 65536
  buffer_load_dwordx4 v[152:155], v2, s[24:27], s18 offen sc1
  s_add_u32 s18, s18, 65536
  buffer_load_dwordx4 v[156:159], v2, s[24:27], s18 offen sc1
  s_lshl_b32 s16, s16, 10
  s_add_u32 s16, s16, 90112
  v_add_u32 v21, s16, v6
  s_cmp_lg_u32 s46, 0
  s_cbranch_scc1 b_h4_ok
b_h4:
  buffer_load_dwordx2 v[16:17], v12, s[32:35], 0 offen sc1
  s_waitcnt vmcnt(0)
  s_cmp_lg_u32 s42, 0
  s_cbranch_scc1 b_h4_told
  s_mov_b64 exec, 0xff
  buffer_store_dwordx4 v[96:99], v100, s[32:35], s43 offen sc1
  s_mov_b64 exec, -1
  s_mov_b32 s42, 1
b_h4_told:
  v_cmp_eq_u64 vcc, s[60:61], v[16:17]
  s_nop 0
  s_lshr_b32 s16, vcc_lo, 1
  s_and_b32 s16, s16, vcc_lo
  s_lshr_b32 s17, s16, 2
  s_and_b32 s16, s16, s17
  s_and_b32 s45, s16, s44
  s_mov_b32 s46, vcc_hi
  s_cmp_lg_u32 s46, 0
  s_cbranch_scc1 b_h4_ok
  s_sleep 4
  s_sub_u32 s62, s62, 1
  s_cbranch_scc0 b_h4
  s_mov_b32 s62, 0
  s_mov_b32 s45, s44
b_h4_ok:
  buffer_load_dwordx4 v[112:115], v23, s[28:31], s47 offen offset:0 sc1
  buffer_load_dwordx4 v[116:119], v23, s[28:31], s47 offen offset:1024 sc1
  s_waitcnt vmcnt(10)
  s_waitcnt lgkmcnt(0)
  ds_read_b64_tr_b16 v[24:25], v20 offset:0
  ds_read_b64_tr_b16 v[26:27], v20 offset:512
  ds_read_b64_tr_b16 v[28:29], v20 offset:1024
  ds_read_b64_tr_b16 v[30:31], v20 offset:1536
  ds_read_b64_tr_b16 v[32:33], v20 offset:2048
  ds_read_b64_tr_b16 v[34:35], v20 offset:2560
  ds_read_b64_tr_b16 v[36:37], v20 offset:3072
  ds_read_b64_tr_b16 v[38:39], v20 offset:3584
  v_mfma_f32_32x32x16_bf16 v[48:63], v[80:83], v[64:67], v[48:63]
  v_mfma_f32_32x32x16_bf16 v[48:63], v[84:87], v[68:71], v[48:63]
  v_mfma_f32_32x32x16_bf16 v[48:63], v[88:91], v[72:75], v[48:63]
  v_mfma_f32_32x32x16_bf16 v[48:63], v[92:95], v[76:79], v[48:63]
  s_waitcnt vmcnt(6)
  s_waitcnt lgkmcnt(0)
  ds_read_b64_tr_b16 v[80:81], v21 offset:0
  ds_read_b64_tr_b16 v[82:83], v21 offset:512
  ds_read_b64_tr_b16 v[84:85], v21 offset:1024
  ds_read_b64_tr_b16 v[86:87], v21 offset:1536
  ds_read_b64_tr_b16 v[88:89], v21 offset:2048
  ds_read_b64_tr_b16 v[90:91], v21 offset:2560
  ds_read_b64_tr_b16 v[92:93], v21 offset:3072
  ds_read_b64_tr_b16 v[94:95], v21 offset:3584
  v_mfma_f32_32x32x16_bf16 v[48:63], v[24:27], v[128:131], v[48:63]
  v_mfma_f32_32x32x16_bf16 v[48:63], v[28:31], v[132:135], v[48:63]
  v_mfma_f32_32x32x16_bf16 v[48:63], v[32:35], v[136:139], v[48:63]
  v_mfma_f32_32x32x16_bf16 v[48:63], v[36:39], v[140:143], v[48:63]
  s_waitcnt vmcnt(2)
  s_waitcnt lgkmcnt(0)
  v_mfma_f32_32x32x16_bf16 v[48:63], v[80:83], v[144:147], v[48:63]
  v_mfma_f32_32x32x16_bf16 v[48:63], v[84:87], v[148:151], v[48:63]
  v_mfma_f32_32x32x16_bf16 v[48:63], v[88:91], v[152:155], v[48:63]
  v_mfma_f32_32x32x16_bf16 v[48:63], v[92:95], v[156:159], v[48:63]
  s_waitcnt vmcnt(0)
  v_lshlrev_b32 v24, 16, v112
  v_and_b32 v25, 0xffff0000, v112
  v_lshlrev_b32 v26, 16, v113
  v_and_b32 v27, 0xffff0000, v113
  v_lshlrev_b32 v28, 16, v114
  v_and_b32 v29, 0xffff0000, v114
  v_lshlrev_b32 v30, 16, v115
  v_and_b32 v31, 0xffff0000, v115
  v_lshlrev_b32 v32, 16, v116
  v_and_b32 v33, 0xffff0000, v116
  v_lshlrev_b32 v34, 16, v117
  v_and_b32 v35, 0xffff0000, v117
  v_lshlrev_b32 v36, 16, v118
  v_and_b32 v37, 0xffff0000, v118
  v_lshlrev_b32 v38, 16, v119
  v_and_b32 v39, 0xffff0000, v119
  v_add_f32 v48, v48, v24
  v_add_f32 v49, v49, v25
  v_add_f32 v50, v50, v26
  v_add_f32 v51, v51, v27
  v_add_f32 v52, v52, v28
  v_add_f32 v53, v53, v29
  v_add_f32 v54, v54, v30
  v_add_f32 v55, v55, v31
  v_add_f32 v56, v56, v32
  v_add_f32 v57, v57, v33
  v_add_f32 v58, v58, v34
  v_add_f32 v59, v59, v35
  v_add_f32 v60, v60, v36
  v_add_f32 v61, v61, v37
  v_add_f32 v62, v62, v38
  v_add_f32 v63, v63, v39
  v_cvt_pk_bf16_f32 v112, v48, v49
  v_cvt_pk_bf16_f32 v113, v50, v51
  v_cvt_pk_bf16_f32 v114, v52, v53
  v_cvt_pk_bf16_f32 v115, v54, v55
  v_cvt_pk_bf16_f32 v116, v56, v57
  v_cvt_pk_bf16_f32 v117, v58, v59
  v_cvt_pk_bf16_f32 v118, v60, v61
  v_cvt_pk_bf16_f32 v119, v62, v63
  v_permlane32_swap_b32 v112, v114
  v_permlane32_swap_b32 v113, v115
  buffer_store_dwordx4 v[112:115], v5, s[36:39], s41 offen offset:0
  v_permlane32_swap_b32 v116, v118
  v_permlane32_swap_b32 v117, v119
  buffer_store_dwordx4 v[116:119], v5, s[36:39], s41 offen offset:32
  s_endpgm
p1_type0:
  v_lshrrev_b32 v10, 4, v1
  v_xor_b32 v10, v10, v1
  v_and_b32 v10, 1, v10
  v_cmp_eq_u32 vcc, 0, v10
  v_mov_b32 v10, 0x3f803f80
  s_lshl_b32 s17, s12, 8
  s_add_u32 s17, s17, 107008
  v_cndmask_b32 v44, 0, v10, vcc
  v_cndmask_b32 v45, 0, v10, vcc
  v_cndmask_b32 v46, 0, v10, vcc
  v_cndmask_b32 v47, 0, v10, vcc
  v_lshl_add_u32 v10, v2, 3, s17
  v_xor_b32 v11, 256, v10
  s_lshl1_add_u32 s32, s15, s19
  s_lshl_b32 s32, s32, 17
  s_add_u32 s33, s32, 65536
  s_lshl2_add_u32 s34, s13, s41
  v_mov_b32 v150, 156088
  s_lshl_b32 s17, s41, 10
  s_add_u32 s17, s17, 98304
  v_lshl_add_u32 v148, v1, 4, s17
  v_xor_b32 v149, 1024, v148
  s_add_u32 s36, s10, 0x1300000
  s_addc_u32 s37, s11, 0
  s_mov_b32 s38, 0x9c000
  s_mov_b32 s39, 0x20000
  s_mov_b32 s20, s10
  s_mov_b32 s21, s11
  s_mov_b32 s22, 0x200000
  s_mov_b32 s23, 0x20000
  s_add_u32 s24, s10, 0x400000
  s_addc_u32 s25, s11, 0
  s_mov_b32 s26, 0x200000
  s_mov_b32 s27, 0x20000
  s_lshl_b32 s17, s34, 5
  v_and_b32 v5, 31, v1
  v_add_u32 v5, s17, v5
  v_lshrrev_b32 v6, 5, v1
  v_lshlrev_b32 v4, 15, v6
  v_lshl_add_u32 v4, v5, 4, v4
  v_xor_b32 v5, 512, v4
  s_lshl_b32 s17, s41, 7
  s_add_u32 s17, s17, 106496
  v_lshl_add_u32 v2, v6, 4, s17
  v_xor_b32 v9, 128, v2
  v_and_b32 v3, 31, v1
  v_lshl_add_u32 v3, v3, 2, s17
  v_bfe_u32 v7, v1, 4, 1
  v_lshlrev_b32 v7, 16, v7
  v_lshl_add_u32 v7, v6, 8, v7
  v_and_b32 v8, 15, v1
  v_lshl_add_u32 v7, v8, 4, v7
  s_lshl_b32 s17, s34, 10
  v_add_u32 v7, s17, v7
  v_xor_b32 v8, 1024, v7
  s_barrier
  ds_read_b128 v[12:15], v152 offset:0
  ds_read_b128 v[16:19], v156 offset:0
  ds_read_b64_tr_b16 v[20:21], v120 offset:0
  ds_read_b64_tr_b16 v[22:23], v120 offset:512
  ds_read_b64_tr_b16 v[24:25], v120 offset:8192
  ds_read_b64_tr_b16 v[26:27], v120 offset:8704
  s_waitcnt lgkmcnt(0)
  v_mfma_f32_32x32x16_bf16 v[52:67], v[20:23], v[12:15], 0
  ds_read_b128 v[28:31], v153 offset:0
  ds_read_b128 v[32:35], v157 offset:0
  v_lshlrev_b32 v144, 16, v12
  v_and_b32 v145, s35, v12
  v_fmac_f32 v48, v144, v144
  v_mfma_f32_32x32x16_bf16 v[68:83], v[20:23], v[16:19], 0
  ds_read_b64_tr_b16 v[36:37], v120 offset:2048
  ds_read_b64_tr_b16 v[38:39], v120 offset:2560
  v_fmac_f32 v49, v145, v145
  v_lshlrev_b32 v146, 16, v13
  v_and_b32 v147, s35, v13
  v_mfma_f32_32x32x16_bf16 v[84:99], v[12:15], v[24:27], 0
  ds_read_b64_tr_b16 v[40:41], v120 offset:10240
  ds_read_b64_tr_b16 v[42:43], v120 offset:10752
  v_fmac_f32 v48, v146, v146
  v_fmac_f32 v49, v147, v147
  v_mfma_f32_32x32x16_bf16 v[100:115], v[16:19], v[24:27], 0
  v_lshlrev_b32 v144, 16, v14
  v_and_b32 v145, s35, v14
  v_fmac_f32 v48, v144, v144
  v_fmac_f32 v49, v145, v145
  v_lshlrev_b32 v146, 16, v15
  v_and_b32 v147, s35, v15
  v_mfma_f32_16x16x32_bf16 v[116:119], v[44:47], v[12:15], 0
  v_fmac_f32 v48, v146, v146
  v_fmac_f32 v49, v147, v147
  v_mfma_f32_16x16x32_bf16 v[124:127], v[44:47], v[20:23], 0
  v_mfma_f32_16x16x32_bf16 v[128:131], v[44:47], v[24:27], 0
  s_waitcnt lgkmcnt(0)
  v_mfma_f32_32x32x16_bf16 v[52:67], v[36:39], v[28:31], v[52:67]
  ds_read_b128 v[12:15], v154 offset:0
  ds_read_b128 v[16:19], v158 offset:0
  v_lshlrev_b32 v144, 16, v28
  v_and_b32 v145, s35, v28
  v_fmac_f32 v48, v144, v144
  v_mfma_f32_32x32x16_bf16 v[68:83], v[36:39], v[32:35], v[68:83]
  ds_read_b64_tr_b16 v[20:21], v121 offset:0
  ds_read_b64_tr_b16 v[22:23], v121 offset:512
  v_fmac_f32 v49, v145, v145
  v_lshlrev_b32 v146, 16, v29
  v_and_b32 v147, s35, v29
  v_mfma_f32_32x32x16_bf16 v[84:99], v[28:31], v[40:43], v[84:99]
  ds_read_b64_tr_b16 v[24:25], v121 offset:8192
  ds_read_b64_tr_b16 v[26:27], v121 offset:8704
  v_fmac_f32 v48, v146, v146
  v_fmac_f32 v49, v147, v147
  v_mfma_f32_32x32x16_bf16 v[100:115], v[32:35], v[40:43], v[100:115]
  v_lshlrev_b32 v144, 16, v30
  v_and_b32 v145, s35, v30
  v_fmac_f32 v48, v144, v144
  v_fmac_f32 v49, v145, v145
  v_lshlrev_b32 v146, 16, v31
  v_and_b32 v147, s35, v31
  v_mfma_f32_16x16x32_bf16 v[116:119], v[44:47], v[28:31], v[116:119]
  v_fmac_f32 v48, v146, v146
  v_fmac_f32 v49, v147, v147
  v_mfma_f32_16x16x32_bf16 v[124:127], v[44:47], v[36:39], v[124:127]
  v_mfma_f32_16x16x32_bf16 v[128:131], v[44:47], v[40:43], v[128:131]
  s_waitcnt lgkmcnt(0)
  v_mfma_f32_32x32x16_bf16 v[52:67], v[20:23], v[12:15], v[52:67]
  ds_read_b128 v[28:31], v155 offset:0
  ds_read_b128 v[32:35], v159 offset:0
  v_lshlrev_b32 v144, 16, v12
  v_and_b32 v145, s35, v12
  v_fmac_f32 v48, v144, v144
  v_mfma_f32_32x32x16_bf16 v[68:83], v[20:23], v[16:19], v[68:83]
  ds_read_b64_tr_b16 v[36:37], v121 offset:2048
  ds_read_b64_tr_b16 v[38:39], v121 offset:2560
  v_fmac_f32 v49, v145, v145
  v_lshlrev_b32 v146, 16, v13
  v_and_b32 v147, s35, v13
  v_mfma_f32_32x32x16_bf16 v[84:99], v[12:15], v[24:27], v[84:99]
  ds_read_b64_tr_b16 v[40:41], v121 offset:10240
  ds_read_b64_tr_b16 v[42:43], v121 offset:10752
  v_fmac_f32 v48, v146, v146
  v_fmac_f32 v49, v147, v147
  v_mfma_f32_32x32x16_bf16 v[100:115], v[16:19], v[24:27], v[100:115]
  v_lshlrev_b32 v144, 16, v14
  v_and_b32 v145, s35, v14
  v_fmac_f32 v48, v144, v144
  v_fmac_f32 v49, v145, v145
  v_lshlrev_b32 v146, 16, v15
  v_and_b32 v147, s35, v15
  v_mfma_f32_16x16x32_bf16 v[116:119], v[44:47], v[12:15], v[116:119]
  v_fmac_f32 v48, v146, v146
  v_fmac_f32 v49, v147, v147
  s_waitcnt lgkmcnt(0)
  v_mfma_f32_32x32x16_bf16 v[52:67], v[36:39], v[28:31], v[52:67]
  s_barrier
  ds_read_b128 v[12:15], v152 offset:32768
  ds_read_b128 v[16:19], v156 offset:32768
  v_lshlrev_b32 v144, 16, v28
  v_and_b32 v145, s35, v28
  v_fmac_f32 v48, v144, v144
  v_mfma_f32_32x32x16_bf16 v[68:83], v[36:39], v[32:35], v[68:83]
  ds_read_b64_tr_b16 v[20:21], v120 offset:32768
  ds_read_b64_tr_b16 v[22:23], v120 offset:33280
  v_fmac_f32 v49, v145, v145
  v_lshlrev_b32 v146, 16, v29
  v_and_b32 v147, s35, v29
  v_mfma_f32_32x32x16_bf16 v[84:99], v[28:31], v[40:43], v[84:99]
  ds_read_b64_tr_b16 v[24:25], v120 offset:40960
  ds_read_b64_tr_b16 v[26:27], v120 offset:41472
  v_fmac_f32 v48, v146, v146
  v_fmac_f32 v49, v147, v147
  v_mfma_f32_32x32x16_bf16 v[100:115], v[32:35], v[40:43], v[100:115]
  v_lshlrev_b32 v144, 16, v30
  v_and_b32 v145, s35, v30
  v_fmac_f32 v48, v144, v144
  v_fmac_f32 v49, v145, v145
  v_lshlrev_b32 v146, 16, v31
  v_and_b32 v147, s35, v31
  v_mfma_f32_16x16x32_bf16 v[116:119], v[44:47], v[28:31], v[116:119]
  v_fmac_f32 v48, v146, v146
  v_fmac_f32 v49, v147, v147
  s_waitcnt lgkmcnt(0)
  v_mfma_f32_32x32x16_bf16 v[52:67], v[20:23], v[12:15], v[52:67]
  ds_read_b128 v[28:31], v153 offset:32768
  ds_read_b128 v[32:35], v157 offset:32768
  v_lshlrev_b32 v144, 16, v12
  v_and_b32 v145, s35, v12
  v_fmac_f32 v48, v144, v144
  v_mfma_f32_32x32x16_bf16 v[68:83], v[20:23], v[16:19], v[68:83]
  ds_read_b64_tr_b16 v[36:37], v120 offset:34816
  ds_read_b64_tr_b16 v[38:39], v120 offset:35328
  v_fmac_f32 v49, v145, v145
  v_lshlrev_b32 v146, 16, v13
  v_and_b32 v147, s35, v13
  v_mfma_f32_32x32x16_bf16 v[84:99], v[12:15], v[24:27], v[84:99]
  ds_read_b64_tr_b16 v[40:41], v120 offset:43008
  ds_read_b64_tr_b16 v[42:43], v120 offset:43520
  v_fmac_f32 v48, v146, v146
  v_fmac_f32 v49, v147, v147
  v_mfma_f32_32x32x16_bf16 v[100:115], v[16:19], v[24:27], v[100:115]
  v_lshlrev_b32 v144, 16, v14
  v_and_b32 v145, s35, v14
  v_fmac_f32 v48, v144, v144
  v_fmac_f32 v49, v145, v145
  v_lshlrev_b32 v146, 16, v15
  v_and_b32 v147, s35, v15
  v_mfma_f32_16x16x32_bf16 v[116:119], v[44:47], v[12:15], v[116:119]
  v_fmac_f32 v48, v146, v146
  v_fmac_f32 v49, v147, v147
  v_mfma_f32_16x16x32_bf16 v[124:127], v[44:47], v[20:23], v[124:127]
  v_mfma_f32_16x16x32_bf16 v[128:131], v[44:47], v[24:27], v[128:131]
  s_waitcnt lgkmcnt(0)
  v_mfma_f32_32x32x16_bf16 v[52:67], v[36:39], v[28:31], v[52:67]
  ds_read_b128 v[12:15], v154 offset:32768
  ds_read_b128 v[16:19], v158 offset:32768
  v_lshlrev_b32 v144, 16, v28
  v_and_b32 v145, s35, v28
  v_fmac_f32 v48, v144, v144
  v_mfma_f32_32x32x16_bf16 v[68:83], v[36:39], v[32:35], v[68:83]
  ds_read_b64_tr_b16 v[20:21], v121 offset:32768
  ds_read_b64_tr_b16 v[22:23], v121 offset:33280
  v_fmac_f32 v49, v145, v145
  v_lshlrev_b32 v146, 16, v29
  v_and_b32 v147, s35, v29
  v_mfma_f32_32x32x16_bf16 v[84:99], v[28:31], v[40:43], v[84:99]
  ds_read_b64_tr_b16 v[24:25], v121 offset:40960
  ds_read_b64_tr_b16 v[26:27], v121 offset:41472
  v_fmac_f32 v48, v146, v146
  v_fmac_f32 v49, v147, v147
  v_mfma_f32_32x32x16_bf16 v[100:115], v[32:35], v[40:43], v[100:115]
  v_lshlrev_b32 v144, 16, v30
  v_and_b32 v145, s35, v30
  v_fmac_f32 v48, v144, v144
  v_fmac_f32 v49, v145, v145
  v_lshlrev_b32 v146, 16, v31
  v_and_b32 v147, s35, v31
  v_mfma_f32_16x16x32_bf16 v[116:119], v[44:47], v[28:31], v[116:119]
  v_fmac_f32 v48, v146, v146
  v_fmac_f32 v49, v147, v147
  v_mfma_f32_16x16x32_bf16 v[124:127], v[44:47], v[36:39], v[124:127]
  v_mfma_f32_16x16x32_bf16 v[128:131], v[44:47], v[40:43], v[128:131]
  s_waitcnt lgkmcnt(0)
  v_mfma_f32_32x32x16_bf16 v[52:67], v[20:23], v[12:15], v[52:67]
  ds_read_b128 v[28:31], v155 offset:32768
  ds_read_b128 v[32:35], v159 offset:32768
  v_lshlrev_b32 v144, 16, v12
  v_and_b32 v145, s35, v12
  v_fmac_f32 v48, v144, v144
  v_mfma_f32_32x32x16_bf16 v[68:83], v[20:23], v[16:19], v[68:83]
  ds_read_b64_tr_b16 v[36:37], v121 offset:34816
  ds_read_b64_tr_b16 v[38:39], v121 offset:35328
  v_fmac_f32 v49, v145, v145
  v_lshlrev_b32 v146, 16, v13
  v_and_b32 v147, s35, v13
  v_mfma_f32_32x32x16_bf16 v[84:99], v[12:15], v[24:27], v[84:99]
  ds_read_b64_tr_b16 v[40:41], v121 offset:43008
  ds_read_b64_tr_b16 v[42:43], v121 offset:43520
  v_fmac_f32 v48, v146, v146
  v_fmac_f32 v49, v147, v147
  v_mfma_f32_32x32x16_bf16 v[100:115], v[16:19], v[24:27], v[100:115]
  v_lshlrev_b32 v144, 16, v14
  v_and_b32 v145, s35, v14
  v_fmac_f32 v48, v144, v144
  v_fmac_f32 v49, v145, v145
  v_lshlrev_b32 v146, 16, v15
  v_and_b32 v147, s35, v15
  v_mfma_f32_16x16x32_bf16 v[116:119], v[44:47], v[12:15], v[116:119]
  v_fmac_f32 v48, v146, v146
  v_fmac_f32 v49, v147, v147
  s_waitcnt lgkmcnt(0)
  v_mfma_f32_32x32x16_bf16 v[52:67], v[36:39], v[28:31], v[52:67]
  s_barrier
  ds_read_b128 v[12:15], v160 offset:0
  ds_read_b128 v[16:19], v164 offset:0
  v_lshlrev_b32 v144, 16, v28
  v_and_b32 v145, s35, v28
  v_fmac_f32 v48, v144, v144
  v_mfma_f32_32x32x16_bf16 v[68:83], v[36:39], v[32:35], v[68:83]
  ds_read_b64_tr_b16 v[20:21], v122 offset:0
  ds_read_b64_tr_b16 v[22:23], v122 offset:512
  v_fmac_f32 v49, v145, v145
  v_lshlrev_b32 v146, 16, v29
  v_and_b32 v147, s35, v29
  v_mfma_f32_32x32x16_bf16 v[84:99], v[28:31], v[40:43], v[84:99]
  ds_read_b64_tr_b16 v[24:25], v122 offset:8192
  ds_read_b64_tr_b16 v[26:27], v122 offset:8704
  v_fmac_f32 v48, v146, v146
  v_fmac_f32 v49, v147, v147
  v_mfma_f32_32x32x16_bf16 v[100:115], v[32:35], v[40:43], v[100:115]
  v_lshlrev_b32 v144, 16, v30
  v_and_b32 v145, s35, v30
  v_fmac_f32 v48, v144, v144
  v_fmac_f32 v49, v145, v145
  v_lshlrev_b32 v146, 16, v31
  v_and_b32 v147, s35, v31
  v_mfma_f32_16x16x32_bf16 v[116:119], v[44:47], v[28:31], v[116:119]
  v_fmac_f32 v48, v146, v146
  v_fmac_f32 v49, v147, v147
  s_waitcnt lgkmcnt(0)
  v_mfma_f32_32x32x16_bf16 v[52:67], v[20:23], v[12:15], v[52:67]
  ds_read_b128 v[28:31], v161 offset:0
  ds_read_b128 v[32:35], v165 offset:0
  v_lshlrev_b32 v144, 16, v12
  v_and_b32 v145, s35, v12
  v_fmac_f32 v48, v144, v144
  v_mfma_f32_32x32x16_bf16 v[68:83], v[20:23], v[16:19], v[68:83]
  ds_read_b64_tr_b16 v[36:37], v122 offset:2048
  ds_read_b64_tr_b16 v[38:39], v122 offset:2560
  v_fmac_f32 v49, v145, v145
  v_lshlrev_b32 v146, 16, v13
  v_and_b32 v147, s35, v13
  v_mfma_f32_32x32x16_bf16 v[84:99], v[12:15], v[24:27], v[84:99]
  ds_read_b64_tr_b16 v[40:41], v122 offset:10240
  ds_read_b64_tr_b16 v[42:43], v122 offset:10752
  v_fmac_f32 v48, v146, v146
  v_fmac_f32 v49, v147, v147
  v_mfma_f32_32x32x16_bf16 v[100:115], v[16:19], v[24:27], v[100:115]
  v_lshlrev_b32 v144, 16, v14
  v_and_b32 v145, s35, v14
  v_fmac_f32 v48, v144, v144
  v_fmac_f32 v49, v145, v145
  v_lshlrev_b32 v146, 16, v15
  v_and_b32 v147, s35, v15
  v_mfma_f32_16x16x32_bf16 v[116:119], v[44:47], v[12:15], v[116:119]
  v_fmac_f32 v48, v146, v146
  v_fmac_f32 v49, v147, v147
  v_mfma_f32_16x16x32_bf16 v[124:127], v[44:47], v[20:23], v[124:127]
  v_mfma_f32_16x16x32_bf16 v[128:131], v[44:47], v[24:27], v[128:131]
  s_waitcnt lgkmcnt(0)
  v_mfma_f32_32x32x16_bf16 v[52:67], v[36:39], v[28:31], v[52:67]
  ds_read_b128 v[12:15], v162 offset:0
  ds_read_b128 v[16:19], v166 offset:0
  v_lshlrev_b32 v144, 16, v28
  v_and_b32 v145, s35, v28
  v_fmac_f32 v48, v144, v144
  v_mfma_f32_32x32x16_bf16 v[68:83], v[36:39], v[32:35], v[68:83]
  ds_read_b64_tr_b16 v[20:21], v123 offset:0
  ds_read_b64_tr_b16 v[22:23], v123 offset:512
  v_fmac_f32 v49, v145, v145
  v_lshlrev_b32 v146, 16, v29
  v_and_b32 v147, s35, v29
  v_mfma_f32_32x32x16_bf16 v[84:99], v[28:31], v[40:43], v[84:99]
  ds_read_b64_tr_b16 v[24:25], v123 offset:8192
  ds_read_b64_tr_b16 v[26:27], v123 offset:8704
  v_fmac_f32 v48, v146, v146
  v_fmac_f32 v49, v147, v147
  v_mfma_f32_32x32x16_bf16 v[100:115], v[32:35], v[40:43], v[100:115]
  v_lshlrev_b32 v144, 16, v30
  v_and_b32 v145, s35, v30
  v_fmac_f32 v48, v144, v144
  v_fmac_f32 v49, v145, v145
  v_lshlrev_b32 v146, 16, v31
  v_and_b32 v147, s35, v31
  v_mfma_f32_16x16x32_bf16 v[116:119], v[44:47], v[28:31], v[116:119]
  v_fmac_f32 v48, v146, v146
  v_fmac_f32 v49, v147, v147
  v_mfma_f32_16x16x32_bf16 v[124:127], v[44:47], v[36:39], v[124:127]
  v_mfma_f32_16x16x32_bf16 v[128:131], v[44:47], v[40:43], v[128:131]
  s_waitcnt lgkmcnt(0)
  v_mfma_f32_32x32x16_bf16 v[52:67], v[20:23], v[12:15], v[52:67]
  ds_read_b128 v[28:31], v163 offset:0
  ds_read_b128 v[32:35], v167 offset:0
  v_lshlrev_b32 v144, 16, v12
  v_and_b32 v145, s35, v12
  v_fmac_f32 v48, v144, v144
  v_mfma_f32_32x32x16_bf16 v[68:83], v[20:23], v[16:19], v[68:83]
  ds_read_b64_tr_b16 v[36:37], v123 offset:2048
  ds_read_b64_tr_b16 v[38:39], v123 offset:2560
  v_fmac_f32 v49, v145, v145
  v_lshlrev_b32 v146, 16, v13
  v_and_b32 v147, s35, v13
  v_mfma_f32_32x32x16_bf16 v[84:99], v[12:15], v[24:27], v[84:99]
  ds_read_b64_tr_b16 v[40:41], v123 offset:10240
  ds_read_b64_tr_b16 v[42:43], v123 offset:10752
  v_fmac_f32 v48, v146, v146
  v_fmac_f32 v49, v147, v147
  v_mfma_f32_32x32x16_bf16 v[100:115], v[16:19], v[24:27], v[100:115]
  v_lshlrev_b32 v144, 16, v14
  v_and_b32 v145, s35, v14
  v_fmac_f32 v48, v144, v144
  v_fmac_f32 v49, v145, v145
  v_lshlrev_b32 v146, 16, v15
  v_and_b32 v147, s35, v15
  v_mfma_f32_16x16x32_bf16 v[116:119], v[44:47], v[12:15], v[116:119]
  v_fmac_f32 v48, v146, v146
  v_fmac_f32 v49, v147, v147
  s_waitcnt lgkmcnt(0)
  v_mfma_f32_32x32x16_bf16 v[52:67], v[36:39], v[28:31], v[52:67]
  s_barrier
  ds_read_b128 v[12:15], v152 offset:0
  ds_read_b128 v[16:19], v156 offset:0
  v_lshlrev_b32 v144, 16, v28
  v_and_b32 v145, s35, v28
  v_fmac_f32 v48, v144, v144
  v_mfma_f32_32x32x16_bf16 v[68:83], v[36:39], v[32:35], v[68:83]
  ds_read_b64_tr_b16 v[20:21], v120 offset:0
  ds_read_b64_tr_b16 v[22:23], v120 offset:512
  v_fmac_f32 v49, v145, v145
  v_lshlrev_b32 v146, 16, v29
  v_and_b32 v147, s35, v29
  v_mfma_f32_32x32x16_bf16 v[84:99], v[28:31], v[40:43], v[84:99]
  ds_read_b64_tr_b16 v[24:25], v120 offset:8192
  ds_read_b64_tr_b16 v[26:27], v120 offset:8704
  v_fmac_f32 v48, v146, v146
  v_fmac_f32 v49, v147, v147
  v_mfma_f32_32x32x16_bf16 v[100:115], v[32:35], v[40:43], v[100:115]
  v_lshlrev_b32 v144, 16, v30
  v_and_b32 v145, s35, v30
  v_fmac_f32 v48, v144, v144
  v_fmac_f32 v49, v145, v145
  v_lshlrev_b32 v146, 16, v31
  v_and_b32 v147, s35, v31
  v_mfma_f32_16x16x32_bf16 v[116:119], v[44:47], v[28:31], v[116:119]
  v_fmac_f32 v48, v146, v146
  v_fmac_f32 v49, v147, v147
  s_waitcnt lgkmcnt(0)
  v_mfma_f32_32x32x16_bf16 v[52:67], v[20:23], v[12:15], v[52:67]
  ds_read_b128 v[28:31], v153 offset:0
  ds_read_b128 v[32:35], v157 offset:0
  v_lshlrev_b32 v144, 16, v12
  v_and_b32 v145, s35, v12
  v_fmac_f32 v48, v144, v144
  v_mfma_f32_32x32x16_bf16 v[68:83], v[20:23], v[16:19], v[68:83]
  ds_read_b64_tr_b16 v[36:37], v120 offset:2048
  ds_read_b64_tr_b16 v[38:39], v120 offset:2560
  v_fmac_f32 v49, v145, v145
  v_lshlrev_b32 v146, 16, v13
  v_and_b32 v147, s35, v13
  v_mfma_f32_32x32x16_bf16 v[84:99], v[12:15], v[24:27], v[84:99]
  ds_read_b64_tr_b16 v[40:41], v120 offset:10240
  ds_read_b64_tr_b16 v[42:43], v120 offset:10752
  v_fmac_f32 v48, v146, v146
  v_fmac_f32 v49, v147, v147
  v_mfma_f32_32x32x16_bf16 v[100:115], v[16:19], v[24:27], v[100:115]
  v_lshlrev_b32 v144, 16, v14
  v_and_b32 v145, s35, v14
  v_fmac_f32 v48, v144, v144
  v_fmac_f32 v49, v145, v145
  v_lshlrev_b32 v146, 16, v15
  v_and_b32 v147, s35, v15
  v_mfma_f32_16x16x32_bf16 v[116:119], v[44:47], v[12:15], v[116:119]
  v_fmac_f32 v48, v146, v146
  v_fmac_f32 v49, v147, v147
  v_mfma_f32_16x16x32_bf16 v[124:127], v[44:47], v[20:23], v[124:127]
  v_mfma_f32_16x16x32_bf16 v[128:131], v[44:47], v[24:27], v[128:131]
  s_waitcnt lgkmcnt(0)
  v_mfma_f32_32x32x16_bf16 v[52:67], v[36:39], v[28:31], v[52:67]
  ds_read_b128 v[12:15], v154 offset:0
  ds_read_b128 v[16:19], v158 offset:0
  v_lshlrev_b32 v144, 16, v28
  v_and_b32 v145, s35, v28
  v_fmac_f32 v48, v144, v144
  v_mfma_f32_32x32x16_bf16 v[68:83], v[36:39], v[32:35], v[68:83]
  ds_read_b64_tr_b16 v[20:21], v121 offset:0
  ds_read_b64_tr_b16 v[22:23], v121 offset:512
  v_fmac_f32 v49, v145, v145
  v_lshlrev_b32 v146, 16, v29
  v_and_b32 v147, s35, v29
  v_mfma_f32_32x32x16_bf16 v[84:99], v[28:31], v[40:43], v[84:99]
  ds_read_b64_tr_b16 v[24:25], v121 offset:8192
  ds_read_b64_tr_b16 v[26:27], v121 offset:8704
  v_fmac_f32 v48, v146, v146
  v_fmac_f32 v49, v147, v147
  v_mfma_f32_32x32x16_bf16 v[100:115], v[32:35], v[40:43], v[100:115]
  v_lshlrev_b32 v144, 16, v30
  v_and_b32 v145, s35, v30
  v_fmac_f32 v48, v144, v144
  v_fmac_f32 v49, v145, v145
  v_lshlrev_b32 v146, 16, v31
  v_and_b32 v147, s35, v31
  v_mfma_f32_16x16x32_bf16 v[116:119], v[44:47], v[28:31], v[116:119]
  v_fmac_f32 v48, v146, v146
  v_fmac_f32 v49, v147, v147
  v_mfma_f32_16x16x32_bf16 v[124:127], v[44:47], v[36:39], v[124:127]
  v_mfma_f32_16x16x32_bf16 v[128:131], v[44:47], v[40:43], v[128:131]
  s_waitcnt lgkmcnt(0)
  v_mfma_f32_32x32x16_bf16 v[52:67], v[20:23], v[12:15], v[52:67]
  ds_read_b128 v[28:31], v155 offset:0
  ds_read_b128 v[32:35], v159 offset:0
  v_lshlrev_b32 v144, 16, v12
  v_and_b32 v145, s35, v12
  v_fmac_f32 v48, v144, v144
  v_mfma_f32_32x32x16_bf16 v[68:83], v[20:23], v[16:19], v[68:83]
  ds_read_b64_tr_b16 v[36:37], v121 offset:2048
  ds_read_b64_tr_b16 v[38:39], v121 offset:2560
  v_fmac_f32 v49, v145, v145
  v_lshlrev_b32 v146, 16, v13
  v_and_b32 v147, s35, v13
  v_mfma_f32_32x32x16_bf16 v[84:99], v[12:15], v[24:27], v[84:99]
  ds_read_b64_tr_b16 v[40:41], v121 offset:10240
  ds_read_b64_tr_b16 v[42:43], v121 offset:10752
  v_fmac_f32 v48, v146, v146
  v_fmac_f32 v49, v147, v147
  v_mfma_f32_32x32x16_bf16 v[100:115], v[16:19], v[24:27], v[100:115]
  v_lshlrev_b32 v144, 16, v14
  v_and_b32 v145, s35, v14
  v_fmac_f32 v48, v144, v144
  v_fmac_f32 v49, v145, v145
  v_lshlrev_b32 v146, 16, v15
  v_and_b32 v147, s35, v15
  v_mfma_f32_16x16x32_bf16 v[116:119], v[44:47], v[12:15], v[116:119]
  v_fmac_f32 v48, v146, v146
  v_fmac_f32 v49, v147, v147
  s_waitcnt lgkmcnt(0)
  v_mfma_f32_32x32x16_bf16 v[52:67], v[36:39], v[28:31], v[52:67]
  s_barrier
  ds_read_b128 v[12:15], v152 offset:32768
  ds_read_b128 v[16:19], v156 offset:32768
  v_lshlrev_b32 v144, 16, v28
  v_and_b32 v145, s35, v28
  v_fmac_f32 v48, v144, v144
  v_mfma_f32_32x32x16_bf16 v[68:83], v[36:39], v[32:35], v[68:83]
  ds_read_b64_tr_b16 v[20:21], v120 offset:32768
  ds_read_b64_tr_b16 v[22:23], v120 offset:33280
  v_fmac_f32 v49, v145, v145
  v_lshlrev_b32 v146, 16, v29
  v_and_b32 v147, s35, v29
  v_mfma_f32_32x32x16_bf16 v[84:99], v[28:31], v[40:43], v[84:99]
  ds_read_b64_tr_b16 v[24:25], v120 offset:40960
  ds_read_b64_tr_b16 v[26:27], v120 offset:41472
  v_fmac_f32 v48, v146, v146
  v_fmac_f32 v49, v147, v147
  v_mfma_f32_32x32x16_bf16 v[100:115], v[32:35], v[40:43], v[100:115]
  v_lshlrev_b32 v144, 16, v30
  v_and_b32 v145, s35, v30
  v_fmac_f32 v48, v144, v144
  v_fmac_f32 v49, v145, v145
  v_lshlrev_b32 v146, 16, v31
  v_and_b32 v147, s35, v31
  v_mfma_f32_16x16x32_bf16 v[116:119], v[44:47], v[28:31], v[116:119]
  v_fmac_f32 v48, v146, v146
  v_fmac_f32 v49, v147, v147
  s_waitcnt lgkmcnt(0)
  v_mfma_f32_32x32x16_bf16 v[52:67], v[20:23], v[12:15], v[52:67]
  ds_read_b128 v[28:31], v153 offset:32768
  ds_read_b128 v[32:35], v157 offset:32768
  v_lshlrev_b32 v144, 16, v12
  v_and_b32 v145, s35, v12
  v_fmac_f32 v48, v144, v144
  v_mfma_f32_32x32x16_bf16 v[68:83], v[20:23], v[16:19], v[68:83]
  ds_read_b64_tr_b16 v[36:37], v120 offset:34816
  ds_read_b64_tr_b16 v[38:39], v120 offset:35328
  v_fmac_f32 v49, v145, v145
  v_lshlrev_b32 v146, 16, v13
  v_and_b32 v147, s35, v13
  v_mfma_f32_32x32x16_bf16 v[84:99], v[12:15], v[24:27], v[84:99]
  ds_read_b64_tr_b16 v[40:41], v120 offset:43008
  ds_read_b64_tr_b16 v[42:43], v120 offset:43520
  v_fmac_f32 v48, v146, v146
  v_fmac_f32 v49, v147, v147
  v_mfma_f32_32x32x16_bf16 v[100:115], v[16:19], v[24:27], v[100:115]
  v_lshlrev_b32 v144, 16, v14
  v_and_b32 v145, s35, v14
  v_fmac_f32 v48, v144, v144
  v_fmac_f32 v49, v145, v145
  v_lshlrev_b32 v146, 16, v15
  v_and_b32 v147, s35, v15
  v_mfma_f32_16x16x32_bf16 v[116:119], v[44:47], v[12:15], v[116:119]
  v_fmac_f32 v48, v146, v146
  v_fmac_f32 v49, v147, v147
  v_mfma_f32_16x16x32_bf16 v[124:127], v[44:47], v[20:23], v[124:127]
  v_mfma_f32_16x16x32_bf16 v[128:131], v[44:47], v[24:27], v[128:131]
  s_waitcnt lgkmcnt(0)
  v_mfma_f32_32x32x16_bf16 v[52:67], v[36:39], v[28:31], v[52:67]
  ds_read_b128 v[12:15], v154 offset:32768
  ds_read_b128 v[16:19], v158 offset:32768
  v_lshlrev_b32 v144, 16, v28
  v_and_b32 v145, s35, v28
  v_fmac_f32 v48, v144, v144
  v_mfma_f32_32x32x16_bf16 v[68:83], v[36:39], v[32:35], v[68:83]
  ds_read_b64_tr_b16 v[20:21], v121 offset:32768
  ds_read_b64_tr_b16 v[22:23], v121 offset:33280
  v_fmac_f32 v49, v145, v145
  v_lshlrev_b32 v146, 16, v29
  v_and_b32 v147, s35, v29
  v_mfma_f32_32x32x16_bf16 v[84:99], v[28:31], v[40:43], v[84:99]
  ds_read_b64_tr_b16 v[24:25], v121 offset:40960
  ds_read_b64_tr_b16 v[26:27], v121 offset:41472
  v_fmac_f32 v48, v146, v146
  v_fmac_f32 v49, v147, v147
  v_mfma_f32_32x32x16_bf16 v[100:115], v[32:35], v[40:43], v[100:115]
  v_lshlrev_b32 v144, 16, v30
  v_and_b32 v145, s35, v30
  v_fmac_f32 v48, v144, v144
  v_fmac_f32 v49, v145, v145
  v_lshlrev_b32 v146, 16, v31
  v_and_b32 v147, s35, v31
  v_mfma_f32_16x16x32_bf16 v[116:119], v[44:47], v[28:31], v[116:119]
  v_fmac_f32 v48, v146, v146
  v_fmac_f32 v49, v147, v147
  v_mfma_f32_16x16x32_bf16 v[124:127], v[44:47], v[36:39], v[124:127]
  v_mfma_f32_16x16x32_bf16 v[128:131], v[44:47], v[40:43], v[128:131]
  s_waitcnt lgkmcnt(0)
  v_mfma_f32_32x32x16_bf16 v[52:67], v[20:23], v[12:15], v[52:67]
  ds_read_b128 v[28:31], v155 offset:32768
  ds_read_b128 v[32:35], v159 offset:32768
  v_lshlrev_b32 v144, 16, v12
  v_and_b32 v145, s35, v12
  v_fmac_f32 v48, v144, v144
  v_mfma_f32_32x32x16_bf16 v[68:83], v[20:23], v[16:19], v[68:83]
  ds_read_b64_tr_b16 v[36:37], v121 offset:34816
  ds_read_b64_tr_b16 v[38:39], v121 offset:35328
  v_fmac_f32 v49, v145, v145
  v_lshlrev_b32 v146, 16, v13
  v_and_b32 v147, s35, v13
  v_mfma_f32_32x32x16_bf16 v[84:99], v[12:15], v[24:27], v[84:99]
  ds_read_b64_tr_b16 v[40:41], v121 offset:43008
  ds_read_b64_tr_b16 v[42:43], v121 offset:43520
  v_fmac_f32 v48, v146, v146
  v_fmac_f32 v49, v147, v147
  v_mfma_f32_32x32x16_bf16 v[100:115], v[16:19], v[24:27], v[100:115]
  v_lshlrev_b32 v144, 16, v14
  v_and_b32 v145, s35, v14
  v_fmac_f32 v48, v144, v144
  v_fmac_f32 v49, v145, v145
  v_lshlrev_b32 v146, 16, v15
  v_and_b32 v147, s35, v15
  v_mfma_f32_16x16x32_bf16 v[116:119], v[44:47], v[12:15], v[116:119]
  v_fmac_f32 v48, v146, v146
  v_fmac_f32 v49, v147, v147
  s_waitcnt lgkmcnt(0)
  v_mfma_f32_32x32x16_bf16 v[52:67], v[36:39], v[28:31], v[52:67]
  s_barrier
  ds_read_b128 v[12:15], v160 offset:0
  ds_read_b128 v[16:19], v164 offset:0
  v_lshlrev_b32 v144, 16, v28
  v_and_b32 v145, s35, v28
  v_fmac_f32 v48, v144, v144
  v_mfma_f32_32x32x16_bf16 v[68:83], v[36:39], v[32:35], v[68:83]
  ds_read_b64_tr_b16 v[20:21], v122 offset:0
  ds_read_b64_tr_b16 v[22:23], v122 offset:512
  v_fmac_f32 v49, v145, v145
  v_lshlrev_b32 v146, 16, v29
  v_and_b32 v147, s35, v29
  v_mfma_f32_32x32x16_bf16 v[84:99], v[28:31], v[40:43], v[84:99]
  ds_read_b64_tr_b16 v[24:25], v122 offset:8192
  ds_read_b64_tr_b16 v[26:27], v122 offset:8704
  v_fmac_f32 v48, v146, v146
  v_fmac_f32 v49, v147, v147
  v_mfma_f32_32x32x16_bf16 v[100:115], v[32:35], v[40:43], v[100:115]
  v_lshlrev_b32 v144, 16, v30
  v_and_b32 v145, s35, v30
  v_fmac_f32 v48, v144, v144
  v_fmac_f32 v49, v145, v145
  v_lshlrev_b32 v146, 16, v31
  v_and_b32 v147, s35, v31
  v_mfma_f32_16x16x32_bf16 v[116:119], v[44:47], v[28:31], v[116:119]
  v_fmac_f32 v48, v146, v146
  v_fmac_f32 v49, v147, v147
  s_waitcnt lgkmcnt(0)
  v_mfma_f32_32x32x16_bf16 v[52:67], v[20:23], v[12:15], v[52:67]
  ds_read_b128 v[28:31], v161 offset:0
  ds_read_b128 v[32:35], v165 offset:0
  v_lshlrev_b32 v144, 16, v12
  v_and_b32 v145, s35, v12
  v_fmac_f32 v48, v144, v144
  v_mfma_f32_32x32x16_bf16 v[68:83], v[20:23], v[16:19], v[68:83]
  ds_read_b64_tr_b16 v[36:37], v122 offset:2048
  ds_read_b64_tr_b16 v[38:39], v122 offset:2560
  v_fmac_f32 v49, v145, v145
  v_lshlrev_b32 v146, 16, v13
  v_and_b32 v147, s35, v13
  v_mfma_f32_32x32x16_bf16 v[84:99], v[12:15], v[24:27], v[84:99]
  ds_read_b64_tr_b16 v[40:41], v122 offset:10240
  ds_read_b64_tr_b16 v[42:43], v122 offset:10752
  v_fmac_f32 v48, v146, v146
  v_fmac_f32 v49, v147, v147
  v_mfma_f32_32x32x16_bf16 v[100:115], v[16:19], v[24:27], v[100:115]
  v_lshlrev_b32 v144, 16, v14
  v_and_b32 v145, s35, v14
  v_fmac_f32 v48, v144, v144
  v_fmac_f32 v49, v145, v145
  v_lshlrev_b32 v146, 16, v15
  v_and_b32 v147, s35, v15
  v_mfma_f32_16x16x32_bf16 v[116:119], v[44:47], v[12:15], v[116:119]
  v_fmac_f32 v48, v146, v146
  v_fmac_f32 v49, v147, v147
  v_mfma_f32_16x16x32_bf16 v[124:127], v[44:47], v[20:23], v[124:127]
  v_mfma_f32_16x16x32_bf16 v[128:131], v[44:47], v[24:27], v[128:131]
  s_waitcnt lgkmcnt(0)
  v_mfma_f32_32x32x16_bf16 v[52:67], v[36:39], v[28:31], v[52:67]
  ds_read_b128 v[12:15], v162 offset:0
  ds_read_b128 v[16:19], v166 offset:0
  v_lshlrev_b32 v144, 16, v28
  v_and_b32 v145, s35, v28
  v_fmac_f32 v48, v144, v144
  v_mfma_f32_32x32x16_bf16 v[68:83], v[36:39], v[32:35], v[68:83]
  ds_read_b64_tr_b16 v[20:21], v123 offset:0
  ds_read_b64_tr_b16 v[22:23], v123 offset:512
  v_fmac_f32 v49, v145, v145
  v_lshlrev_b32 v146, 16, v29
  v_and_b32 v147, s35, v29
  v_mfma_f32_32x32x16_bf16 v[84:99], v[28:31], v[40:43], v[84:99]
  ds_read_b64_tr_b16 v[24:25], v123 offset:8192
  ds_read_b64_tr_b16 v[26:27], v123 offset:8704
  v_fmac_f32 v48, v146, v146
  v_fmac_f32 v49, v147, v147
  v_mfma_f32_32x32x16_bf16 v[100:115], v[32:35], v[40:43], v[100:115]
  v_lshlrev_b32 v144, 16, v30
  v_and_b32 v145, s35, v30
  v_fmac_f32 v48, v144, v144
  v_fmac_f32 v49, v145, v145
  v_lshlrev_b32 v146, 16, v31
  v_and_b32 v147, s35, v31
  v_mfma_f32_16x16x32_bf16 v[116:119], v[44:47], v[28:31], v[116:119]
  v_fmac_f32 v48, v146, v146
  v_fmac_f32 v49, v147, v147
  v_mfma_f32_16x16x32_bf16 v[124:127], v[44:47], v[36:39], v[124:127]
  v_mfma_f32_16x16x32_bf16 v[128:131], v[44:47], v[40:43], v[128:131]
  s_waitcnt lgkmcnt(0)
  v_mfma_f32_32x32x16_bf16 v[52:67], v[20:23], v[12:15], v[52:67]
  ds_read_b128 v[28:31], v163 offset:0
  ds_read_b128 v[32:35], v167 offset:0
  v_lshlrev_b32 v144, 16, v12
  v_and_b32 v145, s35, v12
  v_fmac_f32 v48, v144, v144
  v_mfma_f32_32x32x16_bf16 v[68:83], v[20:23], v[16:19], v[68:83]
  ds_read_b64_tr_b16 v[36:37], v123 offset:2048
  ds_read_b64_tr_b16 v[38:39], v123 offset:2560
  v_fmac_f32 v49, v145, v145
  v_lshlrev_b32 v146, 16, v13
  v_and_b32 v147, s35, v13
  v_mfma_f32_32x32x16_bf16 v[84:99], v[12:15], v[24:27], v[84:99]
  ds_read_b64_tr_b16 v[40:41], v123 offset:10240
  ds_read_b64_tr_b16 v[42:43], v123 offset:10752
  v_fmac_f32 v48, v146, v146
  v_fmac_f32 v49, v147, v147
  v_mfma_f32_32x32x16_bf16 v[100:115], v[16:19], v[24:27], v[100:115]
  v_lshlrev_b32 v144, 16, v14
  v_and_b32 v145, s35, v14
  v_fmac_f32 v48, v144, v144
  v_fmac_f32 v49, v145, v145
  v_lshlrev_b32 v146, 16, v15
  v_and_b32 v147, s35, v15
  v_mfma_f32_16x16x32_bf16 v[116:119], v[44:47], v[12:15], v[116:119]
  v_fmac_f32 v48, v146, v146
  v_fmac_f32 v49, v147, v147
  s_waitcnt lgkmcnt(0)
  v_mfma_f32_32x32x16_bf16 v[52:67], v[36:39], v[28:31], v[52:67]
  s_barrier
  ds_read_b128 v[12:15], v152 offset:0
  ds_read_b128 v[16:19], v156 offset:0
  v_lshlrev_b32 v144, 16, v28
  v_and_b32 v145, s35, v28
  v_fmac_f32 v48, v144, v144
  v_mfma_f32_32x32x16_bf16 v[68:83], v[36:39], v[32:35], v[68:83]
  ds_read_b64_tr_b16 v[20:21], v120 offset:0
  ds_read_b64_tr_b16 v[22:23], v120 offset:512
  v_fmac_f32 v49, v145, v145
  v_lshlrev_b32 v146, 16, v29
  v_and_b32 v147, s35, v29
  v_mfma_f32_32x32x16_bf16 v[84:99], v[28:31], v[40:43], v[84:99]
  ds_read_b64_tr_b16 v[24:25], v120 offset:8192
  ds_read_b64_tr_b16 v[26:27], v120 offset:8704
  v_fmac_f32 v48, v146, v146
  v_fmac_f32 v49, v147, v147
  v_mfma_f32_32x32x16_bf16 v[100:115], v[32:35], v[40:43], v[100:115]
  v_lshlrev_b32 v144, 16, v30
  v_and_b32 v145, s35, v30
  v_fmac_f32 v48, v144, v144
  v_fmac_f32 v49, v145, v145
  v_lshlrev_b32 v146, 16, v31
  v_and_b32 v147, s35, v31
  v_mfma_f32_16x16x32_bf16 v[116:119], v[44:47], v[28:31], v[116:119]
  v_fmac_f32 v48, v146, v146
  v_fmac_f32 v49, v147, v147
  s_waitcnt lgkmcnt(0)
  v_mfma_f32_32x32x16_bf16 v[52:67], v[20:23], v[12:15], v[52:67]
  ds_read_b128 v[28:31], v153 offset:0
  ds_read_b128 v[32:35], v157 offset:0
  v_lshlrev_b32 v144, 16, v12
  v_and_b32 v145, s35, v12
  v_fmac_f32 v48, v144, v144
  v_mfma_f32_32x32x16_bf16 v[68:83], v[20:23], v[16:19], v[68:83]
  ds_read_b64_tr_b16 v[36:37], v120 offset:2048
  ds_read_b64_tr_b16 v[38:39], v120 offset:2560
  v_fmac_f32 v49, v145, v145
  v_lshlrev_b32 v146, 16, v13
  v_and_b32 v147, s35, v13
  v_mfma_f32_32x32x16_bf16 v[84:99], v[12:15], v[24:27], v[84:99]
  ds_read_b64_tr_b16 v[40:41], v120 offset:10240
  ds_read_b64_tr_b16 v[42:43], v120 offset:10752
  v_fmac_f32 v48, v146, v146
  v_fmac_f32 v49, v147, v147
  v_mfma_f32_32x32x16_bf16 v[100:115], v[16:19], v[24:27], v[100:115]
  v_lshlrev_b32 v144, 16, v14
  v_and_b32 v145, s35, v14
  v_fmac_f32 v48, v144, v144
  v_fmac_f32 v49, v145, v145
  v_lshlrev_b32 v146, 16, v15
  v_and_b32 v147, s35, v15
  v_mfma_f32_16x16x32_bf16 v[116:119], v[44:47], v[12:15], v[116:119]
  v_fmac_f32 v48, v146, v146
  v_fmac_f32 v49, v147, v147
  v_mfma_f32_16x16x32_bf16 v[124:127], v[44:47], v[20:23], v[124:127]
  v_mfma_f32_16x16x32_bf16 v[128:131], v[44:47], v[24:27], v[128:131]
  s_waitcnt lgkmcnt(0)
  v_mfma_f32_32x32x16_bf16 v[52:67], v[36:39], v[28:31], v[52:67]
  ds_read_b128 v[12:15], v154 offset:0
  ds_read_b128 v[16:19], v158 offset:0
  v_lshlrev_b32 v144, 16, v28
  v_and_b32 v145, s35, v28
  v_fmac_f32 v48, v144, v144
  v_mfma_f32_32x32x16_bf16 v[68:83], v[36:39], v[32:35], v[68:83]
  ds_read_b64_tr_b16 v[20:21], v121 offset:0
  ds_read_b64_tr_b16 v[22:23], v121 offset:512
  v_fmac_f32 v49, v145, v145
  v_lshlrev_b32 v146, 16, v29
  v_and_b32 v147, s35, v29
  v_mfma_f32_32x32x16_bf16 v[84:99], v[28:31], v[40:43], v[84:99]
  ds_read_b64_tr_b16 v[24:25], v121 offset:8192
  ds_read_b64_tr_b16 v[26:27], v121 offset:8704
  v_fmac_f32 v48, v146, v146
  v_fmac_f32 v49, v147, v147
  v_mfma_f32_32x32x16_bf16 v[100:115], v[32:35], v[40:43], v[100:115]
  v_lshlrev_b32 v144, 16, v30
  v_and_b32 v145, s35, v30
  v_fmac_f32 v48, v144, v144
  v_fmac_f32 v49, v145, v145
  v_lshlrev_b32 v146, 16, v31
  v_and_b32 v147, s35, v31
  v_mfma_f32_16x16x32_bf16 v[116:119], v[44:47], v[28:31], v[116:119]
  v_fmac_f32 v48, v146, v146
  v_fmac_f32 v49, v147, v147
  v_mfma_f32_16x16x32_bf16 v[124:127], v[44:47], v[36:39], v[124:127]
  v_mfma_f32_16x16x32_bf16 v[128:131], v[44:47], v[40:43], v[128:131]
  s_waitcnt lgkmcnt(0)
  v_mfma_f32_32x32x16_bf16 v[52:67], v[20:23], v[12:15], v[52:67]
  ds_read_b128 v[28:31], v155 offset:0
  ds_read_b128 v[32:35], v159 offset:0
  v_lshlrev_b32 v144, 16, v12
  v_and_b32 v145, s35, v12
  v_fmac_f32 v48, v144, v144
  v_mfma_f32_32x32x16_bf16 v[68:83], v[20:23], v[16:19], v[68:83]
  ds_read_b64_tr_b16 v[36:37], v121 offset:2048
  ds_read_b64_tr_b16 v[38:39], v121 offset:2560
  v_fmac_f32 v49, v145, v145
  v_lshlrev_b32 v146, 16, v13
  v_and_b32 v147, s35, v13
  v_mfma_f32_32x32x16_bf16 v[84:99], v[12:15], v[24:27], v[84:99]
  ds_read_b64_tr_b16 v[40:41], v121 offset:10240
  ds_read_b64_tr_b16 v[42:43], v121 offset:10752
  v_fmac_f32 v48, v146, v146
  v_fmac_f32 v49, v147, v147
  v_mfma_f32_32x32x16_bf16 v[100:115], v[16:19], v[24:27], v[100:115]
  v_lshlrev_b32 v144, 16, v14
  v_and_b32 v145, s35, v14
  v_fmac_f32 v48, v144, v144
  v_fmac_f32 v49, v145, v145
  v_lshlrev_b32 v146, 16, v15
  v_and_b32 v147, s35, v15
  v_mfma_f32_16x16x32_bf16 v[116:119], v[44:47], v[12:15], v[116:119]
  v_fmac_f32 v48, v146, v146
  v_fmac_f32 v49, v147, v147
  s_waitcnt lgkmcnt(0)
  v_mfma_f32_32x32x16_bf16 v[52:67], v[36:39], v[28:31], v[52:67]
  s_barrier
  ds_read_b128 v[12:15], v152 offset:32768
  ds_read_b128 v[16:19], v156 offset:32768
  v_lshlrev_b32 v144, 16, v28
  v_and_b32 v145, s35, v28
  v_fmac_f32 v48, v144, v144
  v_mfma_f32_32x32x16_bf16 v[68:83], v[36:39], v[32:35], v[68:83]
  ds_read_b64_tr_b16 v[20:21], v120 offset:32768
  ds_read_b64_tr_b16 v[22:23], v120 offset:33280
  v_fmac_f32 v49, v145, v145
  v_lshlrev_b32 v146, 16, v29
  v_and_b32 v147, s35, v29
  v_mfma_f32_32x32x16_bf16 v[84:99], v[28:31], v[40:43], v[84:99]
  ds_read_b64_tr_b16 v[24:25], v120 offset:40960
  ds_read_b64_tr_b16 v[26:27], v120 offset:41472
  v_fmac_f32 v48, v146, v146
  v_fmac_f32 v49, v147, v147
  v_mfma_f32_32x32x16_bf16 v[100:115], v[32:35], v[40:43], v[100:115]
  v_lshlrev_b32 v144, 16, v30
  v_and_b32 v145, s35, v30
  v_fmac_f32 v48, v144, v144
  v_fmac_f32 v49, v145, v145
  v_lshlrev_b32 v146, 16, v31
  v_and_b32 v147, s35, v31
  v_mfma_f32_16x16x32_bf16 v[116:119], v[44:47], v[28:31], v[116:119]
  v_fmac_f32 v48, v146, v146
  v_fmac_f32 v49, v147, v147
  s_waitcnt lgkmcnt(0)
  v_mfma_f32_32x32x16_bf16 v[52:67], v[20:23], v[12:15], v[52:67]
  ds_read_b128 v[28:31], v153 offset:32768
  ds_read_b128 v[32:35], v157 offset:32768
  v_lshlrev_b32 v144, 16, v12
  v_and_b32 v145, s35, v12
  v_fmac_f32 v48, v144, v144
  v_mfma_f32_32x32x16_bf16 v[68:83], v[20:23], v[16:19], v[68:83]
  ds_read_b64_tr_b16 v[36:37], v120 offset:34816
  ds_read_b64_tr_b16 v[38:39], v120 offset:35328
  v_fmac_f32 v49, v145, v145
  v_lshlrev_b32 v146, 16, v13
  v_and_b32 v147, s35, v13
  v_mfma_f32_32x32x16_bf16 v[84:99], v[12:15], v[24:27], v[84:99]
  ds_read_b64_tr_b16 v[40:41], v120 offset:43008
  ds_read_b64_tr_b16 v[42:43], v120 offset:43520
  v_fmac_f32 v48, v146, v146
  v_fmac_f32 v49, v147, v147
  v_mfma_f32_32x32x16_bf16 v[100:115], v[16:19], v[24:27], v[100:115]
  v_lshlrev_b32 v144, 16, v14
  v_and_b32 v145, s35, v14
  v_fmac_f32 v48, v144, v144
  v_fmac_f32 v49, v145, v145
  v_lshlrev_b32 v146, 16, v15
  v_and_b32 v147, s35, v15
  v_mfma_f32_16x16x32_bf16 v[116:119], v[44:47], v[12:15], v[116:119]
  v_fmac_f32 v48, v146, v146
  v_fmac_f32 v49, v147, v147
  v_mfma_f32_16x16x32_bf16 v[124:127], v[44:47], v[20:23], v[124:127]
  v_mfma_f32_16x16x32_bf16 v[128:131], v[44:47], v[24:27], v[128:131]
  s_waitcnt lgkmcnt(0)
  v_mfma_f32_32x32x16_bf16 v[52:67], v[36:39], v[28:31], v[52:67]
  ds_read_b128 v[12:15], v154 offset:32768
  ds_read_b128 v[16:19], v158 offset:32768
  v_lshlrev_b32 v144, 16, v28
  v_and_b32 v145, s35, v28
  v_fmac_f32 v48, v144, v144
  v_mfma_f32_32x32x16_bf16 v[68:83], v[36:39], v[32:35], v[68:83]
  ds_read_b64_tr_b16 v[20:21], v121 offset:32768
  ds_read_b64_tr_b16 v[22:23], v121 offset:33280
  v_fmac_f32 v49, v145, v145
  v_lshlrev_b32 v146, 16, v29
  v_and_b32 v147, s35, v29
  v_mfma_f32_32x32x16_bf16 v[84:99], v[28:31], v[40:43], v[84:99]
  ds_read_b64_tr_b16 v[24:25], v121 offset:40960
  ds_read_b64_tr_b16 v[26:27], v121 offset:41472
  v_fmac_f32 v48, v146, v146
  v_fmac_f32 v49, v147, v147
  v_mfma_f32_32x32x16_bf16 v[100:115], v[32:35], v[40:43], v[100:115]
  v_lshlrev_b32 v144, 16, v30
  v_and_b32 v145, s35, v30
  v_fmac_f32 v48, v144, v144
  v_fmac_f32 v49, v145, v145
  v_lshlrev_b32 v146, 16, v31
  v_and_b32 v147, s35, v31
  v_mfma_f32_16x16x32_bf16 v[116:119], v[44:47], v[28:31], v[116:119]
  v_fmac_f32 v48, v146, v146
  v_fmac_f32 v49, v147, v147
  v_mfma_f32_16x16x32_bf16 v[124:127], v[44:47], v[36:39], v[124:127]
  v_mfma_f32_16x16x32_bf16 v[128:131], v[44:47], v[40:43], v[128:131]
  s_waitcnt lgkmcnt(0)
  v_mfma_f32_32x32x16_bf16 v[52:67], v[20:23], v[12:15], v[52:67]
  ds_read_b128 v[28:31], v155 offset:32768
  ds_read_b128 v[32:35], v159 offset:32768
  v_lshlrev_b32 v144, 16, v12
  v_and_b32 v145, s35, v12
  v_fmac_f32 v48, v144, v144
  v_mfma_f32_32x32x16_bf16 v[68:83], v[20:23], v[16:19], v[68:83]
  ds_read_b64_tr_b16 v[36:37], v121 offset:34816
  ds_read_b64_tr_b16 v[38:39], v121 offset:35328
  v_fmac_f32 v49, v145, v145
  v_lshlrev_b32 v146, 16, v13
  v_and_b32 v147, s35, v13
  v_mfma_f32_32x32x16_bf16 v[84:99], v[12:15], v[24:27], v[84:99]
  ds_read_b64_tr_b16 v[40:41], v121 offset:43008
  ds_read_b64_tr_b16 v[42:43], v121 offset:43520
  v_fmac_f32 v48, v146, v146
  v_fmac_f32 v49, v147, v147
  v_mfma_f32_32x32x16_bf16 v[100:115], v[16:19], v[24:27], v[100:115]
  v_lshlrev_b32 v144, 16, v14
  v_and_b32 v145, s35, v14
  v_fmac_f32 v48, v144, v144
  v_fmac_f32 v49, v145, v145
  v_lshlrev_b32 v146, 16, v15
  v_and_b32 v147, s35, v15
  v_mfma_f32_16x16x32_bf16 v[116:119], v[44:47], v[12:15], v[116:119]
  v_fmac_f32 v48, v146, v146
  v_fmac_f32 v49, v147, v147
  s_waitcnt lgkmcnt(0)
  v_mfma_f32_32x32x16_bf16 v[52:67], v[36:39], v[28:31], v[52:67]
  v_lshlrev_b32 v144, 16, v28
  v_and_b32 v145, s35, v28
  v_fmac_f32 v48, v144, v144
  v_mfma_f32_32x32x16_bf16 v[68:83], v[36:39], v[32:35], v[68:83]
  v_fmac_f32 v49, v145, v145
  v_lshlrev_b32 v146, 16, v29
  v_and_b32 v147, s35, v29
  v_mfma_f32_32x32x16_bf16 v[84:99], v[28:31], v[40:43], v[84:99]
  v_fmac_f32 v48, v146, v146
  v_fmac_f32 v49, v147, v147
  v_mfma_f32_32x32x16_bf16 v[100:115], v[32:35], v[40:43], v[100:115]
  v_lshlrev_b32 v144, 16, v30
  v_and_b32 v145, s35, v30
  v_fmac_f32 v48, v144, v144
  v_fmac_f32 v49, v145, v145
  v_lshlrev_b32 v146, 16, v31
  v_and_b32 v147, s35, v31
  v_mfma_f32_16x16x32_bf16 v[116:119], v[44:47], v[28:31], v[116:119]
  v_fmac_f32 v48, v146, v146
  v_fmac_f32 v49, v147, v147
  v_add_f32 v22, v48, v49
  s_mov_b32 vcc_lo, 0xffff
  s_mov_b32 vcc_hi, 0xffff
  v_mov_b32 v24, v22
  s_nop 1
  v_permlane32_swap_b32 v22, v24
  v_add_f32 v22, v22, v24
  v_mul_f32 v22, 0x3b000000, v22
  v_cndmask_b32 v20, v117, v116, vcc
  v_cndmask_b32 v132, v125, v124, vcc
  v_cndmask_b32 v133, v129, v128, vcc
  ds_write_b64 v10, v[132:133]
  v_mul_f32 v20, 0x3b000000, v20
  s_mov_b32 vcc_lo, -1
  s_mov_b32 vcc_hi, 0
  v_fma_f32 v22, -v20, v20, v22
  v_max_f32 v22, 0, v22
  v_add_f32 v21, 0x3727c5ac, v22
  v_rsq_f32 v21, v21
  v_cndmask_b32 v24, 0, v20, vcc
  v_cvt_pk_bf16_f32 v137, v24, v24
  v_and_b32 v25, s35, v137
  v_sub_f32 v25, v24, v25
  v_cvt_pk_bf16_f32 v136, v24, v25
  v_and_b32 v137, 0xffff, v137
  v_mul_f32 v138, 0x3eb8aa3b, v21
  ds_write_b128 v148, v[136:139]
  ds_write_b32 v3, v21
  s_waitcnt lgkmcnt(0)
  s_barrier
  ds_read_b64 v[134:135], v11
  ds_read_b128 v[140:143], v149
  ds_read_b64 v[36:37], v150
  ds_read_b128 v[152:155], v2 offset:0
  ds_read_b128 v[156:159], v2 offset:32
  ds_read_b128 v[160:163], v2 offset:64
  ds_read_b128 v[164:167], v2 offset:96
  ds_read_b128 v[116:119], v9 offset:0
  ds_read_b128 v[120:123], v9 offset:32
  ds_read_b128 v[124:127], v9 offset:64
  ds_read_b128 v[128:131], v9 offset:96
  s_waitcnt lgkmcnt(10)
  v_add_f32 v132, -v132, -v134
  v_cvt_pk_bf16_f32 v16, v132, v132
  v_and_b32 v17, 0xffff0000, v16
  v_sub_f32 v17, v132, v17
  v_cvt_pk_bf16_f32 v17, v17, 0
  v_add_f32 v133, -v133, -v135
  v_cvt_pk_bf16_f32 v18, v133, v133
  v_and_b32 v19, 0xffff0000, v18
  v_sub_f32 v19, v133, v19
  v_cvt_pk_bf16_f32 v19, v19, 0
  s_waitcnt lgkmcnt(8)
  v_mfma_f32_32x32x8_bf16 v[52:67], v[16:17], v[136:137], v[52:67]
  v_mfma_f32_32x32x8_bf16 v[68:83], v[16:17], v[140:141], v[68:83]
  v_mfma_f32_32x32x8_bf16 v[84:99], v[136:137], v[18:19], v[84:99]
  v_mfma_f32_32x32x8_bf16 v[100:115], v[140:141], v[18:19], v[100:115]
  v_readfirstlane_b32 s60, v36
  v_readfirstlane_b32 s61, v37
  s_nop 6
  v_pk_mul_f32 v[52:53], v[52:53], v[138:139] op_sel_hi:[1,0]
  v_pk_mul_f32 v[54:55], v[54:55], v[138:139] op_sel_hi:[1,0]
  v_pk_mul_f32 v[56:57], v[56:57], v[138:139] op_sel_hi:[1,0]
  v_pk_mul_f32 v[58:59], v[58:59], v[138:139] op_sel_hi:[1,0]
  v_pk_mul_f32 v[60:61], v[60:61], v[138:139] op_sel_hi:[1,0]
  v_pk_mul_f32 v[62:63], v[62:63], v[138:139] op_sel_hi:[1,0]
  v_pk_mul_f32 v[64:65], v[64:65], v[138:139] op_sel_hi:[1,0]
  v_pk_mul_f32 v[66:67], v[66:67], v[138:139] op_sel_hi:[1,0]
  v_cvt_pk_bf16_f32 v20, v52, v53
  v_cvt_pk_bf16_f32 v21, v54, v55
  v_cvt_pk_bf16_f32 v22, v56, v57
  v_cvt_pk_bf16_f32 v23, v58, v59
  v_cvt_pk_bf16_f32 v24, v60, v61
  v_cvt_pk_bf16_f32 v25, v62, v63
  v_cvt_pk_bf16_f32 v26, v64, v65
  v_cvt_pk_bf16_f32 v27, v66, v67
  buffer_store_dwordx4 v[20:23], v4, s[20:23], s32 offen sc1
  buffer_store_dwordx4 v[24:27], v4, s[20:23], s33 offen sc1
  v_pk_mul_f32 v[68:69], v[68:69], v[142:143] op_sel_hi:[1,0]
  v_pk_mul_f32 v[70:71], v[70:71], v[142:143] op_sel_hi:[1,0]
  v_pk_mul_f32 v[72:73], v[72:73], v[142:143] op_sel_hi:[1,0]
  v_pk_mul_f32 v[74:75], v[74:75], v[142:143] op_sel_hi:[1,0]
  v_pk_mul_f32 v[76:77], v[76:77], v[142:143] op_sel_hi:[1,0]
  v_pk_mul_f32 v[78:79], v[78:79], v[142:143] op_sel_hi:[1,0]
  v_pk_mul_f32 v[80:81], v[80:81], v[142:143] op_sel_hi:[1,0]
  v_pk_mul_f32 v[82:83], v[82:83], v[142:143] op_sel_hi:[1,0]
  v_cvt_pk_bf16_f32 v28, v68, v69
  v_cvt_pk_bf16_f32 v29, v70, v71
  v_cvt_pk_bf16_f32 v30, v72, v73
  v_cvt_pk_bf16_f32 v31, v74, v75
  v_cvt_pk_bf16_f32 v32, v76, v77
  v_cvt_pk_bf16_f32 v33, v78, v79
  v_cvt_pk_bf16_f32 v34, v80, v81
  v_cvt_pk_bf16_f32 v35, v82, v83
  buffer_store_dwordx4 v[28:31], v5, s[20:23], s32 offen sc1
  buffer_store_dwordx4 v[32:35], v5, s[20:23], s33 offen sc1
  s_waitcnt lgkmcnt(0)
  v_pk_mul_f32 v[84:85], v[84:85], v[152:153]
  v_pk_mul_f32 v[86:87], v[86:87], v[154:155]
  v_pk_mul_f32 v[88:89], v[88:89], v[156:157]
  v_pk_mul_f32 v[90:91], v[90:91], v[158:159]
  v_pk_mul_f32 v[92:93], v[92:93], v[160:161]
  v_pk_mul_f32 v[94:95], v[94:95], v[162:163]
  v_pk_mul_f32 v[96:97], v[96:97], v[164:165]
  v_pk_mul_f32 v[98:99], v[98:99], v[166:167]
  v_cvt_pk_bf16_f32 v36, v84, v85
  v_cvt_pk_bf16_f32 v37, v86, v87
  v_cvt_pk_bf16_f32 v38, v88, v89
  v_cvt_pk_bf16_f32 v39, v90, v91
  v_cvt_pk_bf16_f32 v40, v92, v93
  v_cvt_pk_bf16_f32 v41, v94, v95
  v_cvt_pk_bf16_f32 v42, v96, v97
  v_cvt_pk_bf16_f32 v43, v98, v99
  buffer_store_dwordx4 v[36:39], v7, s[24:27], s32 offen offset:0 sc1
  buffer_store_dwordx4 v[40:43], v7, s[24:27], s32 offen offset:512 sc1
  v_pk_mul_f32 v[100:101], v[100:101], v[116:117]
  v_pk_mul_f32 v[102:103], v[102:103], v[118:119]
  v_pk_mul_f32 v[104:105], v[104:105], v[120:121]
  v_pk_mul_f32 v[106:107], v[106:107], v[122:123]
  v_pk_mul_f32 v[108:109], v[108:109], v[124:125]
  v_pk_mul_f32 v[110:111], v[110:111], v[126:127]
  v_pk_mul_f32 v[112:113], v[112:113], v[128:129]
  v_pk_mul_f32 v[114:115], v[114:115], v[130:131]
  v_cvt_pk_bf16_f32 v44, v100, v101
  v_cvt_pk_bf16_f32 v45, v102, v103
  v_cvt_pk_bf16_f32 v46, v104, v105
  v_cvt_pk_bf16_f32 v47, v106, v107
  v_cvt_pk_bf16_f32 v48, v108, v109
  v_cvt_pk_bf16_f32 v49, v110, v111
  v_cvt_pk_bf16_f32 v50, v112, v113
  v_cvt_pk_bf16_f32 v51, v114, v115
  buffer_store_dwordx4 v[44:47], v8, s[24:27], s32 offen offset:0 sc1
  buffer_store_dwordx4 v[48:51], v8, s[24:27], s32 offen offset:512 sc1
  s_and_b32 s13, s2, 7
  s_lshl_b32 s13, s13, 2
  s_bfe_u32 s14, s2, 0x20003
  s_add_u32 s13, s13, s14
  s_lshr_b32 s14, s2, 5
  s_lshl_b32 s34, s13, 16
  s_mov_b32 s20, s10
  s_mov_b32 s21, s11
  s_mov_b32 s22, 0x200000
  s_mov_b32 s23, 0x20000
  s_add_u32 s24, s10, 0x200000
  s_addc_u32 s25, s11, 0
  s_mov_b32 s26, 0x200000
  s_mov_b32 s27, 0x20000
  s_add_u32 s28, s10, 0x400000
  s_addc_u32 s29, s11, 0
  s_mov_b32 s30, 0x200000
  s_mov_b32 s31, 0x20000
  s_add_u32 s44, s10, 0xa00000
  s_addc_u32 s45, s11, 0
  s_mov_b32 s46, 0x200000
  s_mov_b32 s47, 0x20000
  s_lshl2_add_u32 s16, s14, s12
  s_lshl_b32 s48, s16, 10
  s_add_u32 s48, s48, s34
  s_add_u32 s49, s48, 512
  v_and_b32 v4, 31, v1
  v_lshrrev_b32 v5, 5, v1
  v_lshlrev_b32 v2, 15, v5
  v_lshl_add_u32 v2, v4, 4, v2
  v_and_b32 v3, 15, v1
  v_lshlrev_b32 v3, 4, v3
  v_lshl_add_u32 v3, v5, 8, v3
  v_lshlrev_b32 v140, 4, v1
  v_add_u32 v140, 131072, v140
  v_and_b32 v6, 27, v1
  v_cmp_eq_u32 vcc, 16, v6
  v_mov_b32 v6, 133136
  v_mov_b32 v7, 133120
  v_cndmask_b32 v6, v6, v7, vcc
  v_cmp_gt_u32 vcc, 16, v4
  v_add_u32 v141, 132096, v3
  s_nop 0
  v_cndmask_b32 v141, v6, v141, vcc
  v_add_u32 v142, 132608, v3
  v_cndmask_b32 v142, v6, v142, vcc
  v_mov_b32 v108, 0
  v_mov_b32 v109, 0
  v_mov_b32 v110, 0
  v_mov_b32 v111, 0
  v_mov_b32 v112, 0
  v_mov_b32 v113, 0
  v_mov_b32 v114, 0
  v_mov_b32 v115, 0
  v_mov_b32 v116, 0
  v_mov_b32 v117, 0
  v_mov_b32 v118, 0
  v_mov_b32 v119, 0
  v_mov_b32 v120, 0
  v_mov_b32 v121, 0
  v_mov_b32 v122, 0
  v_mov_b32 v123, 0
  v_mov_b32 v124, 0
  v_mov_b32 v125, 0
  v_mov_b32 v126, 0
  v_mov_b32 v127, 0
  v_mov_b32 v128, 0
  v_mov_b32 v129, 0
  v_mov_b32 v130, 0
  v_mov_b32 v131, 0
  v_mov_b32 v132, 0
  v_mov_b32 v133, 0
  v_mov_b32 v134, 0
  v_mov_b32 v135, 0
  v_mov_b32 v136, 0
  v_mov_b32 v137, 0
  v_mov_b32 v138, 0
  v_mov_b32 v139, 0
  v_mov_b32 v56, 0
  v_mov_b32 v104, 0
  v_mov_b32 v57, 0
  v_mov_b32 v105, 0
  v_mov_b32 v58, 0
  v_mov_b32 v106, 0
  v_mov_b32 v59, 0
  v_mov_b32 v107, 0
  v_mov_b32 v143, 156096
  v_mov_b32 v145, 1
  s_lshl_b32 s17, s12, 2
  s_add_u32 s17, s17, 156104
  v_mov_b32 v144, s17
  v_mov_b32 v9, 156100
  v_mov_b32 v10, 1
  s_waitcnt vmcnt(4)
  s_mov_b64 exec, 1
  ds_add_u32 v9, v10
  s_mov_b64 exec, -1
  v_mov_b32 v9, 156060
  v_mov_b32 v10, 1
  s_waitcnt vmcnt(0)
  s_mov_b64 exec, 1
  ds_add_u32 v9, v10
  s_mov_b64 exec, -1
  s_branch f_attn
p1_type1:
  v_lshrrev_b32 v10, 4, v1
  v_xor_b32 v10, v10, v1
  v_and_b32 v10, 1, v10
  v_cmp_eq_u32 vcc, 0, v10
  v_mov_b32 v10, 0x3f803f80
  s_lshl_b32 s17, s12, 8
  s_add_u32 s17, s17, 107008
  v_cndmask_b32 v44, 0, v10, vcc
  v_cndmask_b32 v45, 0, v10, vcc
  v_cndmask_b32 v46, 0, v10, vcc
  v_cndmask_b32 v47, 0, v10, vcc
  v_lshl_add_u32 v10, v2, 3, s17
  v_xor_b32 v11, 256, v10
  s_lshl1_add_u32 s32, s15, s19
  s_lshl_b32 s32, s32, 17
  s_add_u32 s33, s32, 65536
  s_lshl2_add_u32 s34, s13, s41
  v_mov_b32 v150, 156088
  s_lshl_b32 s17, s41, 10
  s_add_u32 s17, s17, 98304
  v_lshl_add_u32 v148, v1, 4, s17
  v_xor_b32 v149, 1024, v148
  s_add_u32 s36, s10, 0x1300000
  s_addc_u32 s37, s11, 0
  s_mov_b32 s38, 0x9c000
  s_mov_b32 s39, 0x20000
  s_add_u32 s20, s10, 0x200000
  s_addc_u32 s21, s11, 0
  s_mov_b32 s22, 0x200000
  s_mov_b32 s23, 0x20000
  s_lshl_b32 s17, s34, 5
  v_and_b32 v5, 31, v1
  v_add_u32 v5, s17, v5
  v_lshrrev_b32 v6, 5, v1
  v_lshlrev_b32 v4, 15, v6
  v_lshl_add_u32 v4, v5, 4, v4
  v_xor_b32 v5, 512, v4
  s_lshl1_add_u32 s17, s41, s19
  s_lshl_b32 s17, s17, 12
  s_add_u32 s17, s17, 32768
  v_lshl_add_u32 v2, v1, 4, s17
  v_xor_b32 v7, 8192, v2
  s_lshl_b32 s17, s18, 3
  s_add_u32 s17, s17, 156072
  v_min_u32 v3, 1, v1
  v_lshl_add_u32 v3, v3, 2, s17
  s_barrier
  ds_read_b128 v[12:15], v152 offset:0
  ds_read_b128 v[16:19], v156 offset:0
  ds_read_b64_tr_b16 v[20:21], v120 offset:0
  ds_read_b64_tr_b16 v[22:23], v120 offset:512
  ds_read_b64_tr_b16 v[24:25], v120 offset:8192
  ds_read_b64_tr_b16 v[26:27], v120 offset:8704
  s_waitcnt lgkmcnt(0)
  v_mfma_f32_32x32x16_bf16 v[52:67], v[20:23], v[12:15], 0
  ds_read_b128 v[28:31], v153 offset:0
  ds_read_b128 v[32:35], v157 offset:0
  v_lshlrev_b32 v144, 16, v12
  v_and_b32 v145, s35, v12
  v_fmac_f32 v48, v144, v144
  v_mfma_f32_32x32x16_bf16 v[68:83], v[20:23], v[16:19], 0
  ds_read_b64_tr_b16 v[36:37], v120 offset:2048
  ds_read_b64_tr_b16 v[38:39], v120 offset:2560
  v_fmac_f32 v49, v145, v145
  v_lshlrev_b32 v146, 16, v13
  v_and_b32 v147, s35, v13
  v_mfma_f32_32x32x16_bf16 v[84:99], v[24:27], v[12:15], 0
  ds_read_b64_tr_b16 v[40:41], v120 offset:10240
  ds_read_b64_tr_b16 v[42:43], v120 offset:10752
  v_fmac_f32 v48, v146, v146
  v_fmac_f32 v49, v147, v147
  v_mfma_f32_32x32x16_bf16 v[100:115], v[24:27], v[16:19], 0
  v_lshlrev_b32 v144, 16, v14
  v_and_b32 v145, s35, v14
  v_fmac_f32 v48, v144, v144
  v_fmac_f32 v49, v145, v145
  v_lshlrev_b32 v146, 16, v15
  v_and_b32 v147, s35, v15
  v_mfma_f32_16x16x32_bf16 v[116:119], v[44:47], v[12:15], 0
  v_fmac_f32 v48, v146, v146
  v_fmac_f32 v49, v147, v147
  v_mfma_f32_16x16x32_bf16 v[124:127], v[44:47], v[20:23], 0
  v_mfma_f32_16x16x32_bf16 v[128:131], v[44:47], v[24:27], 0
  s_waitcnt lgkmcnt(0)
  v_mfma_f32_32x32x16_bf16 v[52:67], v[36:39], v[28:31], v[52:67]
  ds_read_b128 v[12:15], v154 offset:0
  ds_read_b128 v[16:19], v158 offset:0
  v_lshlrev_b32 v144, 16, v28
  v_and_b32 v145, s35, v28
  v_fmac_f32 v48, v144, v144
  v_mfma_f32_32x32x16_bf16 v[68:83], v[36:39], v[32:35], v[68:83]
  ds_read_b64_tr_b16 v[20:21], v121 offset:0
  ds_read_b64_tr_b16 v[22:23], v121 offset:512
  v_fmac_f32 v49, v145, v145
  v_lshlrev_b32 v146, 16, v29
  v_and_b32 v147, s35, v29
  v_mfma_f32_32x32x16_bf16 v[84:99], v[40:43], v[28:31], v[84:99]
  ds_read_b64_tr_b16 v[24:25], v121 offset:8192
  ds_read_b64_tr_b16 v[26:27], v121 offset:8704
  v_fmac_f32 v48, v146, v146
  v_fmac_f32 v49, v147, v147
  v_mfma_f32_32x32x16_bf16 v[100:115], v[40:43], v[32:35], v[100:115]
  v_lshlrev_b32 v144, 16, v30
  v_and_b32 v145, s35, v30
  v_fmac_f32 v48, v144, v144
  v_fmac_f32 v49, v145, v145
  v_lshlrev_b32 v146, 16, v31
  v_and_b32 v147, s35, v31
  v_mfma_f32_16x16x32_bf16 v[116:119], v[44:47], v[28:31], v[116:119]
  v_fmac_f32 v48, v146, v146
  v_fmac_f32 v49, v147, v147
  v_mfma_f32_16x16x32_bf16 v[124:127], v[44:47], v[36:39], v[124:127]
  v_mfma_f32_16x16x32_bf16 v[128:131], v[44:47], v[40:43], v[128:131]
  s_waitcnt lgkmcnt(0)
  v_mfma_f32_32x32x16_bf16 v[52:67], v[20:23], v[12:15], v[52:67]
  ds_read_b128 v[28:31], v155 offset:0
  ds_read_b128 v[32:35], v159 offset:0
  v_lshlrev_b32 v144, 16, v12
  v_and_b32 v145, s35, v12
  v_fmac_f32 v48, v144, v144
  v_mfma_f32_32x32x16_bf16 v[68:83], v[20:23], v[16:19], v[68:83]
  ds_read_b64_tr_b16 v[36:37], v121 offset:2048
  ds_read_b64_tr_b16 v[38:39], v121 offset:2560
  v_fmac_f32 v49, v145, v145
  v_lshlrev_b32 v146, 16, v13
  v_and_b32 v147, s35, v13
  v_mfma_f32_32x32x16_bf16 v[84:99], v[24:27], v[12:15], v[84:99]
  ds_read_b64_tr_b16 v[40:41], v121 offset:10240
  ds_read_b64_tr_b16 v[42:43], v121 offset:10752
  v_fmac_f32 v48, v146, v146
  v_fmac_f32 v49, v147, v147
  v_mfma_f32_32x32x16_bf16 v[100:115], v[24:27], v[16:19], v[100:115]
  v_lshlrev_b32 v144, 16, v14
  v_and_b32 v145, s35, v14
  v_fmac_f32 v48, v144, v144
  v_fmac_f32 v49, v145, v145
  v_lshlrev_b32 v146, 16, v15
  v_and_b32 v147, s35, v15
  v_mfma_f32_16x16x32_bf16 v[116:119], v[44:47], v[12:15], v[116:119]
  v_fmac_f32 v48, v146, v146
  v_fmac_f32 v49, v147, v147
  s_waitcnt lgkmcnt(0)
  v_mfma_f32_32x32x16_bf16 v[52:67], v[36:39], v[28:31], v[52:67]
  s_barrier
  ds_read_b128 v[12:15], v152 offset:32768
  ds_read_b128 v[16:19], v156 offset:32768
  v_lshlrev_b32 v144, 16, v28
  v_and_b32 v145, s35, v28
  v_fmac_f32 v48, v144, v144
  v_mfma_f32_32x32x16_bf16 v[68:83], v[36:39], v[32:35], v[68:83]
  ds_read_b64_tr_b16 v[20:21], v120 offset:32768
  ds_read_b64_tr_b16 v[22:23], v120 offset:33280
  v_fmac_f32 v49, v145, v145
  v_lshlrev_b32 v146, 16, v29
  v_and_b32 v147, s35, v29
  v_mfma_f32_32x32x16_bf16 v[84:99], v[40:43], v[28:31], v[84:99]
  ds_read_b64_tr_b16 v[24:25], v120 offset:40960
  ds_read_b64_tr_b16 v[26:27], v120 offset:41472
  v_fmac_f32 v48, v146, v146
  v_fmac_f32 v49, v147, v147
  v_mfma_f32_32x32x16_bf16 v[100:115], v[40:43], v[32:35], v[100:115]
  v_lshlrev_b32 v144, 16, v30
  v_and_b32 v145, s35, v30
  v_fmac_f32 v48, v144, v144
  v_fmac_f32 v49, v145, v145
  v_lshlrev_b32 v146, 16, v31
  v_and_b32 v147, s35, v31
  v_mfma_f32_16x16x32_bf16 v[116:119], v[44:47], v[28:31], v[116:119]
  v_fmac_f32 v48, v146, v146
  v_fmac_f32 v49, v147, v147
  s_waitcnt lgkmcnt(0)
  v_mfma_f32_32x32x16_bf16 v[52:67], v[20:23], v[12:15], v[52:67]
  ds_read_b128 v[28:31], v153 offset:32768
  ds_read_b128 v[32:35], v157 offset:32768
  v_lshlrev_b32 v144, 16, v12
  v_and_b32 v145, s35, v12
  v_fmac_f32 v48, v144, v144
  v_mfma_f32_32x32x16_bf16 v[68:83], v[20:23], v[16:19], v[68:83]
  ds_read_b64_tr_b16 v[36:37], v120 offset:34816
  ds_read_b64_tr_b16 v[38:39], v120 offset:35328
  v_fmac_f32 v49, v145, v145
  v_lshlrev_b32 v146, 16, v13
  v_and_b32 v147, s35, v13
  v_mfma_f32_32x32x16_bf16 v[84:99], v[24:27], v[12:15], v[84:99]
  ds_read_b64_tr_b16 v[40:41], v120 offset:43008
  ds_read_b64_tr_b16 v[42:43], v120 offset:43520
  v_fmac_f32 v48, v146, v146
  v_fmac_f32 v49, v147, v147
  v_mfma_f32_32x32x16_bf16 v[100:115], v[24:27], v[16:19], v[100:115]
  v_lshlrev_b32 v144, 16, v14
  v_and_b32 v145, s35, v14
  v_fmac_f32 v48, v144, v144
  v_fmac_f32 v49, v145, v145
  v_lshlrev_b32 v146, 16, v15
  v_and_b32 v147, s35, v15
  v_mfma_f32_16x16x32_bf16 v[116:119], v[44:47], v[12:15], v[116:119]
  v_fmac_f32 v48, v146, v146
  v_fmac_f32 v49, v147, v147
  v_mfma_f32_16x16x32_bf16 v[124:127], v[44:47], v[20:23], v[124:127]
  v_mfma_f32_16x16x32_bf16 v[128:131], v[44:47], v[24:27], v[128:131]
  s_waitcnt lgkmcnt(0)
  v_mfma_f32_32x32x16_bf16 v[52:67], v[36:39], v[28:31], v[52:67]
  ds_read_b128 v[12:15], v154 offset:32768
  ds_read_b128 v[16:19], v158 offset:32768
  v_lshlrev_b32 v144, 16, v28
  v_and_b32 v145, s35, v28
  v_fmac_f32 v48, v144, v144
  v_mfma_f32_32x32x16_bf16 v[68:83], v[36:39], v[32:35], v[68:83]
  ds_read_b64_tr_b16 v[20:21], v121 offset:32768
  ds_read_b64_tr_b16 v[22:23], v121 offset:33280
  v_fmac_f32 v49, v145, v145
  v_lshlrev_b32 v146, 16, v29
  v_and_b32 v147, s35, v29
  v_mfma_f32_32x32x16_bf16 v[84:99], v[40:43], v[28:31], v[84:99]
  ds_read_b64_tr_b16 v[24:25], v121 offset:40960
  ds_read_b64_tr_b16 v[26:27], v121 offset:41472
  v_fmac_f32 v48, v146, v146
  v_fmac_f32 v49, v147, v147
  v_mfma_f32_32x32x16_bf16 v[100:115], v[40:43], v[32:35], v[100:115]
  v_lshlrev_b32 v144, 16, v30
  v_and_b32 v145, s35, v30
  v_fmac_f32 v48, v144, v144
  v_fmac_f32 v49, v145, v145
  v_lshlrev_b32 v146, 16, v31
  v_and_b32 v147, s35, v31
  v_mfma_f32_16x16x32_bf16 v[116:119], v[44:47], v[28:31], v[116:119]
  v_fmac_f32 v48, v146, v146
  v_fmac_f32 v49, v147, v147
  v_mfma_f32_16x16x32_bf16 v[124:127], v[44:47], v[36:39], v[124:127]
  v_mfma_f32_16x16x32_bf16 v[128:131], v[44:47], v[40:43], v[128:131]
  s_waitcnt lgkmcnt(0)
  v_mfma_f32_32x32x16_bf16 v[52:67], v[20:23], v[12:15], v[52:67]
  ds_read_b128 v[28:31], v155 offset:32768
  ds_read_b128 v[32:35], v159 offset:32768
  v_lshlrev_b32 v144, 16, v12
  v_and_b32 v145, s35, v12
  v_fmac_f32 v48, v144, v144
  v_mfma_f32_32x32x16_bf16 v[68:83], v[20:23], v[16:19], v[68:83]
  ds_read_b64_tr_b16 v[36:37], v121 offset:34816
  ds_read_b64_tr_b16 v[38:39], v121 offset:35328
  v_fmac_f32 v49, v145, v145
  v_lshlrev_b32 v146, 16, v13
  v_and_b32 v147, s35, v13
  v_mfma_f32_32x32x16_bf16 v[84:99], v[24:27], v[12:15], v[84:99]
  ds_read_b64_tr_b16 v[40:41], v121 offset:43008
  ds_read_b64_tr_b16 v[42:43], v121 offset:43520
  v_fmac_f32 v48, v146, v146
  v_fmac_f32 v49, v147, v147
  v_mfma_f32_32x32x16_bf16 v[100:115], v[24:27], v[16:19], v[100:115]
  v_lshlrev_b32 v144, 16, v14
  v_and_b32 v145, s35, v14
  v_fmac_f32 v48, v144, v144
  v_fmac_f32 v49, v145, v145
  v_lshlrev_b32 v146, 16, v15
  v_and_b32 v147, s35, v15
  v_mfma_f32_16x16x32_bf16 v[116:119], v[44:47], v[12:15], v[116:119]
  v_fmac_f32 v48, v146, v146
  v_fmac_f32 v49, v147, v147
  s_waitcnt lgkmcnt(0)
  v_mfma_f32_32x32x16_bf16 v[52:67], v[36:39], v[28:31], v[52:67]
  s_barrier
  ds_read_b128 v[12:15], v160 offset:0
  ds_read_b128 v[16:19], v164 offset:0
  v_lshlrev_b32 v144, 16, v28
  v_and_b32 v145, s35, v28
  v_fmac_f32 v48, v144, v144
  v_mfma_f32_32x32x16_bf16 v[68:83], v[36:39], v[32:35], v[68:83]
  ds_read_b64_tr_b16 v[20:21], v122 offset:0
  ds_read_b64_tr_b16 v[22:23], v122 offset:512
  v_fmac_f32 v49, v145, v145
  v_lshlrev_b32 v146, 16, v29
  v_and_b32 v147, s35, v29
  v_mfma_f32_32x32x16_bf16 v[84:99], v[40:43], v[28:31], v[84:99]
  ds_read_b64_tr_b16 v[24:25], v122 offset:8192
  ds_read_b64_tr_b16 v[26:27], v122 offset:8704
  v_fmac_f32 v48, v146, v146
  v_fmac_f32 v49, v147, v147
  v_mfma_f32_32x32x16_bf16 v[100:115], v[40:43], v[32:35], v[100:115]
  v_lshlrev_b32 v144, 16, v30
  v_and_b32 v145, s35, v30
  v_fmac_f32 v48, v144, v144
  v_fmac_f32 v49, v145, v145
  v_lshlrev_b32 v146, 16, v31
  v_and_b32 v147, s35, v31
  v_mfma_f32_16x16x32_bf16 v[116:119], v[44:47], v[28:31], v[116:119]
  v_fmac_f32 v48, v146, v146
  v_fmac_f32 v49, v147, v147
  s_waitcnt lgkmcnt(0)
  v_mfma_f32_32x32x16_bf16 v[52:67], v[20:23], v[12:15], v[52:67]
  ds_read_b128 v[28:31], v161 offset:0
  ds_read_b128 v[32:35], v165 offset:0
  v_lshlrev_b32 v144, 16, v12
  v_and_b32 v145, s35, v12
  v_fmac_f32 v48, v144, v144
  v_mfma_f32_32x32x16_bf16 v[68:83], v[20:23], v[16:19], v[68:83]
  ds_read_b64_tr_b16 v[36:37], v122 offset:2048
  ds_read_b64_tr_b16 v[38:39], v122 offset:2560
  v_fmac_f32 v49, v145, v145
  v_lshlrev_b32 v146, 16, v13
  v_and_b32 v147, s35, v13
  v_mfma_f32_32x32x16_bf16 v[84:99], v[24:27], v[12:15], v[84:99]
  ds_read_b64_tr_b16 v[40:41], v122 offset:10240
  ds_read_b64_tr_b16 v[42:43], v122 offset:10752
  v_fmac_f32 v48, v146, v146
  v_fmac_f32 v49, v147, v147
  v_mfma_f32_32x32x16_bf16 v[100:115], v[24:27], v[16:19], v[100:115]
  v_lshlrev_b32 v144, 16, v14
  v_and_b32 v145, s35, v14
  v_fmac_f32 v48, v144, v144
  v_fmac_f32 v49, v145, v145
  v_lshlrev_b32 v146, 16, v15
  v_and_b32 v147, s35, v15
  v_mfma_f32_16x16x32_bf16 v[116:119], v[44:47], v[12:15], v[116:119]
  v_fmac_f32 v48, v146, v146
  v_fmac_f32 v49, v147, v147
  v_mfma_f32_16x16x32_bf16 v[124:127], v[44:47], v[20:23], v[124:127]
  v_mfma_f32_16x16x32_bf16 v[128:131], v[44:47], v[24:27], v[128:131]
  s_waitcnt lgkmcnt(0)
  v_mfma_f32_32x32x16_bf16 v[52:67], v[36:39], v[28:31], v[52:67]
  ds_read_b128 v[12:15], v162 offset:0
  ds_read_b128 v[16:19], v166 offset:0
  v_lshlrev_b32 v144, 16, v28
  v_and_b32 v145, s35, v28
  v_fmac_f32 v48, v144, v144
  v_mfma_f32_32x32x16_bf16 v[68:83], v[36:39], v[32:35], v[68:83]
  ds_read_b64_tr_b16 v[20:21], v123 offset:0
  ds_read_b64_tr_b16 v[22:23], v123 offset:512
  v_fmac_f32 v49, v145, v145
  v_lshlrev_b32 v146, 16, v29
  v_and_b32 v147, s35, v29
  v_mfma_f32_32x32x16_bf16 v[84:99], v[40:43], v[28:31], v[84:99]
  ds_read_b64_tr_b16 v[24:25], v123 offset:8192
  ds_read_b64_tr_b16 v[26:27], v123 offset:8704
  v_fmac_f32 v48, v146, v146
  v_fmac_f32 v49, v147, v147
  v_mfma_f32_32x32x16_bf16 v[100:115], v[40:43], v[32:35], v[100:115]
  v_lshlrev_b32 v144, 16, v30
  v_and_b32 v145, s35, v30
  v_fmac_f32 v48, v144, v144
  v_fmac_f32 v49, v145, v145
  v_lshlrev_b32 v146, 16, v31
  v_and_b32 v147, s35, v31
  v_mfma_f32_16x16x32_bf16 v[116:119], v[44:47], v[28:31], v[116:119]
  v_fmac_f32 v48, v146, v146
  v_fmac_f32 v49, v147, v147
  v_mfma_f32_16x16x32_bf16 v[124:127], v[44:47], v[36:39], v[124:127]
  v_mfma_f32_16x16x32_bf16 v[128:131], v[44:47], v[40:43], v[128:131]
  s_waitcnt lgkmcnt(0)
  v_mfma_f32_32x32x16_bf16 v[52:67], v[20:23], v[12:15], v[52:67]
  ds_read_b128 v[28:31], v163 offset:0
  ds_read_b128 v[32:35], v167 offset:0
  v_lshlrev_b32 v144, 16, v12
  v_and_b32 v145, s35, v12
  v_fmac_f32 v48, v144, v144
  v_mfma_f32_32x32x16_bf16 v[68:83], v[20:23], v[16:19], v[68:83]
  ds_read_b64_tr_b16 v[36:37], v123 offset:2048
  ds_read_b64_tr_b16 v[38:39], v123 offset:2560
  v_fmac_f32 v49, v145, v145
  v_lshlrev_b32 v146, 16, v13
  v_and_b32 v147, s35, v13
  v_mfma_f32_32x32x16_bf16 v[84:99], v[24:27], v[12:15], v[84:99]
  ds_read_b64_tr_b16 v[40:41], v123 offset:10240
  ds_read_b64_tr_b16 v[42:43], v123 offset:10752
  v_fmac_f32 v48, v146, v146
  v_fmac_f32 v49, v147, v147
  v_mfma_f32_32x32x16_bf16 v[100:115], v[24:27], v[16:19], v[100:115]
  v_lshlrev_b32 v144, 16, v14
  v_and_b32 v145, s35, v14
  v_fmac_f32 v48, v144, v144
  v_fmac_f32 v49, v145, v145
  v_lshlrev_b32 v146, 16, v15
  v_and_b32 v147, s35, v15
  v_mfma_f32_16x16x32_bf16 v[116:119], v[44:47], v[12:15], v[116:119]
  v_fmac_f32 v48, v146, v146
  v_fmac_f32 v49, v147, v147
  s_waitcnt lgkmcnt(0)
  v_mfma_f32_32x32x16_bf16 v[52:67], v[36:39], v[28:31], v[52:67]
  s_barrier
  ds_read_b128 v[12:15], v152 offset:0
  ds_read_b128 v[16:19], v156 offset:0
  v_lshlrev_b32 v144, 16, v28
  v_and_b32 v145, s35, v28
  v_fmac_f32 v48, v144, v144
  v_mfma_f32_32x32x16_bf16 v[68:83], v[36:39], v[32:35], v[68:83]
  ds_read_b64_tr_b16 v[20:21], v120 offset:0
  ds_read_b64_tr_b16 v[22:23], v120 offset:512
  v_fmac_f32 v49, v145, v145
  v_lshlrev_b32 v146, 16, v29
  v_and_b32 v147, s35, v29
  v_mfma_f32_32x32x16_bf16 v[84:99], v[40:43], v[28:31], v[84:99]
  ds_read_b64_tr_b16 v[24:25], v120 offset:8192
  ds_read_b64_tr_b16 v[26:27], v120 offset:8704
  v_fmac_f32 v48, v146, v146
  v_fmac_f32 v49, v147, v147
  v_mfma_f32_32x32x16_bf16 v[100:115], v[40:43], v[32:35], v[100:115]
  v_lshlrev_b32 v144, 16, v30
  v_and_b32 v145, s35, v30
  v_fmac_f32 v48, v144, v144
  v_fmac_f32 v49, v145, v145
  v_lshlrev_b32 v146, 16, v31
  v_and_b32 v147, s35, v31
  v_mfma_f32_16x16x32_bf16 v[116:119], v[44:47], v[28:31], v[116:119]
  v_fmac_f32 v48, v146, v146
  v_fmac_f32 v49, v147, v147
  s_waitcnt lgkmcnt(0)
  v_mfma_f32_32x32x16_bf16 v[52:67], v[20:23], v[12:15], v[52:67]
  ds_read_b128 v[28:31], v153 offset:0
  ds_read_b128 v[32:35], v157 offset:0
  v_lshlrev_b32 v144, 16, v12
  v_and_b32 v145, s35, v12
  v_fmac_f32 v48, v144, v144
  v_mfma_f32_32x32x16_bf16 v[68:83], v[20:23], v[16:19], v[68:83]
  ds_read_b64_tr_b16 v[36:37], v120 offset:2048
  ds_read_b64_tr_b16 v[38:39], v120 offset:2560
  v_fmac_f32 v49, v145, v145
  v_lshlrev_b32 v146, 16, v13
  v_and_b32 v147, s35, v13
  v_mfma_f32_32x32x16_bf16 v[84:99], v[24:27], v[12:15], v[84:99]
  ds_read_b64_tr_b16 v[40:41], v120 offset:10240
  ds_read_b64_tr_b16 v[42:43], v120 offset:10752
  v_fmac_f32 v48, v146, v146
  v_fmac_f32 v49, v147, v147
  v_mfma_f32_32x32x16_bf16 v[100:115], v[24:27], v[16:19], v[100:115]
  v_lshlrev_b32 v144, 16, v14
  v_and_b32 v145, s35, v14
  v_fmac_f32 v48, v144, v144
  v_fmac_f32 v49, v145, v145
  v_lshlrev_b32 v146, 16, v15
  v_and_b32 v147, s35, v15
  v_mfma_f32_16x16x32_bf16 v[116:119], v[44:47], v[12:15], v[116:119]
  v_fmac_f32 v48, v146, v146
  v_fmac_f32 v49, v147, v147
  v_mfma_f32_16x16x32_bf16 v[124:127], v[44:47], v[20:23], v[124:127]
  v_mfma_f32_16x16x32_bf16 v[128:131], v[44:47], v[24:27], v[128:131]
  s_waitcnt lgkmcnt(0)
  v_mfma_f32_32x32x16_bf16 v[52:67], v[36:39], v[28:31], v[52:67]
  ds_read_b128 v[12:15], v154 offset:0
  ds_read_b128 v[16:19], v158 offset:0
  v_lshlrev_b32 v144, 16, v28
  v_and_b32 v145, s35, v28
  v_fmac_f32 v48, v144, v144
  v_mfma_f32_32x32x16_bf16 v[68:83], v[36:39], v[32:35], v[68:83]
  ds_read_b64_tr_b16 v[20:21], v121 offset:0
  ds_read_b64_tr_b16 v[22:23], v121 offset:512
  v_fmac_f32 v49, v145, v145
  v_lshlrev_b32 v146, 16, v29
  v_and_b32 v147, s35, v29
  v_mfma_f32_32x32x16_bf16 v[84:99], v[40:43], v[28:31], v[84:99]
  ds_read_b64_tr_b16 v[24:25], v121 offset:8192
  ds_read_b64_tr_b16 v[26:27], v121 offset:8704
  v_fmac_f32 v48, v146, v146
  v_fmac_f32 v49, v147, v147
  v_mfma_f32_32x32x16_bf16 v[100:115], v[40:43], v[32:35], v[100:115]
  v_lshlrev_b32 v144, 16, v30
  v_and_b32 v145, s35, v30
  v_fmac_f32 v48, v144, v144
  v_fmac_f32 v49, v145, v145
  v_lshlrev_b32 v146, 16, v31
  v_and_b32 v147, s35, v31
  v_mfma_f32_16x16x32_bf16 v[116:119], v[44:47], v[28:31], v[116:119]
  v_fmac_f32 v48, v146, v146
  v_fmac_f32 v49, v147, v147
  v_mfma_f32_16x16x32_bf16 v[124:127], v[44:47], v[36:39], v[124:127]
  v_mfma_f32_16x16x32_bf16 v[128:131], v[44:47], v[40:43], v[128:131]
  s_waitcnt lgkmcnt(0)
  v_mfma_f32_32x32x16_bf16 v[52:67], v[20:23], v[12:15], v[52:67]
  ds_read_b128 v[28:31], v155 offset:0
  ds_read_b128 v[32:35], v159 offset:0
  v_lshlrev_b32 v144, 16, v12
  v_and_b32 v145, s35, v12
  v_fmac_f32 v48, v144, v144
  v_mfma_f32_32x32x16_bf16 v[68:83], v[20:23], v[16:19], v[68:83]
  ds_read_b64_tr_b16 v[36:37], v121 offset:2048
  ds_read_b64_tr_b16 v[38:39], v121 offset:2560
  v_fmac_f32 v49, v145, v145
  v_lshlrev_b32 v146, 16, v13
  v_and_b32 v147, s35, v13
  v_mfma_f32_32x32x16_bf16 v[84:99], v[24:27], v[12:15], v[84:99]
  ds_read_b64_tr_b16 v[40:41], v121 offset:10240
  ds_read_b64_tr_b16 v[42:43], v121 offset:10752
  v_fmac_f32 v48, v146, v146
  v_fmac_f32 v49, v147, v147
  v_mfma_f32_32x32x16_bf16 v[100:115], v[24:27], v[16:19], v[100:115]
  v_lshlrev_b32 v144, 16, v14
  v_and_b32 v145, s35, v14
  v_fmac_f32 v48, v144, v144
  v_fmac_f32 v49, v145, v145
  v_lshlrev_b32 v146, 16, v15
  v_and_b32 v147, s35, v15
  v_mfma_f32_16x16x32_bf16 v[116:119], v[44:47], v[12:15], v[116:119]
  v_fmac_f32 v48, v146, v146
  v_fmac_f32 v49, v147, v147
  s_waitcnt lgkmcnt(0)
  v_mfma_f32_32x32x16_bf16 v[52:67], v[36:39], v[28:31], v[52:67]
  s_barrier
  ds_read_b128 v[12:15], v152 offset:32768
  ds_read_b128 v[16:19], v156 offset:32768
  v_lshlrev_b32 v144, 16, v28
  v_and_b32 v145, s35, v28
  v_fmac_f32 v48, v144, v144
  v_mfma_f32_32x32x16_bf16 v[68:83], v[36:39], v[32:35], v[68:83]
  ds_read_b64_tr_b16 v[20:21], v120 offset:32768
  ds_read_b64_tr_b16 v[22:23], v120 offset:33280
  v_fmac_f32 v49, v145, v145
  v_lshlrev_b32 v146, 16, v29
  v_and_b32 v147, s35, v29
  v_mfma_f32_32x32x16_bf16 v[84:99], v[40:43], v[28:31], v[84:99]
  ds_read_b64_tr_b16 v[24:25], v120 offset:40960
  ds_read_b64_tr_b16 v[26:27], v120 offset:41472
  v_fmac_f32 v48, v146, v146
  v_fmac_f32 v49, v147, v147
  v_mfma_f32_32x32x16_bf16 v[100:115], v[40:43], v[32:35], v[100:115]
  v_lshlrev_b32 v144, 16, v30
  v_and_b32 v145, s35, v30
  v_fmac_f32 v48, v144, v144
  v_fmac_f32 v49, v145, v145
  v_lshlrev_b32 v146, 16, v31
  v_and_b32 v147, s35, v31
  v_mfma_f32_16x16x32_bf16 v[116:119], v[44:47], v[28:31], v[116:119]
  v_fmac_f32 v48, v146, v146
  v_fmac_f32 v49, v147, v147
  s_waitcnt lgkmcnt(0)
  v_mfma_f32_32x32x16_bf16 v[52:67], v[20:23], v[12:15], v[52:67]
  ds_read_b128 v[28:31], v153 offset:32768
  ds_read_b128 v[32:35], v157 offset:32768
  v_lshlrev_b32 v144, 16, v12
  v_and_b32 v145, s35, v12
  v_fmac_f32 v48, v144, v144
  v_mfma_f32_32x32x16_bf16 v[68:83], v[20:23], v[16:19], v[68:83]
  ds_read_b64_tr_b16 v[36:37], v120 offset:34816
  ds_read_b64_tr_b16 v[38:39], v120 offset:35328
  v_fmac_f32 v49, v145, v145
  v_lshlrev_b32 v146, 16, v13
  v_and_b32 v147, s35, v13
  v_mfma_f32_32x32x16_bf16 v[84:99], v[24:27], v[12:15], v[84:99]
  ds_read_b64_tr_b16 v[40:41], v120 offset:43008
  ds_read_b64_tr_b16 v[42:43], v120 offset:43520
  v_fmac_f32 v48, v146, v146
  v_fmac_f32 v49, v147, v147
  v_mfma_f32_32x32x16_bf16 v[100:115], v[24:27], v[16:19], v[100:115]
  v_lshlrev_b32 v144, 16, v14
  v_and_b32 v145, s35, v14
  v_fmac_f32 v48, v144, v144
  v_fmac_f32 v49, v145, v145
  v_lshlrev_b32 v146, 16, v15
  v_and_b32 v147, s35, v15
  v_mfma_f32_16x16x32_bf16 v[116:119], v[44:47], v[12:15], v[116:119]
  v_fmac_f32 v48, v146, v146
  v_fmac_f32 v49, v147, v147
  v_mfma_f32_16x16x32_bf16 v[124:127], v[44:47], v[20:23], v[124:127]
  v_mfma_f32_16x16x32_bf16 v[128:131], v[44:47], v[24:27], v[128:131]
  s_waitcnt lgkmcnt(0)
  v_mfma_f32_32x32x16_bf16 v[52:67], v[36:39], v[28:31], v[52:67]
  ds_read_b128 v[12:15], v154 offset:32768
  ds_read_b128 v[16:19], v158 offset:32768
  v_lshlrev_b32 v144, 16, v28
  v_and_b32 v145, s35, v28
  v_fmac_f32 v48, v144, v144
  v_mfma_f32_32x32x16_bf16 v[68:83], v[36:39], v[32:35], v[68:83]
  ds_read_b64_tr_b16 v[20:21], v121 offset:32768
  ds_read_b64_tr_b16 v[22:23], v121 offset:33280
  v_fmac_f32 v49, v145, v145
  v_lshlrev_b32 v146, 16, v29
  v_and_b32 v147, s35, v29
  v_mfma_f32_32x32x16_bf16 v[84:99], v[40:43], v[28:31], v[84:99]
  ds_read_b64_tr_b16 v[24:25], v121 offset:40960
  ds_read_b64_tr_b16 v[26:27], v121 offset:41472
  v_fmac_f32 v48, v146, v146
  v_fmac_f32 v49, v147, v147
  v_mfma_f32_32x32x16_bf16 v[100:115], v[40:43], v[32:35], v[100:115]
  v_lshlrev_b32 v144, 16, v30
  v_and_b32 v145, s35, v30
  v_fmac_f32 v48, v144, v144
  v_fmac_f32 v49, v145, v145
  v_lshlrev_b32 v146, 16, v31
  v_and_b32 v147, s35, v31
  v_mfma_f32_16x16x32_bf16 v[116:119], v[44:47], v[28:31], v[116:119]
  v_fmac_f32 v48, v146, v146
  v_fmac_f32 v49, v147, v147
  v_mfma_f32_16x16x32_bf16 v[124:127], v[44:47], v[36:39], v[124:127]
  v_mfma_f32_16x16x32_bf16 v[128:131], v[44:47], v[40:43], v[128:131]
  s_waitcnt lgkmcnt(0)
  v_mfma_f32_32x32x16_bf16 v[52:67], v[20:23], v[12:15], v[52:67]
  ds_read_b128 v[28:31], v155 offset:32768
  ds_read_b128 v[32:35], v159 offset:32768
  v_lshlrev_b32 v144, 16, v12
  v_and_b32 v145, s35, v12
  v_fmac_f32 v48, v144, v144
  v_mfma_f32_32x32x16_bf16 v[68:83], v[20:23], v[16:19], v[68:83]
  ds_read_b64_tr_b16 v[36:37], v121 offset:34816
  ds_read_b64_tr_b16 v[38:39], v121 offset:35328
  v_fmac_f32 v49, v145, v145
  v_lshlrev_b32 v146, 16, v13
  v_and_b32 v147, s35, v13
  v_mfma_f32_32x32x16_bf16 v[84:99], v[24:27], v[12:15], v[84:99]
  ds_read_b64_tr_b16 v[40:41], v121 offset:43008
  ds_read_b64_tr_b16 v[42:43], v121 offset:43520
  v_fmac_f32 v48, v146, v146
  v_fmac_f32 v49, v147, v147
  v_mfma_f32_32x32x16_bf16 v[100:115], v[24:27], v[16:19], v[100:115]
  v_lshlrev_b32 v144, 16, v14
  v_and_b32 v145, s35, v14
  v_fmac_f32 v48, v144, v144
  v_fmac_f32 v49, v145, v145
  v_lshlrev_b32 v146, 16, v15
  v_and_b32 v147, s35, v15
  v_mfma_f32_16x16x32_bf16 v[116:119], v[44:47], v[12:15], v[116:119]
  v_fmac_f32 v48, v146, v146
  v_fmac_f32 v49, v147, v147
  s_waitcnt lgkmcnt(0)
  v_mfma_f32_32x32x16_bf16 v[52:67], v[36:39], v[28:31], v[52:67]
  s_barrier
  ds_read_b128 v[12:15], v160 offset:0
  ds_read_b128 v[16:19], v164 offset:0
  v_lshlrev_b32 v144, 16, v28
  v_and_b32 v145, s35, v28
  v_fmac_f32 v48, v144, v144
  v_mfma_f32_32x32x16_bf16 v[68:83], v[36:39], v[32:35], v[68:83]
  ds_read_b64_tr_b16 v[20:21], v122 offset:0
  ds_read_b64_tr_b16 v[22:23], v122 offset:512
  v_fmac_f32 v49, v145, v145
  v_lshlrev_b32 v146, 16, v29
  v_and_b32 v147, s35, v29
  v_mfma_f32_32x32x16_bf16 v[84:99], v[40:43], v[28:31], v[84:99]
  ds_read_b64_tr_b16 v[24:25], v122 offset:8192
  ds_read_b64_tr_b16 v[26:27], v122 offset:8704
  v_fmac_f32 v48, v146, v146
  v_fmac_f32 v49, v147, v147
  v_mfma_f32_32x32x16_bf16 v[100:115], v[40:43], v[32:35], v[100:115]
  v_lshlrev_b32 v144, 16, v30
  v_and_b32 v145, s35, v30
  v_fmac_f32 v48, v144, v144
  v_fmac_f32 v49, v145, v145
  v_lshlrev_b32 v146, 16, v31
  v_and_b32 v147, s35, v31
  v_mfma_f32_16x16x32_bf16 v[116:119], v[44:47], v[28:31], v[116:119]
  v_fmac_f32 v48, v146, v146
  v_fmac_f32 v49, v147, v147
  s_waitcnt lgkmcnt(0)
  v_mfma_f32_32x32x16_bf16 v[52:67], v[20:23], v[12:15], v[52:67]
  ds_read_b128 v[28:31], v161 offset:0
  ds_read_b128 v[32:35], v165 offset:0
  v_lshlrev_b32 v144, 16, v12
  v_and_b32 v145, s35, v12
  v_fmac_f32 v48, v144, v144
  v_mfma_f32_32x32x16_bf16 v[68:83], v[20:23], v[16:19], v[68:83]
  ds_read_b64_tr_b16 v[36:37], v122 offset:2048
  ds_read_b64_tr_b16 v[38:39], v122 offset:2560
  v_fmac_f32 v49, v145, v145
  v_lshlrev_b32 v146, 16, v13
  v_and_b32 v147, s35, v13
  v_mfma_f32_32x32x16_bf16 v[84:99], v[24:27], v[12:15], v[84:99]
  ds_read_b64_tr_b16 v[40:41], v122 offset:10240
  ds_read_b64_tr_b16 v[42:43], v122 offset:10752
  v_fmac_f32 v48, v146, v146
  v_fmac_f32 v49, v147, v147
  v_mfma_f32_32x32x16_bf16 v[100:115], v[24:27], v[16:19], v[100:115]
  v_lshlrev_b32 v144, 16, v14
  v_and_b32 v145, s35, v14
  v_fmac_f32 v48, v144, v144
  v_fmac_f32 v49, v145, v145
  v_lshlrev_b32 v146, 16, v15
  v_and_b32 v147, s35, v15
  v_mfma_f32_16x16x32_bf16 v[116:119], v[44:47], v[12:15], v[116:119]
  v_fmac_f32 v48, v146, v146
  v_fmac_f32 v49, v147, v147
  v_mfma_f32_16x16x32_bf16 v[124:127], v[44:47], v[20:23], v[124:127]
  v_mfma_f32_16x16x32_bf16 v[128:131], v[44:47], v[24:27], v[128:131]
  s_waitcnt lgkmcnt(0)
  v_mfma_f32_32x32x16_bf16 v[52:67], v[36:39], v[28:31], v[52:67]
  ds_read_b128 v[12:15], v162 offset:0
  ds_read_b128 v[16:19], v166 offset:0
  v_lshlrev_b32 v144, 16, v28
  v_and_b32 v145, s35, v28
  v_fmac_f32 v48, v144, v144
  v_mfma_f32_32x32x16_bf16 v[68:83], v[36:39], v[32:35], v[68:83]
  ds_read_b64_tr_b16 v[20:21], v123 offset:0
  ds_read_b64_tr_b16 v[22:23], v123 offset:512
  v_fmac_f32 v49, v145, v145
  v_lshlrev_b32 v146, 16, v29
  v_and_b32 v147, s35, v29
  v_mfma_f32_32x32x16_bf16 v[84:99], v[40:43], v[28:31], v[84:99]
  ds_read_b64_tr_b16 v[24:25], v123 offset:8192
  ds_read_b64_tr_b16 v[26:27], v123 offset:8704
  v_fmac_f32 v48, v146, v146
  v_fmac_f32 v49, v147, v147
  v_mfma_f32_32x32x16_bf16 v[100:115], v[40:43], v[32:35], v[100:115]
  v_lshlrev_b32 v144, 16, v30
  v_and_b32 v145, s35, v30
  v_fmac_f32 v48, v144, v144
  v_fmac_f32 v49, v145, v145
  v_lshlrev_b32 v146, 16, v31
  v_and_b32 v147, s35, v31
  v_mfma_f32_16x16x32_bf16 v[116:119], v[44:47], v[28:31], v[116:119]
  v_fmac_f32 v48, v146, v146
  v_fmac_f32 v49, v147, v147
  v_mfma_f32_16x16x32_bf16 v[124:127], v[44:47], v[36:39], v[124:127]
  v_mfma_f32_16x16x32_bf16 v[128:131], v[44:47], v[40:43], v[128:131]
  s_waitcnt lgkmcnt(0)
  v_mfma_f32_32x32x16_bf16 v[52:67], v[20:23], v[12:15], v[52:67]
  ds_read_b128 v[28:31], v163 offset:0
  ds_read_b128 v[32:35], v167 offset:0
  v_lshlrev_b32 v144, 16, v12
  v_and_b32 v145, s35, v12
  v_fmac_f32 v48, v144, v144
  v_mfma_f32_32x32x16_bf16 v[68:83], v[20:23], v[16:19], v[68:83]
  ds_read_b64_tr_b16 v[36:37], v123 offset:2048
  ds_read_b64_tr_b16 v[38:39], v123 offset:2560
  v_fmac_f32 v49, v145, v145
  v_lshlrev_b32 v146, 16, v13
  v_and_b32 v147, s35, v13
  v_mfma_f32_32x32x16_bf16 v[84:99], v[24:27], v[12:15], v[84:99]
  ds_read_b64_tr_b16 v[40:41], v123 offset:10240
  ds_read_b64_tr_b16 v[42:43], v123 offset:10752
  v_fmac_f32 v48, v146, v146
  v_fmac_f32 v49, v147, v147
  v_mfma_f32_32x32x16_bf16 v[100:115], v[24:27], v[16:19], v[100:115]
  v_lshlrev_b32 v144, 16, v14
  v_and_b32 v145, s35, v14
  v_fmac_f32 v48, v144, v144
  v_fmac_f32 v49, v145, v145
  v_lshlrev_b32 v146, 16, v15
  v_and_b32 v147, s35, v15
  v_mfma_f32_16x16x32_bf16 v[116:119], v[44:47], v[12:15], v[116:119]
  v_fmac_f32 v48, v146, v146
  v_fmac_f32 v49, v147, v147
  s_waitcnt lgkmcnt(0)
  v_mfma_f32_32x32x16_bf16 v[52:67], v[36:39], v[28:31], v[52:67]
  s_barrier
  ds_read_b128 v[12:15], v152 offset:0
  ds_read_b128 v[16:19], v156 offset:0
  v_lshlrev_b32 v144, 16, v28
  v_and_b32 v145, s35, v28
  v_fmac_f32 v48, v144, v144
  v_mfma_f32_32x32x16_bf16 v[68:83], v[36:39], v[32:35], v[68:83]
  ds_read_b64_tr_b16 v[20:21], v120 offset:0
  ds_read_b64_tr_b16 v[22:23], v120 offset:512
  v_fmac_f32 v49, v145, v145
  v_lshlrev_b32 v146, 16, v29
  v_and_b32 v147, s35, v29
  v_mfma_f32_32x32x16_bf16 v[84:99], v[40:43], v[28:31], v[84:99]
  ds_read_b64_tr_b16 v[24:25], v120 offset:8192
  ds_read_b64_tr_b16 v[26:27], v120 offset:8704
  v_fmac_f32 v48, v146, v146
  v_fmac_f32 v49, v147, v147
  v_mfma_f32_32x32x16_bf16 v[100:115], v[40:43], v[32:35], v[100:115]
  v_lshlrev_b32 v144, 16, v30
  v_and_b32 v145, s35, v30
  v_fmac_f32 v48, v144, v144
  v_fmac_f32 v49, v145, v145
  v_lshlrev_b32 v146, 16, v31
  v_and_b32 v147, s35, v31
  v_mfma_f32_16x16x32_bf16 v[116:119], v[44:47], v[28:31], v[116:119]
  v_fmac_f32 v48, v146, v146
  v_fmac_f32 v49, v147, v147
  s_waitcnt lgkmcnt(0)
  v_mfma_f32_32x32x16_bf16 v[52:67], v[20:23], v[12:15], v[52:67]
  ds_read_b128 v[28:31], v153 offset:0
  ds_read_b128 v[32:35], v157 offset:0
  v_lshlrev_b32 v144, 16, v12
  v_and_b32 v145, s35, v12
  v_fmac_f32 v48, v144, v144
  v_mfma_f32_32x32x16_bf16 v[68:83], v[20:23], v[16:19], v[68:83]
  ds_read_b64_tr_b16 v[36:37], v120 offset:2048
  ds_read_b64_tr_b16 v[38:39], v120 offset:2560
  v_fmac_f32 v49, v145, v145
  v_lshlrev_b32 v146, 16, v13
  v_and_b32 v147, s35, v13
  v_mfma_f32_32x32x16_bf16 v[84:99], v[24:27], v[12:15], v[84:99]
  ds_read_b64_tr_b16 v[40:41], v120 offset:10240
  ds_read_b64_tr_b16 v[42:43], v120 offset:10752
  v_fmac_f32 v48, v146, v146
  v_fmac_f32 v49, v147, v147
  v_mfma_f32_32x32x16_bf16 v[100:115], v[24:27], v[16:19], v[100:115]
  v_lshlrev_b32 v144, 16, v14
  v_and_b32 v145, s35, v14
  v_fmac_f32 v48, v144, v144
  v_fmac_f32 v49, v145, v145
  v_lshlrev_b32 v146, 16, v15
  v_and_b32 v147, s35, v15
  v_mfma_f32_16x16x32_bf16 v[116:119], v[44:47], v[12:15], v[116:119]
  v_fmac_f32 v48, v146, v146
  v_fmac_f32 v49, v147, v147
  v_mfma_f32_16x16x32_bf16 v[124:127], v[44:47], v[20:23], v[124:127]
  v_mfma_f32_16x16x32_bf16 v[128:131], v[44:47], v[24:27], v[128:131]
  s_waitcnt lgkmcnt(0)
  v_mfma_f32_32x32x16_bf16 v[52:67], v[36:39], v[28:31], v[52:67]
  ds_read_b128 v[12:15], v154 offset:0
  ds_read_b128 v[16:19], v158 offset:0
  v_lshlrev_b32 v144, 16, v28
  v_and_b32 v145, s35, v28
  v_fmac_f32 v48, v144, v144
  v_mfma_f32_32x32x16_bf16 v[68:83], v[36:39], v[32:35], v[68:83]
  ds_read_b64_tr_b16 v[20:21], v121 offset:0
  ds_read_b64_tr_b16 v[22:23], v121 offset:512
  v_fmac_f32 v49, v145, v145
  v_lshlrev_b32 v146, 16, v29
  v_and_b32 v147, s35, v29
  v_mfma_f32_32x32x16_bf16 v[84:99], v[40:43], v[28:31], v[84:99]
  ds_read_b64_tr_b16 v[24:25], v121 offset:8192
  ds_read_b64_tr_b16 v[26:27], v121 offset:8704
  v_fmac_f32 v48, v146, v146
  v_fmac_f32 v49, v147, v147
  v_mfma_f32_32x32x16_bf16 v[100:115], v[40:43], v[32:35], v[100:115]
  v_lshlrev_b32 v144, 16, v30
  v_and_b32 v145, s35, v30
  v_fmac_f32 v48, v144, v144
  v_fmac_f32 v49, v145, v145
  v_lshlrev_b32 v146, 16, v31
  v_and_b32 v147, s35, v31
  v_mfma_f32_16x16x32_bf16 v[116:119], v[44:47], v[28:31], v[116:119]
  v_fmac_f32 v48, v146, v146
  v_fmac_f32 v49, v147, v147
  v_mfma_f32_16x16x32_bf16 v[124:127], v[44:47], v[36:39], v[124:127]
  v_mfma_f32_16x16x32_bf16 v[128:131], v[44:47], v[40:43], v[128:131]
  s_waitcnt lgkmcnt(0)
  v_mfma_f32_32x32x16_bf16 v[52:67], v[20:23], v[12:15], v[52:67]
  ds_read_b128 v[28:31], v155 offset:0
  ds_read_b128 v[32:35], v159 offset:0
  v_lshlrev_b32 v144, 16, v12
  v_and_b32 v145, s35, v12
  v_fmac_f32 v48, v144, v144
  v_mfma_f32_32x32x16_bf16 v[68:83], v[20:23], v[16:19], v[68:83]
  ds_read_b64_tr_b16 v[36:37], v121 offset:2048
  ds_read_b64_tr_b16 v[38:39], v121 offset:2560
  v_fmac_f32 v49, v145, v145
  v_lshlrev_b32 v146, 16, v13
  v_and_b32 v147, s35, v13
  v_mfma_f32_32x32x16_bf16 v[84:99], v[24:27], v[12:15], v[84:99]
  ds_read_b64_tr_b16 v[40:41], v121 offset:10240
  ds_read_b64_tr_b16 v[42:43], v121 offset:10752
  v_fmac_f32 v48, v146, v146
  v_fmac_f32 v49, v147, v147
  v_mfma_f32_32x32x16_bf16 v[100:115], v[24:27], v[16:19], v[100:115]
  v_lshlrev_b32 v144, 16, v14
  v_and_b32 v145, s35, v14
  v_fmac_f32 v48, v144, v144
  v_fmac_f32 v49, v145, v145
  v_lshlrev_b32 v146, 16, v15
  v_and_b32 v147, s35, v15
  v_mfma_f32_16x16x32_bf16 v[116:119], v[44:47], v[12:15], v[116:119]
  v_fmac_f32 v48, v146, v146
  v_fmac_f32 v49, v147, v147
  s_waitcnt lgkmcnt(0)
  v_mfma_f32_32x32x16_bf16 v[52:67], v[36:39], v[28:31], v[52:67]
  s_barrier
  ds_read_b128 v[12:15], v152 offset:32768
  ds_read_b128 v[16:19], v156 offset:32768
  v_lshlrev_b32 v144, 16, v28
  v_and_b32 v145, s35, v28
  v_fmac_f32 v48, v144, v144
  v_mfma_f32_32x32x16_bf16 v[68:83], v[36:39], v[32:35], v[68:83]
  ds_read_b64_tr_b16 v[20:21], v120 offset:32768
  ds_read_b64_tr_b16 v[22:23], v120 offset:33280
  v_fmac_f32 v49, v145, v145
  v_lshlrev_b32 v146, 16, v29
  v_and_b32 v147, s35, v29
  v_mfma_f32_32x32x16_bf16 v[84:99], v[40:43], v[28:31], v[84:99]
  ds_read_b64_tr_b16 v[24:25], v120 offset:40960
  ds_read_b64_tr_b16 v[26:27], v120 offset:41472
  v_fmac_f32 v48, v146, v146
  v_fmac_f32 v49, v147, v147
  v_mfma_f32_32x32x16_bf16 v[100:115], v[40:43], v[32:35], v[100:115]
  v_lshlrev_b32 v144, 16, v30
  v_and_b32 v145, s35, v30
  v_fmac_f32 v48, v144, v144
  v_fmac_f32 v49, v145, v145
  v_lshlrev_b32 v146, 16, v31
  v_and_b32 v147, s35, v31
  v_mfma_f32_16x16x32_bf16 v[116:119], v[44:47], v[28:31], v[116:119]
  v_fmac_f32 v48, v146, v146
  v_fmac_f32 v49, v147, v147
  s_waitcnt lgkmcnt(0)
  v_mfma_f32_32x32x16_bf16 v[52:67], v[20:23], v[12:15], v[52:67]
  ds_read_b128 v[28:31], v153 offset:32768
  ds_read_b128 v[32:35], v157 offset:32768
  v_lshlrev_b32 v144, 16, v12
  v_and_b32 v145, s35, v12
  v_fmac_f32 v48, v144, v144
  v_mfma_f32_32x32x16_bf16 v[68:83], v[20:23], v[16:19], v[68:83]
  ds_read_b64_tr_b16 v[36:37], v120 offset:34816
  ds_read_b64_tr_b16 v[38:39], v120 offset:35328
  v_fmac_f32 v49, v145, v145
  v_lshlrev_b32 v146, 16, v13
  v_and_b32 v147, s35, v13
  v_mfma_f32_32x32x16_bf16 v[84:99], v[24:27], v[12:15], v[84:99]
  ds_read_b64_tr_b16 v[40:41], v120 offset:43008
  ds_read_b64_tr_b16 v[42:43], v120 offset:43520
  v_fmac_f32 v48, v146, v146
  v_fmac_f32 v49, v147, v147
  v_mfma_f32_32x32x16_bf16 v[100:115], v[24:27], v[16:19], v[100:115]
  v_lshlrev_b32 v144, 16, v14
  v_and_b32 v145, s35, v14
  v_fmac_f32 v48, v144, v144
  v_fmac_f32 v49, v145, v145
  v_lshlrev_b32 v146, 16, v15
  v_and_b32 v147, s35, v15
  v_mfma_f32_16x16x32_bf16 v[116:119], v[44:47], v[12:15], v[116:119]
  v_fmac_f32 v48, v146, v146
  v_fmac_f32 v49, v147, v147
  v_mfma_f32_16x16x32_bf16 v[124:127], v[44:47], v[20:23], v[124:127]
  v_mfma_f32_16x16x32_bf16 v[128:131], v[44:47], v[24:27], v[128:131]
  s_waitcnt lgkmcnt(0)
  v_mfma_f32_32x32x16_bf16 v[52:67], v[36:39], v[28:31], v[52:67]
  ds_read_b128 v[12:15], v154 offset:32768
  ds_read_b128 v[16:19], v158 offset:32768
  v_lshlrev_b32 v144, 16, v28
  v_and_b32 v145, s35, v28
  v_fmac_f32 v48, v144, v144
  v_mfma_f32_32x32x16_bf16 v[68:83], v[36:39], v[32:35], v[68:83]
  ds_read_b64_tr_b16 v[20:21], v121 offset:32768
  ds_read_b64_tr_b16 v[22:23], v121 offset:33280
  v_fmac_f32 v49, v145, v145
  v_lshlrev_b32 v146, 16, v29
  v_and_b32 v147, s35, v29
  v_mfma_f32_32x32x16_bf16 v[84:99], v[40:43], v[28:31], v[84:99]
  ds_read_b64_tr_b16 v[24:25], v121 offset:40960
  ds_read_b64_tr_b16 v[26:27], v121 offset:41472
  v_fmac_f32 v48, v146, v146
  v_fmac_f32 v49, v147, v147
  v_mfma_f32_32x32x16_bf16 v[100:115], v[40:43], v[32:35], v[100:115]
  v_lshlrev_b32 v144, 16, v30
  v_and_b32 v145, s35, v30
  v_fmac_f32 v48, v144, v144
  v_fmac_f32 v49, v145, v145
  v_lshlrev_b32 v146, 16, v31
  v_and_b32 v147, s35, v31
  v_mfma_f32_16x16x32_bf16 v[116:119], v[44:47], v[28:31], v[116:119]
  v_fmac_f32 v48, v146, v146
  v_fmac_f32 v49, v147, v147
  v_mfma_f32_16x16x32_bf16 v[124:127], v[44:47], v[36:39], v[124:127]
  v_mfma_f32_16x16x32_bf16 v[128:131], v[44:47], v[40:43], v[128:131]
  s_waitcnt lgkmcnt(0)
  v_mfma_f32_32x32x16_bf16 v[52:67], v[20:23], v[12:15], v[52:67]
  ds_read_b128 v[28:31], v155 offset:32768
  ds_read_b128 v[32:35], v159 offset:32768
  v_lshlrev_b32 v144, 16, v12
  v_and_b32 v145, s35, v12
  v_fmac_f32 v48, v144, v144
  v_mfma_f32_32x32x16_bf16 v[68:83], v[20:23], v[16:19], v[68:83]
  ds_read_b64_tr_b16 v[36:37], v121 offset:34816
  ds_read_b64_tr_b16 v[38:39], v121 offset:35328
  v_fmac_f32 v49, v145, v145
  v_lshlrev_b32 v146, 16, v13
  v_and_b32 v147, s35, v13
  v_mfma_f32_32x32x16_bf16 v[84:99], v[24:27], v[12:15], v[84:99]
  ds_read_b64_tr_b16 v[40:41], v121 offset:43008
  ds_read_b64_tr_b16 v[42:43], v121 offset:43520
  v_fmac_f32 v48, v146, v146
  v_fmac_f32 v49, v147, v147
  v_mfma_f32_32x32x16_bf16 v[100:115], v[24:27], v[16:19], v[100:115]
  v_lshlrev_b32 v144, 16, v14
  v_and_b32 v145, s35, v14
  v_fmac_f32 v48, v144, v144
  v_fmac_f32 v49, v145, v145
  v_lshlrev_b32 v146, 16, v15
  v_and_b32 v147, s35, v15
  v_mfma_f32_16x16x32_bf16 v[116:119], v[44:47], v[12:15], v[116:119]
  v_fmac_f32 v48, v146, v146
  v_fmac_f32 v49, v147, v147
  s_waitcnt lgkmcnt(0)
  v_mfma_f32_32x32x16_bf16 v[52:67], v[36:39], v[28:31], v[52:67]
  v_lshlrev_b32 v144, 16, v28
  v_and_b32 v145, s35, v28
  v_fmac_f32 v48, v144, v144
  v_mfma_f32_32x32x16_bf16 v[68:83], v[36:39], v[32:35], v[68:83]
  v_fmac_f32 v49, v145, v145
  v_lshlrev_b32 v146, 16, v29
  v_and_b32 v147, s35, v29
  v_mfma_f32_32x32x16_bf16 v[84:99], v[40:43], v[28:31], v[84:99]
  v_fmac_f32 v48, v146, v146
  v_fmac_f32 v49, v147, v147
  v_mfma_f32_32x32x16_bf16 v[100:115], v[40:43], v[32:35], v[100:115]
  v_lshlrev_b32 v144, 16, v30
  v_and_b32 v145, s35, v30
  v_fmac_f32 v48, v144, v144
  v_fmac_f32 v49, v145, v145
  v_lshlrev_b32 v146, 16, v31
  v_and_b32 v147, s35, v31
  v_mfma_f32_16x16x32_bf16 v[116:119], v[44:47], v[28:31], v[116:119]
  v_fmac_f32 v48, v146, v146
  v_fmac_f32 v49, v147, v147
  v_add_f32 v22, v48, v49
  s_mov_b32 vcc_lo, 0xffff
  s_mov_b32 vcc_hi, 0xffff
  v_mov_b32 v24, v22
  s_nop 1
  v_permlane32_swap_b32 v22, v24
  v_add_f32 v22, v22, v24
  v_mul_f32 v22, 0x3b000000, v22
  v_cndmask_b32 v20, v117, v116, vcc
  v_cndmask_b32 v132, v125, v124, vcc
  v_cndmask_b32 v133, v129, v128, vcc
  ds_write_b64 v10, v[132:133]
  v_mul_f32 v20, 0x3b000000, v20
  s_mov_b32 vcc_lo, -1
  s_mov_b32 vcc_hi, 0
  v_fma_f32 v22, -v20, v20, v22
  v_max_f32 v22, 0, v22
  v_add_f32 v21, 0x3727c5ac, v22
  v_rsq_f32 v21, v21
  v_cndmask_b32 v24, 0, v20, vcc
  v_cvt_pk_bf16_f32 v137, v24, v24
  v_and_b32 v25, s35, v137
  v_sub_f32 v25, v24, v25
  v_cvt_pk_bf16_f32 v136, v24, v25
  v_and_b32 v137, 0xffff, v137
  v_mul_f32 v138, 1.0, v21
  ds_write_b128 v148, v[136:139]
  ds_write_b128 v148, v[20:23] offset:4096
  s_waitcnt lgkmcnt(0)
  s_barrier
  ds_read_b64 v[134:135], v11
  ds_read_b128 v[140:143], v149
  ds_read_b64 v[36:37], v150
  s_waitcnt lgkmcnt(2)
  v_add_f32 v132, -v132, -v134
  v_cvt_pk_bf16_f32 v16, v132, v132
  v_and_b32 v17, 0xffff0000, v16
  v_sub_f32 v17, v132, v17
  v_cvt_pk_bf16_f32 v17, v17, 0
  v_add_f32 v133, -v133, -v135
  v_cvt_pk_bf16_f32 v18, v133, v133
  v_and_b32 v19, 0xffff0000, v18
  v_sub_f32 v19, v133, v19
  v_cvt_pk_bf16_f32 v19, v19, 0
  s_waitcnt lgkmcnt(0)
  v_mfma_f32_32x32x8_bf16 v[52:67], v[16:17], v[136:137], v[52:67]
  v_mfma_f32_32x32x8_bf16 v[68:83], v[16:17], v[140:141], v[68:83]
  v_mfma_f32_32x32x8_bf16 v[84:99], v[18:19], v[136:137], v[84:99]
  v_mfma_f32_32x32x8_bf16 v[100:115], v[18:19], v[140:141], v[100:115]
  v_readfirstlane_b32 s60, v36
  v_readfirstlane_b32 s61, v37
  s_nop 6
  v_pk_mul_f32 v[52:53], v[52:53], v[138:139] op_sel_hi:[1,0]
  v_pk_mul_f32 v[54:55], v[54:55], v[138:139] op_sel_hi:[1,0]
  v_pk_mul_f32 v[56:57], v[56:57], v[138:139] op_sel_hi:[1,0]
  v_pk_mul_f32 v[58:59], v[58:59], v[138:139] op_sel_hi:[1,0]
  v_pk_mul_f32 v[60:61], v[60:61], v[138:139] op_sel_hi:[1,0]
  v_pk_mul_f32 v[62:63], v[62:63], v[138:139] op_sel_hi:[1,0]
  v_pk_mul_f32 v[64:65], v[64:65], v[138:139] op_sel_hi:[1,0]
  v_pk_mul_f32 v[66:67], v[66:67], v[138:139] op_sel_hi:[1,0]
  v_cvt_pk_bf16_f32 v20, v52, v53
  v_cvt_pk_bf16_f32 v21, v54, v55
  v_cvt_pk_bf16_f32 v22, v56, v57
  v_cvt_pk_bf16_f32 v23, v58, v59
  v_cvt_pk_bf16_f32 v24, v60, v61
  v_cvt_pk_bf16_f32 v25, v62, v63
  v_cvt_pk_bf16_f32 v26, v64, v65
  v_cvt_pk_bf16_f32 v27, v66, v67
  buffer_store_dwordx4 v[20:23], v4, s[20:23], s32 offen sc1
  buffer_store_dwordx4 v[24:27], v4, s[20:23], s33 offen sc1
  v_pk_mul_f32 v[68:69], v[68:69], v[142:143] op_sel_hi:[1,0]
  v_pk_mul_f32 v[70:71], v[70:71], v[142:143] op_sel_hi:[1,0]
  v_pk_mul_f32 v[72:73], v[72:73], v[142:143] op_sel_hi:[1,0]
  v_pk_mul_f32 v[74:75], v[74:75], v[142:143] op_sel_hi:[1,0]
  v_pk_mul_f32 v[76:77], v[76:77], v[142:143] op_sel_hi:[1,0]
  v_pk_mul_f32 v[78:79], v[78:79], v[142:143] op_sel_hi:[1,0]
  v_pk_mul_f32 v[80:81], v[80:81], v[142:143] op_sel_hi:[1,0]
  v_pk_mul_f32 v[82:83], v[82:83], v[142:143] op_sel_hi:[1,0]
  v_cvt_pk_bf16_f32 v28, v68, v69
  v_cvt_pk_bf16_f32 v29, v70, v71
  v_cvt_pk_bf16_f32 v30, v72, v73
  v_cvt_pk_bf16_f32 v31, v74, v75
  v_cvt_pk_bf16_f32 v32, v76, v77
  v_cvt_pk_bf16_f32 v33, v78, v79
  v_cvt_pk_bf16_f32 v34, v80, v81
  v_cvt_pk_bf16_f32 v35, v82, v83
  buffer_store_dwordx4 v[28:31], v5, s[20:23], s32 offen sc1
  buffer_store_dwordx4 v[32:35], v5, s[20:23], s33 offen sc1
  ds_write_b128 v2, v[84:87] offset:0
  ds_write_b128 v2, v[88:91] offset:1024
  ds_write_b128 v2, v[92:95] offset:2048
  ds_write_b128 v2, v[96:99] offset:3072
  ds_write_b128 v7, v[100:103] offset:0
  ds_write_b128 v7, v[104:107] offset:1024
  ds_write_b128 v7, v[108:111] offset:2048
  ds_write_b128 v7, v[112:115] offset:3072
  v_mov_b32 v6, 2
  s_waitcnt lgkmcnt(0)
  s_mov_b64 exec, 3
  ds_add_u32 v3, v6
  s_mov_b64 exec, -1
  s_and_b32 s13, s2, 7
  s_lshl_b32 s13, s13, 2
  s_bfe_u32 s14, s2, 0x20003
  s_add_u32 s13, s13, s14
  s_lshr_b32 s14, s2, 5
  s_lshl_b32 s34, s13, 16
  s_mov_b32 s20, s10
  s_mov_b32 s21, s11
  s_mov_b32 s22, 0x200000
  s_mov_b32 s23, 0x20000
  s_add_u32 s24, s10, 0x200000
  s_addc_u32 s25, s11, 0
  s_mov_b32 s26, 0x200000
  s_mov_b32 s27, 0x20000
  s_add_u32 s28, s10, 0x400000
  s_addc_u32 s29, s11, 0
  s_mov_b32 s30, 0x200000
  s_mov_b32 s31, 0x20000
  s_add_u32 s44, s10, 0xa00000
  s_addc_u32 s45, s11, 0
  s_mov_b32 s46, 0x200000
  s_mov_b32 s47, 0x20000
  s_lshl2_add_u32 s16, s14, s12
  s_lshl_b32 s48, s16, 10
  s_add_u32 s48, s48, s34
  s_add_u32 s49, s48, 512
  v_and_b32 v4, 31, v1
  v_lshrrev_b32 v5, 5, v1
  v_lshlrev_b32 v2, 15, v5
  v_lshl_add_u32 v2, v4, 4, v2
  v_and_b32 v3, 15, v1
  v_lshlrev_b32 v3, 4, v3
  v_lshl_add_u32 v3, v5, 8, v3
  v_lshlrev_b32 v140, 4, v1
  v_add_u32 v140, 131072, v140
  v_and_b32 v6, 27, v1
  v_cmp_eq_u32 vcc, 16, v6
  v_mov_b32 v6, 133136
  v_mov_b32 v7, 133120
  v_cndmask_b32 v6, v6, v7, vcc
  v_cmp_gt_u32 vcc, 16, v4
  v_add_u32 v141, 132096, v3
  s_nop 0
  v_cndmask_b32 v141, v6, v141, vcc
  v_add_u32 v142, 132608, v3
  v_cndmask_b32 v142, v6, v142, vcc
  v_mov_b32 v108, 0
  v_mov_b32 v109, 0
  v_mov_b32 v110, 0
  v_mov_b32 v111, 0
  v_mov_b32 v112, 0
  v_mov_b32 v113, 0
  v_mov_b32 v114, 0
  v_mov_b32 v115, 0
  v_mov_b32 v116, 0
  v_mov_b32 v117, 0
  v_mov_b32 v118, 0
  v_mov_b32 v119, 0
  v_mov_b32 v120, 0
  v_mov_b32 v121, 0
  v_mov_b32 v122, 0
  v_mov_b32 v123, 0
  v_mov_b32 v124, 0
  v_mov_b32 v125, 0
  v_mov_b32 v126, 0
  v_mov_b32 v127, 0
  v_mov_b32 v128, 0
  v_mov_b32 v129, 0
  v_mov_b32 v130, 0
  v_mov_b32 v131, 0
  v_mov_b32 v132, 0
  v_mov_b32 v133, 0
  v_mov_b32 v134, 0
  v_mov_b32 v135, 0
  v_mov_b32 v136, 0
  v_mov_b32 v137, 0
  v_mov_b32 v138, 0
  v_mov_b32 v139, 0
  v_mov_b32 v56, 0
  v_mov_b32 v104, 0
  v_mov_b32 v57, 0
  v_mov_b32 v105, 0
  v_mov_b32 v58, 0
  v_mov_b32 v106, 0
  v_mov_b32 v59, 0
  v_mov_b32 v107, 0
  v_mov_b32 v143, 156096
  v_mov_b32 v145, 1
  s_lshl_b32 s17, s12, 2
  s_add_u32 s17, s17, 156104
  v_mov_b32 v144, s17
  v_mov_b32 v9, 156060
  v_mov_b32 v10, 1
  s_waitcnt vmcnt(0)
  s_mov_b64 exec, 1
  ds_add_u32 v9, v10
  s_mov_b64 exec, -1
f_attn:
  v_mov_b32 v8, 156064
at_go:
  ds_read_b32 v9, v8
  s_waitcnt lgkmcnt(0)
  v_readfirstlane_b32 s17, v9
  s_nop 0
  s_cmp_ge_u32 s17, 4
  s_cbranch_scc1 at_go_ok
  s_sleep 1
  s_sub_u32 s62, s62, 1
  s_cbranch_scc0 at_go
  s_mov_b32 s62, 0
at_go_ok:
  buffer_load_dwordx4 v[12:15], v2, s[20:23], s48 offen sc1
  buffer_load_dwordx4 v[16:19], v2, s[20:23], s49 offen sc1
at_first:
  ds_read_b32 v9, v143
  s_waitcnt lgkmcnt(0)
  v_readfirstlane_b32 s17, v9
  s_nop 0
  s_cmp_ge_u32 s17, 1
  s_cbranch_scc1 at_first_ok
  s_sleep 0
  s_sub_u32 s62, s62, 1
  s_cbranch_scc0 at_first
  s_mov_b32 s62, 0
at_first_ok:
  ds_read_b128 v[60:63], v140 offset:0
  ds_read_b128 v[64:67], v141 offset:0
  ds_read_b128 v[68:71], v142 offset:0
  ds_read_b128 v[72:75], v140 offset:2080
  ds_read_b128 v[76:79], v141 offset:2080
  ds_read_b128 v[80:83], v142 offset:2080
  ds_read_b128 v[84:87], v140 offset:4160
  ds_read_b128 v[88:91], v141 offset:4160
  ds_read_b128 v[92:95], v142 offset:4160
  s_mov_b32 s35, 4
  s_waitcnt vmcnt(0) lgkmcnt(6)
  v_mfma_f32_32x32x16_bf16 v[20:35], v[60:63], v[12:15], 0
  s_nop 11
.p2align 3
at_loop:
  v_mfma_f32_32x32x16_bf16 v[36:51], v[60:63], v[16:19], 0
  ds_read_b128 v[96:99], v140 offset:6240
  v_exp_f32 v20, v20
  v_exp_f32 v21, v21
  v_exp_f32 v22, v22
  v_exp_f32 v23, v23
  v_mfma_f32_32x32x16_bf16 v[124:139], v[104:107], v[56:59], v[124:139]
  ds_read_b128 v[104:107], v142 offset:6240
  v_exp_f32 v24, v24
  v_exp_f32 v25, v25
  v_exp_f32 v26, v26
  v_exp_f32 v27, v27
  v_cvt_pk_bf16_f32 v52, v20, v21
  v_cvt_pk_bf16_f32 v53, v22, v23
  v_cvt_pk_bf16_f32 v54, v24, v25
  v_cvt_pk_bf16_f32 v55, v26, v27
  v_exp_f32 v28, v28
  v_exp_f32 v29, v29
  v_mfma_f32_32x32x16_bf16 v[108:123], v[64:67], v[52:55], v[108:123]
  ds_read_b128 v[100:103], v141 offset:6240
  v_exp_f32 v30, v30
  v_exp_f32 v31, v31
  v_exp_f32 v32, v32
  v_exp_f32 v33, v33
  v_exp_f32 v34, v34
  v_exp_f32 v35, v35
  v_cvt_pk_bf16_f32 v56, v28, v29
  v_cvt_pk_bf16_f32 v57, v30, v31
  v_cvt_pk_bf16_f32 v58, v32, v33
  v_cvt_pk_bf16_f32 v59, v34, v35
  s_waitcnt lgkmcnt(3)
  v_add_u32 v145, 1, v145
  v_mfma_f32_32x32x16_bf16 v[20:35], v[72:75], v[12:15], 0
  ds_read_b32 v146, v143
  v_exp_f32 v36, v36
  v_exp_f32 v37, v37
  v_exp_f32 v38, v38
  v_exp_f32 v39, v39
  v_mfma_f32_32x32x16_bf16 v[108:123], v[68:71], v[56:59], v[108:123]
  v_exp_f32 v40, v40
  v_exp_f32 v41, v41
  v_exp_f32 v42, v42
  v_exp_f32 v43, v43
  v_cvt_pk_bf16_f32 v52, v36, v37
  v_cvt_pk_bf16_f32 v53, v38, v39
  v_cvt_pk_bf16_f32 v54, v40, v41
  v_cvt_pk_bf16_f32 v55, v42, v43
  v_exp_f32 v44, v44
  v_exp_f32 v45, v45
  v_mfma_f32_32x32x16_bf16 v[124:139], v[64:67], v[52:55], v[124:139]
  s_waitcnt lgkmcnt(0)
  s_nop 0
  v_exp_f32 v46, v46
  v_exp_f32 v47, v47
  v_exp_f32 v48, v48
  v_exp_f32 v49, v49
  v_exp_f32 v50, v50
  v_exp_f32 v51, v51
  v_cvt_pk_bf16_f32 v56, v44, v45
  v_cvt_pk_bf16_f32 v57, v46, v47
  v_cvt_pk_bf16_f32 v58, v48, v49
  v_cvt_pk_bf16_f32 v59, v50, v51
  v_cmp_le_u32 vcc, v145, v146
  s_cbranch_vccz at_wait0
at_resume0:
  v_mfma_f32_32x32x16_bf16 v[36:51], v[72:75], v[16:19], 0
  ds_read_b128 v[60:63], v140 offset:8320
  v_exp_f32 v20, v20
  v_exp_f32 v21, v21
  v_exp_f32 v22, v22
  v_exp_f32 v23, v23
  v_mfma_f32_32x32x16_bf16 v[124:139], v[68:71], v[56:59], v[124:139]
  ds_read_b128 v[68:71], v142 offset:8320
  v_exp_f32 v24, v24
  v_exp_f32 v25, v25
  v_exp_f32 v26, v26
  v_exp_f32 v27, v27
  v_cvt_pk_bf16_f32 v52, v20, v21
  v_cvt_pk_bf16_f32 v53, v22, v23
  v_cvt_pk_bf16_f32 v54, v24, v25
  v_cvt_pk_bf16_f32 v55, v26, v27
  v_exp_f32 v28, v28
  v_exp_f32 v29, v29
  v_mfma_f32_32x32x16_bf16 v[108:123], v[76:79], v[52:55], v[108:123]
  ds_read_b128 v[64:67], v141 offset:8320
  v_exp_f32 v30, v30
  v_exp_f32 v31, v31
  v_exp_f32 v32, v32
  v_exp_f32 v33, v33
  v_exp_f32 v34, v34
  v_exp_f32 v35, v35
  v_cvt_pk_bf16_f32 v56, v28, v29
  v_cvt_pk_bf16_f32 v57, v30, v31
  v_cvt_pk_bf16_f32 v58, v32, v33
  v_cvt_pk_bf16_f32 v59, v34, v35
  v_mfma_f32_32x32x16_bf16 v[20:35], v[84:87], v[12:15], 0
  v_exp_f32 v36, v36
  v_exp_f32 v37, v37
  v_exp_f32 v38, v38
  v_exp_f32 v39, v39
  v_mfma_f32_32x32x16_bf16 v[108:123], v[80:83], v[56:59], v[108:123]
  v_exp_f32 v40, v40
  v_exp_f32 v41, v41
  v_exp_f32 v42, v42
  v_exp_f32 v43, v43
  v_cvt_pk_bf16_f32 v52, v36, v37
  v_cvt_pk_bf16_f32 v53, v38, v39
  v_cvt_pk_bf16_f32 v54, v40, v41
  v_cvt_pk_bf16_f32 v55, v42, v43
  v_exp_f32 v44, v44
  v_exp_f32 v45, v45
  v_mfma_f32_32x32x16_bf16 v[124:139], v[76:79], v[52:55], v[124:139]
  v_exp_f32 v46, v46
  v_exp_f32 v47, v47
  v_exp_f32 v48, v48
  v_exp_f32 v49, v49
  v_exp_f32 v50, v50
  v_exp_f32 v51, v51
  v_cvt_pk_bf16_f32 v56, v44, v45
  v_cvt_pk_bf16_f32 v57, v46, v47
  v_cvt_pk_bf16_f32 v58, v48, v49
  v_cvt_pk_bf16_f32 v59, v50, v51
  v_mfma_f32_32x32x16_bf16 v[36:51], v[84:87], v[16:19], 0
  ds_read_b128 v[72:75], v140 offset:10400
  v_exp_f32 v20, v20
  v_exp_f32 v21, v21
  v_exp_f32 v22, v22
  v_exp_f32 v23, v23
  v_mfma_f32_32x32x16_bf16 v[124:139], v[80:83], v[56:59], v[124:139]
  ds_read_b128 v[80:83], v142 offset:10400
  v_exp_f32 v24, v24
  v_exp_f32 v25, v25
  v_exp_f32 v26, v26
  v_exp_f32 v27, v27
  v_cvt_pk_bf16_f32 v52, v20, v21
  v_cvt_pk_bf16_f32 v53, v22, v23
  v_cvt_pk_bf16_f32 v54, v24, v25
  v_cvt_pk_bf16_f32 v55, v26, v27
  v_exp_f32 v28, v28
  v_exp_f32 v29, v29
  v_mfma_f32_32x32x16_bf16 v[108:123], v[88:91], v[52:55], v[108:123]
  ds_read_b128 v[76:79], v141 offset:10400
  v_exp_f32 v30, v30
  v_exp_f32 v31, v31
  v_exp_f32 v32, v32
  v_exp_f32 v33, v33
  v_exp_f32 v34, v34
  v_exp_f32 v35, v35
  v_cvt_pk_bf16_f32 v56, v28, v29
  v_cvt_pk_bf16_f32 v57, v30, v31
  v_cvt_pk_bf16_f32 v58, v32, v33
  v_cvt_pk_bf16_f32 v59, v34, v35
  s_waitcnt lgkmcnt(3)
  s_nop 0
  v_mfma_f32_32x32x16_bf16 v[20:35], v[96:99], v[12:15], 0
  ds_write_b32 v144, v145
  v_exp_f32 v36, v36
  v_exp_f32 v37, v37
  v_exp_f32 v38, v38
  v_exp_f32 v39, v39
  v_mfma_f32_32x32x16_bf16 v[108:123], v[92:95], v[56:59], v[108:123]
  v_exp_f32 v40, v40
  v_exp_f32 v41, v41
  v_exp_f32 v42, v42
  v_exp_f32 v43, v43
  v_cvt_pk_bf16_f32 v52, v36, v37
  v_cvt_pk_bf16_f32 v53, v38, v39
  v_cvt_pk_bf16_f32 v54, v40, v41
  v_cvt_pk_bf16_f32 v55, v42, v43
  v_exp_f32 v44, v44
  v_exp_f32 v45, v45
  v_mfma_f32_32x32x16_bf16 v[124:139], v[88:91], v[52:55], v[124:139]
  v_exp_f32 v46, v46
  v_exp_f32 v47, v47
  v_exp_f32 v48, v48
  v_exp_f32 v49, v49
  v_exp_f32 v50, v50
  v_exp_f32 v51, v51
  v_cvt_pk_bf16_f32 v56, v44, v45
  v_cvt_pk_bf16_f32 v57, v46, v47
  v_cvt_pk_bf16_f32 v58, v48, v49
  v_cvt_pk_bf16_f32 v59, v50, v51
  v_mfma_f32_32x32x16_bf16 v[36:51], v[96:99], v[16:19], 0
  ds_read_b128 v[84:87], v140 offset:12480
  v_exp_f32 v20, v20
  v_exp_f32 v21, v21
  v_exp_f32 v22, v22
  v_exp_f32 v23, v23
  v_mfma_f32_32x32x16_bf16 v[124:139], v[92:95], v[56:59], v[124:139]
  ds_read_b128 v[92:95], v142 offset:12480
  v_exp_f32 v24, v24
  v_exp_f32 v25, v25
  v_exp_f32 v26, v26
  v_exp_f32 v27, v27
  v_cvt_pk_bf16_f32 v52, v20, v21
  v_cvt_pk_bf16_f32 v53, v22, v23
  v_cvt_pk_bf16_f32 v54, v24, v25
  v_cvt_pk_bf16_f32 v55, v26, v27
  v_exp_f32 v28, v28
  v_exp_f32 v29, v29
  v_mfma_f32_32x32x16_bf16 v[108:123], v[100:103], v[52:55], v[108:123]
  ds_read_b128 v[88:91], v141 offset:12480
  v_exp_f32 v30, v30
  v_exp_f32 v31, v31
  v_exp_f32 v32, v32
  v_exp_f32 v33, v33
  v_exp_f32 v34, v34
  v_exp_f32 v35, v35
  v_cvt_pk_bf16_f32 v56, v28, v29
  v_cvt_pk_bf16_f32 v57, v30, v31
  v_cvt_pk_bf16_f32 v58, v32, v33
  v_cvt_pk_bf16_f32 v59, v34, v35
  v_mfma_f32_32x32x16_bf16 v[20:35], v[60:63], v[12:15], 0
  v_exp_f32 v36, v36
  v_exp_f32 v37, v37
  v_exp_f32 v38, v38
  v_exp_f32 v39, v39
  v_mfma_f32_32x32x16_bf16 v[108:123], v[104:107], v[56:59], v[108:123]
  v_exp_f32 v40, v40
  v_exp_f32 v41, v41
  v_exp_f32 v42, v42
  v_exp_f32 v43, v43
  v_cvt_pk_bf16_f32 v52, v36, v37
  v_cvt_pk_bf16_f32 v53, v38, v39
  v_cvt_pk_bf16_f32 v54, v40, v41
  v_cvt_pk_bf16_f32 v55, v42, v43
  v_exp_f32 v44, v44
  v_exp_f32 v45, v45
  v_mfma_f32_32x32x16_bf16 v[124:139], v[100:103], v[52:55], v[124:139]
  v_exp_f32 v46, v46
  v_exp_f32 v47, v47
  v_exp_f32 v48, v48
  v_exp_f32 v49, v49
  v_exp_f32 v50, v50
  v_exp_f32 v51, v51
  v_cvt_pk_bf16_f32 v56, v44, v45
  v_cvt_pk_bf16_f32 v57, v46, v47
  v_cvt_pk_bf16_f32 v58, v48, v49
  v_cvt_pk_bf16_f32 v59, v50, v51
  v_mfma_f32_32x32x16_bf16 v[36:51], v[60:63], v[16:19], 0
  ds_read_b128 v[96:99], v140 offset:14560
  v_exp_f32 v20, v20
  v_exp_f32 v21, v21
  v_exp_f32 v22, v22
  v_exp_f32 v23, v23
  v_mfma_f32_32x32x16_bf16 v[124:139], v[104:107], v[56:59], v[124:139]
  ds_read_b128 v[104:107], v142 offset:14560
  v_exp_f32 v24, v24
  v_exp_f32 v25, v25
  v_exp_f32 v26, v26
  v_exp_f32 v27, v27
  v_cvt_pk_bf16_f32 v52, v20, v21
  v_cvt_pk_bf16_f32 v53, v22, v23
  v_cvt_pk_bf16_f32 v54, v24, v25
  v_cvt_pk_bf16_f32 v55, v26, v27
  v_exp_f32 v28, v28
  v_exp_f32 v29, v29
  v_mfma_f32_32x32x16_bf16 v[108:123], v[64:67], v[52:55], v[108:123]
  ds_read_b128 v[100:103], v141 offset:14560
  v_exp_f32 v30, v30
  v_exp_f32 v31, v31
  v_exp_f32 v32, v32
  v_exp_f32 v33, v33
  v_exp_f32 v34, v34
  v_exp_f32 v35, v35
  v_cvt_pk_bf16_f32 v56, v28, v29
  v_cvt_pk_bf16_f32 v57, v30, v31
  v_cvt_pk_bf16_f32 v58, v32, v33
  v_cvt_pk_bf16_f32 v59, v34, v35
  s_waitcnt lgkmcnt(3)
  v_add_u32 v145, 1, v145
  v_mfma_f32_32x32x16_bf16 v[20:35], v[72:75], v[12:15], 0
  ds_read_b32 v146, v143
  v_exp_f32 v36, v36
  v_exp_f32 v37, v37
  v_exp_f32 v38, v38
  v_exp_f32 v39, v39
  v_mfma_f32_32x32x16_bf16 v[108:123], v[68:71], v[56:59], v[108:123]
  v_exp_f32 v40, v40
  v_exp_f32 v41, v41
  v_exp_f32 v42, v42
  v_exp_f32 v43, v43
  v_cvt_pk_bf16_f32 v52, v36, v37
  v_cvt_pk_bf16_f32 v53, v38, v39
  v_cvt_pk_bf16_f32 v54, v40, v41
  v_cvt_pk_bf16_f32 v55, v42, v43
  v_exp_f32 v44, v44
  v_exp_f32 v45, v45
  v_mfma_f32_32x32x16_bf16 v[124:139], v[64:67], v[52:55], v[124:139]
  s_waitcnt lgkmcnt(0)
  s_nop 0
  v_exp_f32 v46, v46
  v_exp_f32 v47, v47
  v_exp_f32 v48, v48
  v_exp_f32 v49, v49
  v_exp_f32 v50, v50
  v_exp_f32 v51, v51
  v_cvt_pk_bf16_f32 v56, v44, v45
  v_cvt_pk_bf16_f32 v57, v46, v47
  v_cvt_pk_bf16_f32 v58, v48, v49
  v_cvt_pk_bf16_f32 v59, v50, v51
  v_cmp_le_u32 vcc, v145, v146
  s_cbranch_vccz at_wait1
at_resume1:
  v_mfma_f32_32x32x16_bf16 v[36:51], v[72:75], v[16:19], 0
  ds_read_b128 v[60:63], v140 offset:16640
  v_exp_f32 v20, v20
  v_exp_f32 v21, v21
  v_exp_f32 v22, v22
  v_exp_f32 v23, v23
  v_mfma_f32_32x32x16_bf16 v[124:139], v[68:71], v[56:59], v[124:139]
  ds_read_b128 v[68:71], v142 offset:16640
  v_exp_f32 v24, v24
  v_exp_f32 v25, v25
  v_exp_f32 v26, v26
  v_exp_f32 v27, v27
  v_cvt_pk_bf16_f32 v52, v20, v21
  v_cvt_pk_bf16_f32 v53, v22, v23
  v_cvt_pk_bf16_f32 v54, v24, v25
  v_cvt_pk_bf16_f32 v55, v26, v27
  v_exp_f32 v28, v28
  v_exp_f32 v29, v29
  v_mfma_f32_32x32x16_bf16 v[108:123], v[76:79], v[52:55], v[108:123]
  ds_read_b128 v[64:67], v141 offset:16640
  v_exp_f32 v30, v30
  v_exp_f32 v31, v31
  v_exp_f32 v32, v32
  v_exp_f32 v33, v33
  v_exp_f32 v34, v34
  v_exp_f32 v35, v35
  v_cvt_pk_bf16_f32 v56, v28, v29
  v_cvt_pk_bf16_f32 v57, v30, v31
  v_cvt_pk_bf16_f32 v58, v32, v33
  v_cvt_pk_bf16_f32 v59, v34, v35
  v_mfma_f32_32x32x16_bf16 v[20:35], v[84:87], v[12:15], 0
  v_exp_f32 v36, v36
  v_exp_f32 v37, v37
  v_exp_f32 v38, v38
  v_exp_f32 v39, v39
  v_mfma_f32_32x32x16_bf16 v[108:123], v[80:83], v[56:59], v[108:123]
  v_exp_f32 v40, v40
  v_exp_f32 v41, v41
  v_exp_f32 v42, v42
  v_exp_f32 v43, v43
  v_cvt_pk_bf16_f32 v52, v36, v37
  v_cvt_pk_bf16_f32 v53, v38, v39
  v_cvt_pk_bf16_f32 v54, v40, v41
  v_cvt_pk_bf16_f32 v55, v42, v43
  v_exp_f32 v44, v44
  v_exp_f32 v45, v45
  v_mfma_f32_32x32x16_bf16 v[124:139], v[76:79], v[52:55], v[124:139]
  v_exp_f32 v46, v46
  v_exp_f32 v47, v47
  v_exp_f32 v48, v48
  v_exp_f32 v49, v49
  v_exp_f32 v50, v50
  v_exp_f32 v51, v51
  v_cvt_pk_bf16_f32 v56, v44, v45
  v_cvt_pk_bf16_f32 v57, v46, v47
  v_cvt_pk_bf16_f32 v58, v48, v49
  v_cvt_pk_bf16_f32 v59, v50, v51
  v_mfma_f32_32x32x16_bf16 v[36:51], v[84:87], v[16:19], 0
  ds_read_b128 v[72:75], v140 offset:18720
  v_exp_f32 v20, v20
  v_exp_f32 v21, v21
  v_exp_f32 v22, v22
  v_exp_f32 v23, v23
  v_mfma_f32_32x32x16_bf16 v[124:139], v[80:83], v[56:59], v[124:139]
  ds_read_b128 v[80:83], v142 offset:18720
  v_exp_f32 v24, v24
  v_exp_f32 v25, v25
  v_exp_f32 v26, v26
  v_exp_f32 v27, v27
  v_cvt_pk_bf16_f32 v52, v20, v21
  v_cvt_pk_bf16_f32 v53, v22, v23
  v_cvt_pk_bf16_f32 v54, v24, v25
  v_cvt_pk_bf16_f32 v55, v26, v27
  v_exp_f32 v28, v28
  v_exp_f32 v29, v29
  v_mfma_f32_32x32x16_bf16 v[108:123], v[88:91], v[52:55], v[108:123]
  ds_read_b128 v[76:79], v141 offset:18720
  v_exp_f32 v30, v30
  v_exp_f32 v31, v31
  v_exp_f32 v32, v32
  v_exp_f32 v33, v33
  v_exp_f32 v34, v34
  v_exp_f32 v35, v35
  v_cvt_pk_bf16_f32 v56, v28, v29
  v_cvt_pk_bf16_f32 v57, v30, v31
  v_cvt_pk_bf16_f32 v58, v32, v33
  v_cvt_pk_bf16_f32 v59, v34, v35
  s_waitcnt lgkmcnt(3)
  s_nop 0
  v_mfma_f32_32x32x16_bf16 v[20:35], v[96:99], v[12:15], 0
  ds_write_b32 v144, v145
  v_exp_f32 v36, v36
  v_exp_f32 v37, v37
  v_exp_f32 v38, v38
  v_exp_f32 v39, v39
  v_mfma_f32_32x32x16_bf16 v[108:123], v[92:95], v[56:59], v[108:123]
  v_exp_f32 v40, v40
  v_exp_f32 v41, v41
  v_exp_f32 v42, v42
  v_exp_f32 v43, v43
  v_cvt_pk_bf16_f32 v52, v36, v37
  v_cvt_pk_bf16_f32 v53, v38, v39
  v_cvt_pk_bf16_f32 v54, v40, v41
  v_cvt_pk_bf16_f32 v55, v42, v43
  v_exp_f32 v44, v44
  v_exp_f32 v45, v45
  v_mfma_f32_32x32x16_bf16 v[124:139], v[88:91], v[52:55], v[124:139]
  v_exp_f32 v46, v46
  v_exp_f32 v47, v47
  v_exp_f32 v48, v48
  v_exp_f32 v49, v49
  v_exp_f32 v50, v50
  v_exp_f32 v51, v51
  v_cvt_pk_bf16_f32 v56, v44, v45
  v_cvt_pk_bf16_f32 v57, v46, v47
  v_cvt_pk_bf16_f32 v58, v48, v49
  v_cvt_pk_bf16_f32 v59, v50, v51
  v_mfma_f32_32x32x16_bf16 v[36:51], v[96:99], v[16:19], 0
  ds_read_b128 v[84:87], v140 offset:20800
  v_exp_f32 v20, v20
  v_exp_f32 v21, v21
  v_exp_f32 v22, v22
  v_exp_f32 v23, v23
  v_mfma_f32_32x32x16_bf16 v[124:139], v[92:95], v[56:59], v[124:139]
  ds_read_b128 v[92:95], v142 offset:20800
  v_exp_f32 v24, v24
  v_exp_f32 v25, v25
  v_exp_f32 v26, v26
  v_exp_f32 v27, v27
  v_cvt_pk_bf16_f32 v52, v20, v21
  v_cvt_pk_bf16_f32 v53, v22, v23
  v_cvt_pk_bf16_f32 v54, v24, v25
  v_cvt_pk_bf16_f32 v55, v26, v27
  v_exp_f32 v28, v28
  v_exp_f32 v29, v29
  v_mfma_f32_32x32x16_bf16 v[108:123], v[100:103], v[52:55], v[108:123]
  ds_read_b128 v[88:91], v141 offset:20800
  v_exp_f32 v30, v30
  v_exp_f32 v31, v31
  v_exp_f32 v32, v32
  v_exp_f32 v33, v33
  v_exp_f32 v34, v34
  v_exp_f32 v35, v35
  v_cvt_pk_bf16_f32 v56, v28, v29
  v_cvt_pk_bf16_f32 v57, v30, v31
  v_cvt_pk_bf16_f32 v58, v32, v33
  v_cvt_pk_bf16_f32 v59, v34, v35
  v_mfma_f32_32x32x16_bf16 v[20:35], v[60:63], v[12:15], 0
  v_exp_f32 v36, v36
  v_exp_f32 v37, v37
  v_exp_f32 v38, v38
  v_exp_f32 v39, v39
  v_mfma_f32_32x32x16_bf16 v[108:123], v[104:107], v[56:59], v[108:123]
  v_exp_f32 v40, v40
  v_exp_f32 v41, v41
  v_exp_f32 v42, v42
  v_exp_f32 v43, v43
  v_cvt_pk_bf16_f32 v52, v36, v37
  v_cvt_pk_bf16_f32 v53, v38, v39
  v_cvt_pk_bf16_f32 v54, v40, v41
  v_cvt_pk_bf16_f32 v55, v42, v43
  v_exp_f32 v44, v44
  v_exp_f32 v45, v45
  v_mfma_f32_32x32x16_bf16 v[124:139], v[100:103], v[52:55], v[124:139]
  v_exp_f32 v46, v46
  v_exp_f32 v47, v47
  v_exp_f32 v48, v48
  v_exp_f32 v49, v49
  v_exp_f32 v50, v50
  v_exp_f32 v51, v51
  v_cvt_pk_bf16_f32 v56, v44, v45
  v_cvt_pk_bf16_f32 v57, v46, v47
  v_cvt_pk_bf16_f32 v58, v48, v49
  v_cvt_pk_bf16_f32 v59, v50, v51
  v_mfma_f32_32x32x16_bf16 v[36:51], v[60:63], v[16:19], 0
  ds_read_b128 v[96:99], v140 offset:22880
  v_exp_f32 v20, v20
  v_exp_f32 v21, v21
  v_exp_f32 v22, v22
  v_exp_f32 v23, v23
  v_mfma_f32_32x32x16_bf16 v[124:139], v[104:107], v[56:59], v[124:139]
  ds_read_b128 v[104:107], v142 offset:22880
  v_exp_f32 v24, v24
  v_exp_f32 v25, v25
  v_exp_f32 v26, v26
  v_exp_f32 v27, v27
  v_cvt_pk_bf16_f32 v52, v20, v21
  v_cvt_pk_bf16_f32 v53, v22, v23
  v_cvt_pk_bf16_f32 v54, v24, v25
  v_cvt_pk_bf16_f32 v55, v26, v27
  v_exp_f32 v28, v28
  v_exp_f32 v29, v29
  v_mfma_f32_32x32x16_bf16 v[108:123], v[64:67], v[52:55], v[108:123]
  ds_read_b128 v[100:103], v141 offset:22880
  v_exp_f32 v30, v30
  v_exp_f32 v31, v31
  v_exp_f32 v32, v32
  v_exp_f32 v33, v33
  v_exp_f32 v34, v34
  v_exp_f32 v35, v35
  v_cvt_pk_bf16_f32 v56, v28, v29
  v_cvt_pk_bf16_f32 v57, v30, v31
  v_cvt_pk_bf16_f32 v58, v32, v33
  v_cvt_pk_bf16_f32 v59, v34, v35
  s_waitcnt lgkmcnt(3)
  v_add_u32 v145, 1, v145
  v_mfma_f32_32x32x16_bf16 v[20:35], v[72:75], v[12:15], 0
  ds_read_b32 v146, v143
  v_exp_f32 v36, v36
  v_exp_f32 v37, v37
  v_exp_f32 v38, v38
  v_exp_f32 v39, v39
  v_mfma_f32_32x32x16_bf16 v[108:123], v[68:71], v[56:59], v[108:123]
  v_exp_f32 v40, v40
  v_exp_f32 v41, v41
  v_exp_f32 v42, v42
  v_exp_f32 v43, v43
  v_cvt_pk_bf16_f32 v52, v36, v37
  v_cvt_pk_bf16_f32 v53, v38, v39
  v_cvt_pk_bf16_f32 v54, v40, v41
  v_cvt_pk_bf16_f32 v55, v42, v43
  v_exp_f32 v44, v44
  v_exp_f32 v45, v45
  v_mfma_f32_32x32x16_bf16 v[124:139], v[64:67], v[52:55], v[124:139]
  s_waitcnt lgkmcnt(0)
  s_nop 0
  v_exp_f32 v46, v46
  v_exp_f32 v47, v47
  v_exp_f32 v48, v48
  v_exp_f32 v49, v49
  v_exp_f32 v50, v50
  v_exp_f32 v51, v51
  v_cvt_pk_bf16_f32 v56, v44, v45
  v_cvt_pk_bf16_f32 v57, v46, v47
  v_cvt_pk_bf16_f32 v58, v48, v49
  v_cvt_pk_bf16_f32 v59, v50, v51
  v_cmp_le_u32 vcc, v145, v146
  s_cbranch_vccz at_wait2
at_resume2:
  v_mfma_f32_32x32x16_bf16 v[36:51], v[72:75], v[16:19], 0
  ds_read_b128 v[60:63], v140 offset:0
  v_exp_f32 v20, v20
  v_exp_f32 v21, v21
  v_exp_f32 v22, v22
  v_exp_f32 v23, v23
  v_mfma_f32_32x32x16_bf16 v[124:139], v[68:71], v[56:59], v[124:139]
  ds_read_b128 v[68:71], v142 offset:0
  v_exp_f32 v24, v24
  v_exp_f32 v25, v25
  v_exp_f32 v26, v26
  v_exp_f32 v27, v27
  v_cvt_pk_bf16_f32 v52, v20, v21
  v_cvt_pk_bf16_f32 v53, v22, v23
  v_cvt_pk_bf16_f32 v54, v24, v25
  v_cvt_pk_bf16_f32 v55, v26, v27
  v_exp_f32 v28, v28
  v_exp_f32 v29, v29
  v_mfma_f32_32x32x16_bf16 v[108:123], v[76:79], v[52:55], v[108:123]
  ds_read_b128 v[64:67], v141 offset:0
  v_exp_f32 v30, v30
  v_exp_f32 v31, v31
  v_exp_f32 v32, v32
  v_exp_f32 v33, v33
  v_exp_f32 v34, v34
  v_exp_f32 v35, v35
  v_cvt_pk_bf16_f32 v56, v28, v29
  v_cvt_pk_bf16_f32 v57, v30, v31
  v_cvt_pk_bf16_f32 v58, v32, v33
  v_cvt_pk_bf16_f32 v59, v34, v35
  v_mfma_f32_32x32x16_bf16 v[20:35], v[84:87], v[12:15], 0
  v_exp_f32 v36, v36
  v_exp_f32 v37, v37
  v_exp_f32 v38, v38
  v_exp_f32 v39, v39
  v_mfma_f32_32x32x16_bf16 v[108:123], v[80:83], v[56:59], v[108:123]
  v_exp_f32 v40, v40
  v_exp_f32 v41, v41
  v_exp_f32 v42, v42
  v_exp_f32 v43, v43
  v_cvt_pk_bf16_f32 v52, v36, v37
  v_cvt_pk_bf16_f32 v53, v38, v39
  v_cvt_pk_bf16_f32 v54, v40, v41
  v_cvt_pk_bf16_f32 v55, v42, v43
  v_exp_f32 v44, v44
  v_exp_f32 v45, v45
  v_mfma_f32_32x32x16_bf16 v[124:139], v[76:79], v[52:55], v[124:139]
  v_exp_f32 v46, v46
  v_exp_f32 v47, v47
  v_exp_f32 v48, v48
  v_exp_f32 v49, v49
  v_exp_f32 v50, v50
  v_exp_f32 v51, v51
  v_cvt_pk_bf16_f32 v56, v44, v45
  v_cvt_pk_bf16_f32 v57, v46, v47
  v_cvt_pk_bf16_f32 v58, v48, v49
  v_cvt_pk_bf16_f32 v59, v50, v51
  v_mfma_f32_32x32x16_bf16 v[36:51], v[84:87], v[16:19], 0
  ds_read_b128 v[72:75], v140 offset:2080
  v_exp_f32 v20, v20
  v_exp_f32 v21, v21
  v_exp_f32 v22, v22
  v_exp_f32 v23, v23
  v_mfma_f32_32x32x16_bf16 v[124:139], v[80:83], v[56:59], v[124:139]
  ds_read_b128 v[80:83], v142 offset:2080
  v_exp_f32 v24, v24
  v_exp_f32 v25, v25
  v_exp_f32 v26, v26
  v_exp_f32 v27, v27
  v_cvt_pk_bf16_f32 v52, v20, v21
  v_cvt_pk_bf16_f32 v53, v22, v23
  v_cvt_pk_bf16_f32 v54, v24, v25
  v_cvt_pk_bf16_f32 v55, v26, v27
  v_exp_f32 v28, v28
  v_exp_f32 v29, v29
  v_mfma_f32_32x32x16_bf16 v[108:123], v[88:91], v[52:55], v[108:123]
  ds_read_b128 v[76:79], v141 offset:2080
  v_exp_f32 v30, v30
  v_exp_f32 v31, v31
  v_exp_f32 v32, v32
  v_exp_f32 v33, v33
  v_exp_f32 v34, v34
  v_exp_f32 v35, v35
  v_cvt_pk_bf16_f32 v56, v28, v29
  v_cvt_pk_bf16_f32 v57, v30, v31
  v_cvt_pk_bf16_f32 v58, v32, v33
  v_cvt_pk_bf16_f32 v59, v34, v35
  s_waitcnt lgkmcnt(3)
  s_sub_u32 s35, s35, 1
  v_mfma_f32_32x32x16_bf16 v[20:35], v[96:99], v[12:15], 0
  ds_write_b32 v144, v145
  v_exp_f32 v36, v36
  v_exp_f32 v37, v37
  v_exp_f32 v38, v38
  v_exp_f32 v39, v39
  v_mfma_f32_32x32x16_bf16 v[108:123], v[92:95], v[56:59], v[108:123]
  v_exp_f32 v40, v40
  v_exp_f32 v41, v41
  v_exp_f32 v42, v42
  v_exp_f32 v43, v43
  v_cvt_pk_bf16_f32 v52, v36, v37
  v_cvt_pk_bf16_f32 v53, v38, v39
  v_cvt_pk_bf16_f32 v54, v40, v41
  v_cvt_pk_bf16_f32 v55, v42, v43
  v_exp_f32 v44, v44
  v_exp_f32 v45, v45
  v_mfma_f32_32x32x16_bf16 v[124:139], v[88:91], v[52:55], v[124:139]
  v_exp_f32 v46, v46
  v_exp_f32 v47, v47
  v_exp_f32 v48, v48
  v_exp_f32 v49, v49
  v_exp_f32 v50, v50
  v_exp_f32 v51, v51
  v_cvt_pk_bf16_f32 v56, v44, v45
  v_cvt_pk_bf16_f32 v57, v46, v47
  v_cvt_pk_bf16_f32 v58, v48, v49
  v_cvt_pk_bf16_f32 v59, v50, v51
  v_mfma_f32_32x32x16_bf16 v[36:51], v[96:99], v[16:19], 0
  ds_read_b128 v[84:87], v140 offset:4160
  v_exp_f32 v20, v20
  v_exp_f32 v21, v21
  v_exp_f32 v22, v22
  v_exp_f32 v23, v23
  v_mfma_f32_32x32x16_bf16 v[124:139], v[92:95], v[56:59], v[124:139]
  ds_read_b128 v[92:95], v142 offset:4160
  v_exp_f32 v24, v24
  v_exp_f32 v25, v25
  v_exp_f32 v26, v26
  v_exp_f32 v27, v27
  v_cvt_pk_bf16_f32 v52, v20, v21
  v_cvt_pk_bf16_f32 v53, v22, v23
  v_cvt_pk_bf16_f32 v54, v24, v25
  v_cvt_pk_bf16_f32 v55, v26, v27
  v_exp_f32 v28, v28
  v_exp_f32 v29, v29
  v_mfma_f32_32x32x16_bf16 v[108:123], v[100:103], v[52:55], v[108:123]
  ds_read_b128 v[88:91], v141 offset:4160
  v_exp_f32 v30, v30
  v_exp_f32 v31, v31
  v_exp_f32 v32, v32
  v_exp_f32 v33, v33
  v_exp_f32 v34, v34
  v_exp_f32 v35, v35
  v_cvt_pk_bf16_f32 v56, v28, v29
  v_cvt_pk_bf16_f32 v57, v30, v31
  v_cvt_pk_bf16_f32 v58, v32, v33
  v_cvt_pk_bf16_f32 v59, v34, v35
  v_mfma_f32_32x32x16_bf16 v[20:35], v[60:63], v[12:15], 0
  v_exp_f32 v36, v36
  v_exp_f32 v37, v37
  v_exp_f32 v38, v38
  v_exp_f32 v39, v39
  v_mfma_f32_32x32x16_bf16 v[108:123], v[104:107], v[56:59], v[108:123]
  v_exp_f32 v40, v40
  v_exp_f32 v41, v41
  v_exp_f32 v42, v42
  v_exp_f32 v43, v43
  v_cvt_pk_bf16_f32 v52, v36, v37
  v_cvt_pk_bf16_f32 v53, v38, v39
  v_cvt_pk_bf16_f32 v54, v40, v41
  v_cvt_pk_bf16_f32 v55, v42, v43
  v_exp_f32 v44, v44
  v_exp_f32 v45, v45
  v_mfma_f32_32x32x16_bf16 v[124:139], v[100:103], v[52:55], v[124:139]
  v_exp_f32 v46, v46
  v_exp_f32 v47, v47
  v_exp_f32 v48, v48
  v_exp_f32 v49, v49
  v_exp_f32 v50, v50
  v_exp_f32 v51, v51
  v_cvt_pk_bf16_f32 v56, v44, v45
  v_cvt_pk_bf16_f32 v57, v46, v47
  v_cvt_pk_bf16_f32 v58, v48, v49
  v_cvt_pk_bf16_f32 v59, v50, v51
  s_cbranch_scc0 at_loop
  s_nop 0
  v_mfma_f32_32x32x16_bf16 v[36:51], v[60:63], v[16:19], 0
  ds_read_b128 v[96:99], v140 offset:6240
  v_exp_f32 v20, v20
  v_exp_f32 v21, v21
  v_exp_f32 v22, v22
  v_exp_f32 v23, v23
  v_mfma_f32_32x32x16_bf16 v[124:139], v[104:107], v[56:59], v[124:139]
  ds_read_b128 v[104:107], v142 offset:6240
  v_exp_f32 v24, v24
  v_exp_f32 v25, v25
  v_exp_f32 v26, v26
  v_exp_f32 v27, v27
  v_cvt_pk_bf16_f32 v52, v20, v21
  v_cvt_pk_bf16_f32 v53, v22, v23
  v_cvt_pk_bf16_f32 v54, v24, v25
  v_cvt_pk_bf16_f32 v55, v26, v27
  v_exp_f32 v28, v28
  v_exp_f32 v29, v29
  v_mfma_f32_32x32x16_bf16 v[108:123], v[64:67], v[52:55], v[108:123]
  ds_read_b128 v[100:103], v141 offset:6240
  v_exp_f32 v30, v30
  v_exp_f32 v31, v31
  v_exp_f32 v32, v32
  v_exp_f32 v33, v33
  v_exp_f32 v34, v34
  v_exp_f32 v35, v35
  v_cvt_pk_bf16_f32 v56, v28, v29
  v_cvt_pk_bf16_f32 v57, v30, v31
  v_cvt_pk_bf16_f32 v58, v32, v33
  v_cvt_pk_bf16_f32 v59, v34, v35
  s_waitcnt lgkmcnt(3)
  v_add_u32 v145, 1, v145
  v_mfma_f32_32x32x16_bf16 v[20:35], v[72:75], v[12:15], 0
  v_exp_f32 v36, v36
  v_exp_f32 v37, v37
  v_exp_f32 v38, v38
  v_exp_f32 v39, v39
  v_mfma_f32_32x32x16_bf16 v[108:123], v[68:71], v[56:59], v[108:123]
  v_exp_f32 v40, v40
  v_exp_f32 v41, v41
  v_exp_f32 v42, v42
  v_exp_f32 v43, v43
  v_cvt_pk_bf16_f32 v52, v36, v37
  v_cvt_pk_bf16_f32 v53, v38, v39
  v_cvt_pk_bf16_f32 v54, v40, v41
  v_cvt_pk_bf16_f32 v55, v42, v43
  v_exp_f32 v44, v44
  v_exp_f32 v45, v45
  v_mfma_f32_32x32x16_bf16 v[124:139], v[64:67], v[52:55], v[124:139]
  v_exp_f32 v46, v46
  v_exp_f32 v47, v47
  v_exp_f32 v48, v48
  v_exp_f32 v49, v49
  v_exp_f32 v50, v50
  v_exp_f32 v51, v51
  v_cvt_pk_bf16_f32 v56, v44, v45
  v_cvt_pk_bf16_f32 v57, v46, v47
  v_cvt_pk_bf16_f32 v58, v48, v49
  v_cvt_pk_bf16_f32 v59, v50, v51
  v_mfma_f32_32x32x16_bf16 v[36:51], v[72:75], v[16:19], 0
  v_exp_f32 v20, v20
  v_exp_f32 v21, v21
  v_exp_f32 v22, v22
  v_exp_f32 v23, v23
  v_mfma_f32_32x32x16_bf16 v[124:139], v[68:71], v[56:59], v[124:139]
  v_exp_f32 v24, v24
  v_exp_f32 v25, v25
  v_exp_f32 v26, v26
  v_exp_f32 v27, v27
  v_cvt_pk_bf16_f32 v52, v20, v21
  v_cvt_pk_bf16_f32 v53, v22, v23
  v_cvt_pk_bf16_f32 v54, v24, v25
  v_cvt_pk_bf16_f32 v55, v26, v27
  v_exp_f32 v28, v28
  v_exp_f32 v29, v29
  v_mfma_f32_32x32x16_bf16 v[108:123], v[76:79], v[52:55], v[108:123]
  v_exp_f32 v30, v30
  v_exp_f32 v31, v31
  v_exp_f32 v32, v32
  v_exp_f32 v33, v33
  v_exp_f32 v34, v34
  v_exp_f32 v35, v35
  v_cvt_pk_bf16_f32 v56, v28, v29
  v_cvt_pk_bf16_f32 v57, v30, v31
  v_cvt_pk_bf16_f32 v58, v32, v33
  v_cvt_pk_bf16_f32 v59, v34, v35
  v_mfma_f32_32x32x16_bf16 v[20:35], v[84:87], v[12:15], 0
  v_exp_f32 v36, v36
  v_exp_f32 v37, v37
  v_exp_f32 v38, v38
  v_exp_f32 v39, v39
  v_mfma_f32_32x32x16_bf16 v[108:123], v[80:83], v[56:59], v[108:123]
  v_exp_f32 v40, v40
  v_exp_f32 v41, v41
  v_exp_f32 v42, v42
  v_exp_f32 v43, v43
  v_cvt_pk_bf16_f32 v52, v36, v37
  v_cvt_pk_bf16_f32 v53, v38, v39
  v_cvt_pk_bf16_f32 v54, v40, v41
  v_cvt_pk_bf16_f32 v55, v42, v43
  v_exp_f32 v44, v44
  v_exp_f32 v45, v45
  v_mfma_f32_32x32x16_bf16 v[124:139], v[76:79], v[52:55], v[124:139]
  v_exp_f32 v46, v46
  v_exp_f32 v47, v47
  v_exp_f32 v48, v48
  v_exp_f32 v49, v49
  v_exp_f32 v50, v50
  v_exp_f32 v51, v51
  v_cvt_pk_bf16_f32 v56, v44, v45
  v_cvt_pk_bf16_f32 v57, v46, v47
  v_cvt_pk_bf16_f32 v58, v48, v49
  v_cvt_pk_bf16_f32 v59, v50, v51
  v_mfma_f32_32x32x16_bf16 v[36:51], v[84:87], v[16:19], 0
  v_exp_f32 v20, v20
  v_exp_f32 v21, v21
  v_exp_f32 v22, v22
  v_exp_f32 v23, v23
  v_mfma_f32_32x32x16_bf16 v[124:139], v[80:83], v[56:59], v[124:139]
  v_exp_f32 v24, v24
  v_exp_f32 v25, v25
  v_exp_f32 v26, v26
  v_exp_f32 v27, v27
  v_cvt_pk_bf16_f32 v52, v20, v21
  v_cvt_pk_bf16_f32 v53, v22, v23
  v_cvt_pk_bf16_f32 v54, v24, v25
  v_cvt_pk_bf16_f32 v55, v26, v27
  v_exp_f32 v28, v28
  v_exp_f32 v29, v29
  v_mfma_f32_32x32x16_bf16 v[108:123], v[88:91], v[52:55], v[108:123]
  v_exp_f32 v30, v30
  v_exp_f32 v31, v31
  v_exp_f32 v32, v32
  v_exp_f32 v33, v33
  v_exp_f32 v34, v34
  v_exp_f32 v35, v35
  v_cvt_pk_bf16_f32 v56, v28, v29
  v_cvt_pk_bf16_f32 v57, v30, v31
  v_cvt_pk_bf16_f32 v58, v32, v33
  v_cvt_pk_bf16_f32 v59, v34, v35
  s_waitcnt lgkmcnt(0)
  s_nop 0
  v_mfma_f32_32x32x16_bf16 v[20:35], v[96:99], v[12:15], 0
  v_exp_f32 v36, v36
  v_exp_f32 v37, v37
  v_exp_f32 v38, v38
  v_exp_f32 v39, v39
  v_mfma_f32_32x32x16_bf16 v[108:123], v[92:95], v[56:59], v[108:123]
  v_exp_f32 v40, v40
  v_exp_f32 v41, v41
  v_exp_f32 v42, v42
  v_exp_f32 v43, v43
  v_cvt_pk_bf16_f32 v52, v36, v37
  v_cvt_pk_bf16_f32 v53, v38, v39
  v_cvt_pk_bf16_f32 v54, v40, v41
  v_cvt_pk_bf16_f32 v55, v42, v43
  v_exp_f32 v44, v44
  v_exp_f32 v45, v45
  v_mfma_f32_32x32x16_bf16 v[124:139], v[88:91], v[52:55], v[124:139]
  v_exp_f32 v46, v46
  v_exp_f32 v47, v47
  v_exp_f32 v48, v48
  v_exp_f32 v49, v49
  v_exp_f32 v50, v50
  v_exp_f32 v51, v51
  v_cvt_pk_bf16_f32 v56, v44, v45
  v_cvt_pk_bf16_f32 v57, v46, v47
  v_cvt_pk_bf16_f32 v58, v48, v49
  v_cvt_pk_bf16_f32 v59, v50, v51
  v_mfma_f32_32x32x16_bf16 v[36:51], v[96:99], v[16:19], 0
  v_exp_f32 v20, v20
  v_exp_f32 v21, v21
  v_exp_f32 v22, v22
  v_exp_f32 v23, v23
  v_mfma_f32_32x32x16_bf16 v[124:139], v[92:95], v[56:59], v[124:139]
  v_exp_f32 v24, v24
  v_exp_f32 v25, v25
  v_exp_f32 v26, v26
  v_exp_f32 v27, v27
  v_cvt_pk_bf16_f32 v52, v20, v21
  v_cvt_pk_bf16_f32 v53, v22, v23
  v_cvt_pk_bf16_f32 v54, v24, v25
  v_cvt_pk_bf16_f32 v55, v26, v27
  v_exp_f32 v28, v28
  v_exp_f32 v29, v29
  v_mfma_f32_32x32x16_bf16 v[108:123], v[100:103], v[52:55], v[108:123]
  v_exp_f32 v30, v30
  v_exp_f32 v31, v31
  v_exp_f32 v32, v32
  v_exp_f32 v33, v33
  v_exp_f32 v34, v34
  v_exp_f32 v35, v35
  v_cvt_pk_bf16_f32 v56, v28, v29
  v_cvt_pk_bf16_f32 v57, v30, v31
  v_cvt_pk_bf16_f32 v58, v32, v33
  v_cvt_pk_bf16_f32 v59, v34, v35
  v_mfma_f32_32x32x16_bf16 v[20:35], v[60:63], v[12:15], 0
  v_exp_f32 v36, v36
  v_exp_f32 v37, v37
  v_exp_f32 v38, v38
  v_exp_f32 v39, v39
  v_mfma_f32_32x32x16_bf16 v[108:123], v[104:107], v[56:59], v[108:123]
  v_exp_f32 v40, v40
  v_exp_f32 v41, v41
  v_exp_f32 v42, v42
  v_exp_f32 v43, v43
  v_cvt_pk_bf16_f32 v52, v36, v37
  v_cvt_pk_bf16_f32 v53, v38, v39
  v_cvt_pk_bf16_f32 v54, v40, v41
  v_cvt_pk_bf16_f32 v55, v42, v43
  v_exp_f32 v44, v44
  v_exp_f32 v45, v45
  v_mfma_f32_32x32x16_bf16 v[124:139], v[100:103], v[52:55], v[124:139]
  v_exp_f32 v46, v46
  v_exp_f32 v47, v47
  v_exp_f32 v48, v48
  v_exp_f32 v49, v49
  v_exp_f32 v50, v50
  v_exp_f32 v51, v51
  v_cvt_pk_bf16_f32 v56, v44, v45
  v_cvt_pk_bf16_f32 v57, v46, v47
  v_cvt_pk_bf16_f32 v58, v48, v49
  v_cvt_pk_bf16_f32 v59, v50, v51
  s_nop 1
  v_mfma_f32_32x32x16_bf16 v[124:139], v[104:107], v[56:59], v[124:139]
  s_setprio 3
  v_rcp_f32 v117, v116
  s_nop 0
  v_mul_f32 v108, v108, v117
  v_mul_f32 v109, v109, v117
  v_mul_f32 v110, v110, v117
  v_mul_f32 v111, v111, v117
  v_mul_f32 v112, v112, v117
  v_mul_f32 v113, v113, v117
  v_mul_f32 v114, v114, v117
  v_mul_f32 v115, v115, v117
  s_nop 0
  v_rcp_f32 v133, v132
  s_nop 0
  v_mul_f32 v124, v124, v133
  v_mul_f32 v125, v125, v133
  v_mul_f32 v126, v126, v133
  v_mul_f32 v127, v127, v133
  v_mul_f32 v128, v128, v133
  v_mul_f32 v129, v129, v133
  v_mul_f32 v130, v130, v133
  v_mul_f32 v131, v131, v133
  v_cvt_pk_bf16_f32 v52, v108, v109
  v_cvt_pk_bf16_f32 v53, v110, v111
  v_cvt_pk_bf16_f32 v54, v112, v113
  v_cvt_pk_bf16_f32 v55, v114, v115
  buffer_store_dwordx4 v[52:55], v2, s[44:47], s48 offen sc1
  v_cvt_pk_bf16_f32 v56, v124, v125
  v_cvt_pk_bf16_f32 v57, v126, v127
  v_cvt_pk_bf16_f32 v58, v128, v129
  v_cvt_pk_bf16_f32 v59, v130, v131
  buffer_store_dwordx4 v[56:59], v2, s[44:47], s49 offen sc1
  s_mov_b32 s52, 0x12800000
  s_mov_b32 s53, 0x7b800000
  s_mov_b32 s54, 0x7f800000
  s_mov_b64 s[50:51], -1
  v_cmp_le_f32 vcc, s52, v116
  s_nop 0
  s_and_b64 s[50:51], s[50:51], vcc
  v_cmp_ge_f32 vcc, s53, v116
  s_nop 0
  s_and_b64 s[50:51], s[50:51], vcc
  v_add_f32 v118, abs(v108), abs(v109)
  v_add_f32 v118, v118, abs(v110)
  v_add_f32 v118, v118, abs(v111)
  v_add_f32 v118, v118, abs(v112)
  v_add_f32 v118, v118, abs(v113)
  v_add_f32 v118, v118, abs(v114)
  v_add_f32 v118, v118, abs(v115)
  v_cmp_gt_f32 vcc, s54, v118
  s_nop 0
  s_and_b64 s[50:51], s[50:51], vcc
  v_cmp_le_f32 vcc, s52, v132
  s_nop 0
  s_and_b64 s[50:51], s[50:51], vcc
  v_cmp_ge_f32 vcc, s53, v132
  s_nop 0
  s_and_b64 s[50:51], s[50:51], vcc
  v_add_f32 v134, abs(v124), abs(v125)
  v_add_f32 v134, v134, abs(v126)
  v_add_f32 v134, v134, abs(v127)
  v_add_f32 v134, v134, abs(v128)
  v_add_f32 v134, v134, abs(v129)
  v_add_f32 v134, v134, abs(v130)
  v_add_f32 v134, v134, abs(v131)
  v_cmp_gt_f32 vcc, s54, v134
  s_nop 0
  s_and_b64 s[50:51], s[50:51], vcc
  s_cmp_eq_u64 s[50:51], -1
  s_cbranch_scc0 at_slow
at_store:
  s_sub_u32 s48, s48, s34
  s_lshr_b32 s48, s48, 10
  s_lshl_b32 s48, s48, 12
  s_lshl_b32 s16, s13, 7
  s_add_u32 s48, s48, s16
  s_add_u32 s48, s48, 262144
  v_mov_b32 v4, s60
  v_mov_b32 v5, s61
  v_mov_b32 v6, s60
  v_mov_b32 v7, s61
  v_lshlrev_b32 v8, 4, v1
  v_mov_b32 v9, 17
  ds_write_b32 v144, v9
  v_mov_b32 v10, 18
  s_waitcnt vmcnt(0)
  s_mov_b64 exec, 0xff
  buffer_store_dwordx4 v[4:7], v8, s[36:39], s48 offen sc1
  s_mov_b64 exec, -1
  ds_write_b32 v144, v10
  s_endpgm
at_wait0:
  v_readfirstlane_b32 s16, v145
at_wait_spin0:
  ds_read_b32 v9, v143
  s_waitcnt lgkmcnt(0)
  v_readfirstlane_b32 s17, v9
  s_nop 0
  s_cmp_ge_u32 s17, s16
  s_cbranch_scc1 at_wait_spin0_ok
  s_sleep 0
  s_sub_u32 s62, s62, 1
  s_cbranch_scc0 at_wait_spin0
  s_mov_b32 s62, 0
at_wait_spin0_ok:
  s_branch at_resume0
at_wait1:
  v_readfirstlane_b32 s16, v145
at_wait_spin1:
  ds_read_b32 v9, v143
  s_waitcnt lgkmcnt(0)
  v_readfirstlane_b32 s17, v9
  s_nop 0
  s_cmp_ge_u32 s17, s16
  s_cbranch_scc1 at_wait_spin1_ok
  s_sleep 0
  s_sub_u32 s62, s62, 1
  s_cbranch_scc0 at_wait_spin1
  s_mov_b32 s62, 0
at_wait_spin1_ok:
  s_branch at_resume1
at_wait2:
  v_readfirstlane_b32 s16, v145
at_wait_spin2:
  ds_read_b32 v9, v143
  s_waitcnt lgkmcnt(0)
  v_readfirstlane_b32 s17, v9
  s_nop 0
  s_cmp_ge_u32 s17, s16
  s_cbranch_scc1 at_wait_spin2_ok
  s_sleep 0
  s_sub_u32 s62, s62, 1
  s_cbranch_scc0 at_wait_spin2
  s_mov_b32 s62, 0
at_wait_spin2_ok:
  s_branch at_resume2
at_slow:
  s_mov_b32 s42, 0xffff
  s_mov_b32 s43, 0xffff
  v_and_b32 v6, 27, v1
  v_cmp_eq_u32 vcc, 16, v6
  v_mov_b32 v6, 0x3f803f80
  s_waitcnt vmcnt(0) lgkmcnt(0)
  v_cndmask_b32 v64, 0, v6, vcc
  v_cndmask_b32 v65, 0, v6, vcc
  v_cndmask_b32 v66, 0, v6, vcc
  v_cndmask_b32 v67, 0, v6, vcc
  v_cndmask_b32 v68, 0, v6, vcc
  v_cndmask_b32 v69, 0, v6, vcc
  v_cndmask_b32 v70, 0, v6, vcc
  v_cndmask_b32 v71, 0, v6, vcc
  v_mov_b32 v10, 0xff800000
  s_mov_b32 s32, s34
  s_mov_b32 s35, 64
at_max0:
  buffer_load_dwordx4 v[60:63], v2, s[24:27], s32 offen sc1
  s_add_u32 s32, s32, 512
  s_waitcnt vmcnt(0)
  v_mfma_f32_32x32x16_bf16 v[20:35], v[60:63], v[12:15], 0
  s_nop 11
  v_max3_f32 v10, v10, v20, v21
  v_max3_f32 v10, v10, v22, v23
  v_max3_f32 v10, v10, v24, v25
  v_max3_f32 v10, v10, v26, v27
  v_max3_f32 v10, v10, v28, v29
  v_max3_f32 v10, v10, v30, v31
  v_max3_f32 v10, v10, v32, v33
  v_max3_f32 v10, v10, v34, v35
  s_sub_u32 s35, s35, 1
  s_cmp_lg_u32 s35, 0
  s_cbranch_scc1 at_max0
  v_mov_b32 v11, v10
  s_nop 1
  v_permlane32_swap_b32 v10, v11
  v_max_f32 v10, v10, v11
  v_sub_f32 v36, 0, v10
  v_mov_b32 v108, 0
  v_sub_f32 v37, 0, v10
  v_mov_b32 v109, 0
  v_sub_f32 v38, 0, v10
  v_mov_b32 v110, 0
  v_sub_f32 v39, 0, v10
  v_mov_b32 v111, 0
  v_sub_f32 v40, 0, v10
  v_mov_b32 v112, 0
  v_sub_f32 v41, 0, v10
  v_mov_b32 v113, 0
  v_sub_f32 v42, 0, v10
  v_mov_b32 v114, 0
  v_sub_f32 v43, 0, v10
  v_mov_b32 v115, 0
  v_sub_f32 v44, 0, v10
  v_mov_b32 v116, 0
  v_sub_f32 v45, 0, v10
  v_mov_b32 v117, 0
  v_sub_f32 v46, 0, v10
  v_mov_b32 v118, 0
  v_sub_f32 v47, 0, v10
  v_mov_b32 v119, 0
  v_sub_f32 v48, 0, v10
  v_mov_b32 v120, 0
  v_sub_f32 v49, 0, v10
  v_mov_b32 v121, 0
  v_sub_f32 v50, 0, v10
  v_mov_b32 v122, 0
  v_sub_f32 v51, 0, v10
  v_mov_b32 v123, 0
  s_mov_b32 s32, s34
  s_mov_b32 s33, s34
  s_mov_b32 s35, 64
at_pv0:
  buffer_load_dwordx4 v[60:63], v2, s[24:27], s32 offen sc1
  s_mov_b64 exec, s[42:43]
  buffer_load_dwordx4 v[64:67], v3, s[28:31], s33 offen sc1
  buffer_load_dwordx4 v[68:71], v3, s[28:31], s33 offen offset:512 sc1
  s_mov_b64 exec, -1
  s_add_u32 s32, s32, 512
  s_add_u32 s33, s33, 1024
  s_waitcnt vmcnt(0)
  v_mfma_f32_32x32x16_bf16 v[20:35], v[60:63], v[12:15], v[36:51]
  s_nop 11
  v_exp_f32 v20, v20
  v_exp_f32 v21, v21
  v_exp_f32 v22, v22
  v_exp_f32 v23, v23
  v_exp_f32 v24, v24
  v_exp_f32 v25, v25
  v_exp_f32 v26, v26
  v_exp_f32 v27, v27
  v_exp_f32 v28, v28
  v_exp_f32 v29, v29
  v_exp_f32 v30, v30
  v_exp_f32 v31, v31
  v_exp_f32 v32, v32
  v_exp_f32 v33, v33
  v_exp_f32 v34, v34
  v_exp_f32 v35, v35
  v_cvt_pk_bf16_f32 v52, v20, v21
  v_cvt_pk_bf16_f32 v53, v22, v23
  v_cvt_pk_bf16_f32 v54, v24, v25
  v_cvt_pk_bf16_f32 v55, v26, v27
  v_cvt_pk_bf16_f32 v56, v28, v29
  v_cvt_pk_bf16_f32 v57, v30, v31
  v_cvt_pk_bf16_f32 v58, v32, v33
  v_cvt_pk_bf16_f32 v59, v34, v35
  v_mfma_f32_32x32x16_bf16 v[108:123], v[64:67], v[52:55], v[108:123]
  s_nop 0
  v_mfma_f32_32x32x16_bf16 v[108:123], v[68:71], v[56:59], v[108:123]
  s_sub_u32 s35, s35, 1
  s_cmp_lg_u32 s35, 0
  s_cbranch_scc1 at_pv0
  s_nop 8
  v_rcp_f32 v117, v116
  s_nop 0
  v_mul_f32 v108, v108, v117
  v_mul_f32 v109, v109, v117
  v_mul_f32 v110, v110, v117
  v_mul_f32 v111, v111, v117
  v_mul_f32 v112, v112, v117
  v_mul_f32 v113, v113, v117
  v_mul_f32 v114, v114, v117
  v_mul_f32 v115, v115, v117
  v_mov_b32 v10, 0xff800000
  s_mov_b32 s32, s34
  s_mov_b32 s35, 64
at_max1:
  buffer_load_dwordx4 v[60:63], v2, s[24:27], s32 offen sc1
  s_add_u32 s32, s32, 512
  s_waitcnt vmcnt(0)
  v_mfma_f32_32x32x16_bf16 v[20:35], v[60:63], v[16:19], 0
  s_nop 11
  v_max3_f32 v10, v10, v20, v21
  v_max3_f32 v10, v10, v22, v23
  v_max3_f32 v10, v10, v24, v25
  v_max3_f32 v10, v10, v26, v27
  v_max3_f32 v10, v10, v28, v29
  v_max3_f32 v10, v10, v30, v31
  v_max3_f32 v10, v10, v32, v33
  v_max3_f32 v10, v10, v34, v35
  s_sub_u32 s35, s35, 1
  s_cmp_lg_u32 s35, 0
  s_cbranch_scc1 at_max1
  v_mov_b32 v11, v10
  s_nop 1
  v_permlane32_swap_b32 v10, v11
  v_max_f32 v10, v10, v11
  v_sub_f32 v36, 0, v10
  v_mov_b32 v124, 0
  v_sub_f32 v37, 0, v10
  v_mov_b32 v125, 0
  v_sub_f32 v38, 0, v10
  v_mov_b32 v126, 0
  v_sub_f32 v39, 0, v10
  v_mov_b32 v127, 0
  v_sub_f32 v40, 0, v10
  v_mov_b32 v128, 0
  v_sub_f32 v41, 0, v10
  v_mov_b32 v129, 0
  v_sub_f32 v42, 0, v10
  v_mov_b32 v130, 0
  v_sub_f32 v43, 0, v10
  v_mov_b32 v131, 0
  v_sub_f32 v44, 0, v10
  v_mov_b32 v132, 0
  v_sub_f32 v45, 0, v10
  v_mov_b32 v133, 0
  v_sub_f32 v46, 0, v10
  v_mov_b32 v134, 0
  v_sub_f32 v47, 0, v10
  v_mov_b32 v135, 0
  v_sub_f32 v48, 0, v10
  v_mov_b32 v136, 0
  v_sub_f32 v49, 0, v10
  v_mov_b32 v137, 0
  v_sub_f32 v50, 0, v10
  v_mov_b32 v138, 0
  v_sub_f32 v51, 0, v10
  v_mov_b32 v139, 0
  s_mov_b32 s32, s34
  s_mov_b32 s33, s34
  s_mov_b32 s35, 64
at_pv1:
  buffer_load_dwordx4 v[60:63], v2, s[24:27], s32 offen sc1
  s_mov_b64 exec, s[42:43]
  buffer_load_dwordx4 v[64:67], v3, s[28:31], s33 offen sc1
  buffer_load_dwordx4 v[68:71], v3, s[28:31], s33 offen offset:512 sc1
  s_mov_b64 exec, -1
  s_add_u32 s32, s32, 512
  s_add_u32 s33, s33, 1024
  s_waitcnt vmcnt(0)
  v_mfma_f32_32x32x16_bf16 v[20:35], v[60:63], v[16:19], v[36:51]
  s_nop 11
  v_exp_f32 v20, v20
  v_exp_f32 v21, v21
  v_exp_f32 v22, v22
  v_exp_f32 v23, v23
  v_exp_f32 v24, v24
  v_exp_f32 v25, v25
  v_exp_f32 v26, v26
  v_exp_f32 v27, v27
  v_exp_f32 v28, v28
  v_exp_f32 v29, v29
  v_exp_f32 v30, v30
  v_exp_f32 v31, v31
  v_exp_f32 v32, v32
  v_exp_f32 v33, v33
  v_exp_f32 v34, v34
  v_exp_f32 v35, v35
  v_cvt_pk_bf16_f32 v52, v20, v21
  v_cvt_pk_bf16_f32 v53, v22, v23
  v_cvt_pk_bf16_f32 v54, v24, v25
  v_cvt_pk_bf16_f32 v55, v26, v27
  v_cvt_pk_bf16_f32 v56, v28, v29
  v_cvt_pk_bf16_f32 v57, v30, v31
  v_cvt_pk_bf16_f32 v58, v32, v33
  v_cvt_pk_bf16_f32 v59, v34, v35
  v_mfma_f32_32x32x16_bf16 v[124:139], v[64:67], v[52:55], v[124:139]
  s_nop 0
  v_mfma_f32_32x32x16_bf16 v[124:139], v[68:71], v[56:59], v[124:139]
  s_sub_u32 s35, s35, 1
  s_cmp_lg_u32 s35, 0
  s_cbranch_scc1 at_pv1
  s_nop 8
  v_rcp_f32 v133, v132
  s_nop 0
  v_mul_f32 v124, v124, v133
  v_mul_f32 v125, v125, v133
  v_mul_f32 v126, v126, v133
  v_mul_f32 v127, v127, v133
  v_mul_f32 v128, v128, v133
  v_mul_f32 v129, v129, v133
  v_mul_f32 v130, v130, v133
  v_mul_f32 v131, v131, v133
  v_cvt_pk_bf16_f32 v52, v108, v109
  v_cvt_pk_bf16_f32 v53, v110, v111
  v_cvt_pk_bf16_f32 v54, v112, v113
  v_cvt_pk_bf16_f32 v55, v114, v115
  buffer_store_dwordx4 v[52:55], v2, s[44:47], s48 offen sc1
  v_cvt_pk_bf16_f32 v56, v124, v125
  v_cvt_pk_bf16_f32 v57, v126, v127
  v_cvt_pk_bf16_f32 v58, v128, v129
  v_cvt_pk_bf16_f32 v59, v130, v131
  buffer_store_dwordx4 v[56:59], v2, s[44:47], s49 offen sc1
  s_branch at_store
f_s:
  s_setprio 3
  s_lshl4_add_u32 s44, s15, s13
  s_lshl_b32 s43, s44, 7
  s_add_u32 s43, s43, 622592
  s_mov_b32 s21, s14
  s_cmp_eq_u32 s14, 0
  s_cselect_b32 s43, s43, 0x7ff00000
  s_lshl1_add_u32 s44, s44, s14
  s_lshl_b32 s44, s44, 7
  s_add_u32 s44, s44, 458752
  s_lshl_b32 s45, s13, 5
  s_add_u32 s45, s45, s15
  s_lshl_b32 s45, s45, 7
  s_add_u32 s45, s45, 393216
  s_cmp_eq_u32 s14, 1
  s_cselect_b32 s45, s45, 0x7ff00000
  s_and_b32 s46, s2, 7
  s_bfe_u32 s17, s2, 0x20003
  s_lshl2_add_u32 s46, s46, s17
  s_lshr_b32 s17, s2, 5
  s_lshl_b32 s17, s17, 7
  s_add_u32 s46, s46, s17
  s_lshl_b32 s46, s46, 7
  s_add_u32 s46, s46, 262144
  s_bfe_u32 s18, s2, 0x20001
  s_bfe_u32 s19, s2, 0x20003
  s_lshl2_add_u32 s16, s18, s19
  s_and_b32 s18, s2, 1
  s_lshr_b32 s19, s2, 5
  s_lshl3_add_u32 s17, s18, s19
  s_lshl_b32 s16, s16, 6
  s_add_u32 s16, s16, s17
  s_lshl_b32 s47, s16, 7
  s_add_u32 s48, s47, 131072
  s_xor_b32 s49, s47, 128
  s_add_u32 s49, s49, 491520
  s_and_b32 s13, s2, 7
  s_lshl_b32 s13, s13, 2
  s_bfe_u32 s14, s2, 0x20003
  s_add_u32 s13, s13, s14
  s_lshr_b32 s14, s2, 5
  s_lshl_b32 s34, s13, 16
  s_waitcnt lgkmcnt(0)
  s_add_u32 s24, s10, 0x200000
  s_addc_u32 s25, s11, 0
  s_mov_b32 s26, 0x200000
  s_mov_b32 s27, 0x20000
  s_add_u32 s28, s10, 0x400000
  s_addc_u32 s29, s11, 0
  s_mov_b32 s30, 0x200000
  s_mov_b32 s31, 0x20000
  s_add_u32 s36, s10, 0x1300000
  s_addc_u32 s37, s11, 0
  s_mov_b32 s38, 0x9c000
  s_mov_b32 s39, 0x20000
  v_and_b32 v4, 31, v1
  v_lshrrev_b32 v5, 5, v1
  v_lshlrev_b32 v2, 15, v5
  v_lshl_add_u32 v2, v4, 4, v2
  v_and_b32 v3, 15, v1
  v_lshlrev_b32 v3, 4, v3
  v_lshl_add_u32 v3, v5, 8, v3
  v_lshlrev_b32 v3, 4, v1
  v_add_u32 v12, 512, v2
  v_add_u32 v16, 1024, v3
  v_add_u32 v13, 1024, v2
  v_add_u32 v17, 2048, v3
  v_add_u32 v14, 1536, v2
  v_add_u32 v18, 3072, v3
  v_and_b32 v4, 1, v1
  v_cmp_eq_u32 vcc, 0, v4
  v_lshrrev_b32 v5, 1, v1
  v_min_u32 v5, 11, v5
  v_mul_u32_u24 v5, 2080, v5
  v_lshl_add_u32 v5, v4, 4, v5
  v_add_u32 v8, 133120, v5
  v_mov_b32 v9, 0x3f803f80
  v_cndmask_b32 v4, 0, v9, vcc
  v_cndmask_b32 v5, 0, v9, vcc
  v_cndmask_b32 v6, 0, v9, vcc
  v_cndmask_b32 v7, 0, v9, vcc
  ds_write_b128 v8, v[4:7]
  s_lshr_b32 s17, s13, 2
  s_lshl_b32 s16, s17, 12
  s_add_u32 s16, s16, 458752
  v_lshl_add_u32 v9, v1, 7, s16
  s_lshl3_add_u32 s16, s17, s14
  s_lshl_b32 s16, s16, 8
  s_add_u32 s16, s16, 622592
  v_and_b32 v8, 1, v1
  v_lshl_add_u32 v8, v8, 7, s16
  v_cmp_gt_u32 vcc, 32, v1
  s_nop 1
  v_cndmask_b32 v9, v8, v9, vcc
  v_mov_b32 v10, 156064
  v_mov_b32 v11, 156096
  v_and_b32 v20, 3, v1
  v_lshlrev_b32 v20, 2, v20
  v_add_u32 v20, 156104, v20
  v_mov_b32 v21, 4
  s_mov_b32 s40, -1
  s_mov_b32 s41, 0x55555555
  s_mov_b32 s42, 0
  s_mov_b32 s18, 131072
  s_mov_b32 s19, 0
  v_mov_b32 v8, 156088
  s_waitcnt lgkmcnt(0)
  s_barrier
  s_barrier
  s_barrier
  v_mov_b32 v24, 0
  v_mov_b32 v25, 0
  v_mov_b32 v26, 0
  v_mov_b32 v27, 0
  v_and_b32 v28, 7, v1
  v_lshlrev_b32 v28, 4, v28
  v_lshrrev_b32 v29, 3, v1
  v_lshl_add_u32 v30, v29, 10, v28
  v_lshl_add_u32 v31, v29, 11, v28
  v_lshl_add_u32 v32, v29, 12, v28
  s_mov_b64 exec, 0xff
  buffer_store_dwordx4 v[24:27], v28, s[36:39], s43 offen sc1
  buffer_store_dwordx4 v[24:27], v28, s[36:39], s44 offen sc1
  s_mov_b32 exec_lo, -1
  buffer_store_dwordx4 v[24:27], v30, s[36:39], s45 offen sc1
  buffer_store_dwordx4 v[24:27], v31, s[36:39], s47 offen sc1
  buffer_store_dwordx4 v[24:27], v31, s[36:39], s48 offen sc1
  buffer_store_dwordx4 v[24:27], v31, s[36:39], s49 offen sc1
  buffer_store_dwordx4 v[24:27], v32, s[36:39], s46 offen sc1
  s_mov_b64 exec, -1
  s_barrier
  s_barrier
  s_barrier
  s_barrier
  s_barrier
  s_waitcnt vmcnt(0)
  s_barrier
  ds_read_b64 v[4:5], v8
  s_waitcnt lgkmcnt(0)
  v_readfirstlane_b32 s60, v4
  v_readfirstlane_b32 s61, v5
  s_nop 0
  v_mov_b32 v24, s60
  v_mov_b32 v25, s61
  v_mov_b32 v26, s60
  v_mov_b32 v27, s61
  v_lshlrev_b32 v28, 4, v1
  v_mov_b32 v24, s60
  v_mov_b32 v25, s61
  v_mov_b32 v26, s60
  v_mov_b32 v27, s61
  v_lshlrev_b32 v28, 4, v1
  s_cmp_eq_u32 s21, 0
  s_cbranch_scc0 f_no_q
  v_mov_b32 v8, 156100
f_pubq:
  ds_read_b32 v4, v8
  s_waitcnt lgkmcnt(0)
  v_readfirstlane_b32 s17, v4
  s_nop 0
  s_cmp_ge_u32 s17, 4
  s_cbranch_scc1 f_pubq_ok
  s_sleep 1
  s_sub_u32 s62, s62, 1
  s_cbranch_scc0 f_pubq
  s_mov_b32 s62, 0
f_pubq_ok:
  s_mov_b64 exec, 0xff
  buffer_store_dwordx4 v[24:27], v28, s[36:39], s43 offen sc1
  s_mov_b64 exec, -1
f_no_q:
  v_mov_b32 v8, 156060
f_pub:
  ds_read_b32 v4, v8
  s_waitcnt lgkmcnt(0)
  v_readfirstlane_b32 s17, v4
  s_nop 0
  s_cmp_ge_u32 s17, 4
  s_cbranch_scc1 f_pub_ok
  s_sleep 1
  s_sub_u32 s62, s62, 1
  s_cbranch_scc0 f_pub
  s_mov_b32 s62, 0
f_pub_ok:
  s_mov_b64 exec, 0xff
  buffer_store_dwordx4 v[24:27], v28, s[36:39], s44 offen sc1
  s_mov_b64 exec, -1
st_q:
  buffer_load_dwordx2 v[6:7], v9, s[36:39], 0 offen sc1
  s_waitcnt vmcnt(0)
  v_cmp_eq_u64 vcc, s[60:61], v[6:7]
  s_nop 0
  s_lshr_b32 s17, vcc_lo, 1
  s_and_b32 s17, s17, vcc_lo
  s_and_b32 s42, s17, s41
  s_andn2_b32 s17, s40, vcc_hi
  s_cbranch_scc1 st_q_noq
  ds_write_b32 v10, v21
  s_mov_b32 s40, 0
st_q_noq:
  s_cmp_eq_u32 s40, 0
  s_cbranch_scc1 st_loop
  s_sleep 8
  s_sub_u32 s62, s62, 1
  s_cbranch_scc0 st_q
  s_mov_b32 s62, 0
st_loop:
  s_cmp_lg_u32 s42, 0
  s_cbranch_scc1 st_have
  v_mov_b32 v22, s19
  s_waitcnt vmcnt(0)
  ds_write_b32 v11, v22
st_kv:
  buffer_load_dwordx2 v[6:7], v9, s[36:39], 0 offen sc1
  s_waitcnt vmcnt(0)
  v_cmp_eq_u64 vcc, s[60:61], v[6:7]
  s_nop 0
  s_lshr_b32 s17, vcc_lo, 1
  s_and_b32 s17, s17, vcc_lo
  s_and_b32 s42, s17, s41
  s_andn2_b32 s17, s40, vcc_hi
  s_cbranch_scc1 st_kv_noq
  ds_write_b32 v10, v21
  s_mov_b32 s40, 0
st_kv_noq:
  s_cmp_lg_u32 s42, 0
  s_cbranch_scc1 st_have
  s_sleep 6
  s_sub_u32 s62, s62, 1
  s_cbranch_scc0 st_kv
  s_mov_b32 s62, 0
  s_mov_b32 s42, s41
st_have:
  s_cmp_lt_u32 s19, 3
  s_cbranch_scc1 st_issue
  v_mov_b32 v22, s19
  s_waitcnt vmcnt(0)
  ds_write_b32 v11, v22
  s_sub_u32 s20, s19, 1
st_free:
  ds_read_b32 v23, v20
  s_waitcnt lgkmcnt(0)
  v_cmp_le_u32 vcc, s20, v23
  s_nop 0
  s_cmp_eq_u64 vcc, -1
  s_cbranch_scc1 st_issue
  s_sleep 6
  s_sub_u32 s62, s62, 1
  s_cbranch_scc0 st_free
  s_mov_b32 s62, 0
st_issue:
  s_ff1_i32_b32 s17, s42
  s_bitset0_b32 s41, s17
  s_bitset0_b32 s42, s17
  s_lshl_b32 s17, s17, 10
  s_add_u32 s32, s34, s17
  s_lshl1_add_u32 s33, s17, s34
  s_add_u32 m0, s18, 0
  s_nop 0
  buffer_load_dwordx4 v2, s[24:27], s32 offen sc1 lds
  s_add_u32 m0, m0, 1024
  s_nop 0
  buffer_load_dwordx4 v3, s[28:31], s33 offen sc1 lds
  s_add_u32 m0, s18, 2080
  s_nop 0
  buffer_load_dwordx4 v12, s[24:27], s32 offen sc1 lds
  s_add_u32 m0, m0, 1024
  s_nop 0
  buffer_load_dwordx4 v16, s[28:31], s33 offen sc1 lds
  s_add_u32 m0, s18, 4160
  s_nop 0
  buffer_load_dwordx4 v13, s[24:27], s32 offen sc1 lds
  s_add_u32 m0, m0, 1024
  s_nop 0
  buffer_load_dwordx4 v17, s[28:31], s33 offen sc1 lds
  s_add_u32 m0, s18, 6240
  s_nop 0
  buffer_load_dwordx4 v14, s[24:27], s32 offen sc1 lds
  s_add_u32 m0, m0, 1024
  s_nop 0
  buffer_load_dwordx4 v18, s[28:31], s33 offen sc1 lds
  v_mov_b32 v22, s19
  s_add_u32 s18, s18, 8320
  s_cmp_eq_u32 s18, 156032
  s_cselect_b32 s18, 131072, s18
  s_add_u32 s19, s19, 1
  s_waitcnt vmcnt(8)
  ds_write_b32 v11, v22
  s_cmp_lt_u32 s19, 16
  s_cbranch_scc1 st_loop
  v_mov_b32 v22, s19
  s_waitcnt vmcnt(0)
  ds_write_b32 v11, v22
  s_endpgm
f_done:
  s_endpgm
.section .rodata,"a"
.p2align 6
.amdhsa_kernel parallel_sum__mha_block__mixer_s_mlp__prompt_kernel
  .amdhsa_next_free_vgpr 168
  .amdhsa_next_free_sgpr 102
  .amdhsa_accum_offset 168
  .amdhsa_group_segment_fixed_size 0
  .amdhsa_kernarg_size 88
  .amdhsa_user_sgpr_count 2
  .amdhsa_user_sgpr_kernarg_segment_ptr 1
  .amdhsa_system_sgpr_workgroup_id_x 1
  .amdhsa_float_denorm_mode_32 3
.end_amdhsa_kernel
```
